```python
import torch

def _softmax(x, axis=-1):
    return torch.softmax(x, dim=axis)
def _gelu(x):
    return torch.nn.functional.gelu(x, approximate="tanh")
def _silu(x):
    return torch.nn.functional.silu(x)
def _sigmoid(x):
    return torch.sigmoid(x)
def _layernorm(x, axis=-1, eps=1e-5):
    m = x.mean(dim=axis, keepdim=True)
    v = x.var(dim=axis, keepdim=True, unbiased=False)
    return (x - m) / torch.sqrt(v + eps)
def _scatter_add(tgt, idx, src, axis=0):
    return tgt.clone().index_add_(axis, idx, src)
def _segment_sum(src, seg, n):
    out = torch.zeros((n,) + src.shape[1:], dtype=src.dtype)
    return out.index_add_(0, seg, src)
def _pad(x, pw):
    flat = tuple(v for pair in reversed(pw) for v in pair)
    return torch.nn.functional.pad(x, flat)

kernel_name = 'standalone__batchnorm__sampling'

def setup_inputs():

    _w = (lambda a: (lambda t: t.to(torch.bfloat16) if t.is_floating_point() else t)(torch.as_tensor(a)))
    B, S, C = 1024, 8, 576
    K = 3
    return {
        "x": _w((lambda *s: torch.randn(*s, dtype=torch.bfloat16) * 0.05)(B, S, C)),
        "w": _w((lambda *s: torch.randn(*s, dtype=torch.bfloat16) * 0.05)(K, C, C) * (1.0 / (K * C) ** 0.5)),
        "mean": _w((lambda *s: torch.randn(*s, dtype=torch.bfloat16) * 0.05)(C) * 0.1),
        "var": _w(torch.abs((lambda *s: torch.randn(*s, dtype=torch.bfloat16) * 0.05)(C)) + 0.5),
        "g": _w((lambda *s: torch.randn(*s, dtype=torch.bfloat16) * 0.05)(C) + 1.0),
        "b": _w((lambda *s: torch.randn(*s, dtype=torch.bfloat16) * 0.05)(C) * 0.1),
    }

def reference(x, w, mean, var, g, b):
    K = 3
    P = K // 2
    S = x.shape[1]
    xp = _pad(x, ((0, 0), (P, P), (0, 0)))
    y = sum(torch.einsum('bsc,cd->bsd', xp[:, k:k + S, :], w[k]) for k in range(K))
    inv_std = 1.0 / torch.sqrt(var + 1e-5)
    y = (y - mean) * (g * inv_std) + b
    return _silu(y)
```

```asm
; @launch grid=(256,1,1) block=(512,1,1) lds=163840
.amdgcn_target "amdgcn-amd-amdhsa--gfx950"
.text
.p2align 12
L_base:
.fill 832, 4, 0xbf810000
.globl standalone__batchnorm__sampling_kernel
.p2align 8
.type standalone__batchnorm__sampling_kernel,@function
standalone__batchnorm__sampling_kernel:
  s_cmp_ge_u32 s2, 256
  s_cbranch_scc1 L_end
  s_load_dwordx2 s[24:25], s[0:1], 8
  s_load_dwordx2 s[20:21], s[0:1], 0
  s_load_dwordx8 s[8:15], s[0:1], 16
  s_load_dwordx2 s[28:29], s[0:1], 48
  s_lshr_b32 s42, s2, 3
  s_getpc_b64 s[58:59]
L_pc:
  s_and_b32 s41, s42, 7
  s_mul_i32 s41, s41, 7808
  v_lshl_add_u32 v1, v0, 7, s41
  v_min_u32 v1, L_end-L_pc, v1
  v_cmp_gt_u32 vcc, 61, v0
  s_and_saveexec_b64 s[60:61], vcc
  s_cbranch_execz L_nopf
  global_load_dword v15, v1, s[58:59]
L_nopf:
  s_mov_b64 exec, s[60:61]
  v_lshrrev_b32 v1, 6, v0
  v_and_b32 v0, 63, v0
  s_and_b32 s41, s2, 7
  v_readfirstlane_b32 s33, v1
  s_lshr_b32 s36, s41, 1
  s_andn2_b32 s41, 1, s41
  s_lshl_b32 s41, s41, 5
  s_add_u32 s37, s41, s42
  s_mul_i32 s38, s37, 57
  s_lshr_b32 s38, s38, 9
  s_mul_i32 s41, s38, 9
  s_sub_u32 s39, s37, s41
  s_mul_i32 s41, s36, 7
  s_add_u32 s38, s38, s41
  s_lshl_b32 s41, s36, 1
  s_cmp_eq_u32 s37, 63
  s_cselect_b32 s39, s41, s39
  s_cselect_b32 s38, 28, s38
  s_cselect_b32 s35, 1, 0
  s_mul_i32 s40, s38, 331776
  s_mov_b32 s56, 0xbfb8aa3b
  s_mov_b32 s57, s56
  s_cmp_ge_u32 s33, 4
  s_cbranch_scc0 L_comp
  s_setprio 2
  s_sub_u32 s41, s33, 4
  s_and_b32 s42, s41, 1
  s_lshr_b32 s43, s41, 1
  s_lshl_b32 s44, s42, 2
  v_lshrrev_b32 v10, 3, v0
  v_and_b32 v11, 7, v0
  v_lshrrev_b32 v12, 1, v10
  v_xor_b32 v11, s44, v11
  v_and_b32 v13, 2, v10
  v_lshlrev_b32 v16, 1, v13
  v_xor_b32 v13, v13, v11
  v_mul_u32_u24 v14, 1152, v10
  v_lshl_add_u32 v3, v13, 4, v14
  v_and_b32 v13, 7, v0
  v_xor_b32 v13, v13, v16
  v_lshl_add_u32 v4, v13, 4, v14
  v_xor_b32 v13, v12, v11
  v_mul_u32_u24 v15, 9216, v10
  v_lshl_add_u32 v2, v13, 4, v15
  s_mul_i32 s64, s41, 9216
  s_lshl_b32 s45, s39, 7
  s_add_u32 s64, s64, s45
  s_mul_i32 s62, s42, 73728
  s_add_u32 s62, s62, s40
  s_mov_b32 s44, 112896
  s_mov_b32 s46, 147456
  s_mov_b32 s47, 49152
  s_cmp_eq_u32 s35, 1
  s_cselect_b32 s44, 49152, s44
  s_cselect_b32 s46, 4608, s46
  s_cselect_b32 s47, 8192, s47
  s_mul_i32 s67, s41, 1032
  s_add_u32 s67, s67, s44
  s_mul_i32 s46, s46, s43
  s_add_u32 s62, s62, s46
  s_mul_i32 s47, s47, s43
  s_lshl_b32 s65, s42, 10
  s_add_u32 s65, s65, s47
  s_mov_b32 s26, 1990656
  s_mov_b32 s27, 0x20000
  s_mov_b32 s22, 9437184
  s_mov_b32 s23, 0x20000
  s_add_u32 m0, s67, 4128
  s_add_u32 s70, s64, 663552
  s_waitcnt lgkmcnt(0)
  buffer_load_dwordx4 v4, s[24:27], s70 offen lds
  s_add_u32 m0, s67, 8256
  s_add_u32 s70, s64, 1327104
  buffer_load_dwordx4 v4, s[24:27], s70 offen lds
  s_add_u32 m0, s67, 0
  s_add_u32 s70, s64, 0
  buffer_load_dwordx4 v4, s[24:27], s70 offen lds
  s_add_u32 m0, s65, 0
  s_add_u32 s70, s62, 0
  buffer_load_dwordx4 v2, s[20:23], s70 offen lds
  s_add_u32 m0, s65, 2048
  s_add_u32 s70, s62, 1152
  buffer_load_dwordx4 v2, s[20:23], s70 offen lds
  s_add_u32 m0, s65, 4096
  s_add_u32 s70, s62, 2304
  buffer_load_dwordx4 v2, s[20:23], s70 offen lds
  s_cmp_eq_u32 s35, 1
  s_cbranch_scc1 L_sp_ld
  s_add_u32 m0, s67, 16512
  s_add_u32 s70, s64, 700416
  buffer_load_dwordx4 v4, s[24:27], s70 offen lds
  s_add_u32 m0, s67, 20640
  s_add_u32 s70, s64, 1363968
  buffer_load_dwordx4 v4, s[24:27], s70 offen lds
  s_add_u32 m0, s67, 12384
  s_add_u32 s70, s64, 36864
  buffer_load_dwordx4 v4, s[24:27], s70 offen lds
  s_mul_i32 s46, s41, 9
  s_add_u32 s46, s46, 1
  s_lshl_b32 s66, s46, 7
  s_add_u32 s66, s66, 98304
  s_add_u32 s46, s41, 32
  s_mul_i32 s46, s46, 9216
  s_add_u32 s63, s46, s40
  s_and_b32 s47, s37, 31
  s_mul_i32 s47, s47, 40
  s_mul_i32 s46, s41, 10
  s_add_u32 s47, s47, s46
  s_add_u32 s47, s47, 72576
  s_cmp_lt_u32 s37, 32
  s_cselect_b32 s46, 0, 10
  v_mov_b32 v13, 0x40000000
  v_cmp_gt_u32 vcc, s46, v0
  v_add_u32 v9, s47, v0
  v_lshlrev_b32 v9, 7, v9
  v_cndmask_b32 v9, v13, v9, vcc
  v_lshl_add_u32 v6, v0, 1, s45
  v_lshlrev_b32 v7, 2, v0
  v_add_u32 v7, 162432, v7
  v_mov_b32 v20, 0
  v_mov_b32 v21, 0
  v_mov_b32 v22, 0
  v_mov_b32 v23, 0
  s_lshr_b32 s3, s37, 5
  s_mul_i32 s3, s3, 3
  s_mul_i32 s34, s36, 7
  s_add_u32 s3, s3, s34
  s_mul_i32 s72, s3, 331776
  s_lshr_b32 s3, s2, 3
  s_lshl_b32 s3, s3, 2
  s_add_u32 s3, s3, s41
  s_mul_i32 s34, s3, 10368
  s_add_u32 s72, s72, s34
  v_min_u32 v17, 8, v0
  v_mul_u32_u24 v17, 1152, v17
  s_min_u32 s73, s3, 95
  s_mul_i32 s73, s73, 768
  s_lshl_b32 s34, s2, 2
  s_add_u32 s34, s34, s41
  s_mul_i32 s34, s34, 11
  v_min_u32 v8, 10, v0
  v_add_u32 v8, s34, v8
  v_min_u32 v8, 10367, v8
  v_mul_u32_u24 v19, 77673, v8
  v_lshrrev_b32 v19, 28, v19
  v_mul_u32_u24 v19, 1728, v19
  v_add_u32 v8, v8, v19
  v_add_u32 v8, 1728, v8
  v_lshlrev_b32 v8, 7, v8
  s_getpc_b64 s[96:97]
L_pc2:
  s_lshr_b32 s42, s2, 3
  s_lshl_b32 s42, s42, 2
  s_add_u32 s42, s42, s41
  s_mul_i32 s42, s42, 512
  v_min_u32 v18, 3, v0
  v_lshl_add_u32 v18, v18, 7, s42
  v_min_u32 v18, L_end-L_pc2, v18
  s_mul_i32 s41, s38, 43
  s_lshr_b32 s41, s41, 7
  s_mul_i32 s41, s41, 3
  s_sub_u32 s41, s38, s41
  s_mul_i32 s42, s41, 663552
  s_add_u32 s74, s64, s42
  s_mul_i32 s42, s41, 4128
  s_add_u32 s93, s67, s42
  s_add_u32 s41, s41, 1
  s_cmp_eq_u32 s41, 3
  s_cselect_b32 s41, 0, s41
  s_mul_i32 s42, s41, 663552
  s_add_u32 s75, s64, s42
  s_mul_i32 s42, s41, 4128
  s_add_u32 s100, s67, s42
  s_add_u32 s41, s41, 1
  s_cmp_eq_u32 s41, 3
  s_cselect_b32 s41, 0, s41
  s_mul_i32 s42, s41, 663552
  s_add_u32 s92, s64, s42
  s_mul_i32 s42, s41, 4128
  s_add_u32 s101, s67, s42
  s_add_u32 s41, s39, 0
  s_and_b32 s41, s41, 3
  s_or_b32 s41, s41, 0
  s_mul_i32 s42, s41, 1152
  s_add_u32 s44, s62, s42
  s_lshl_b32 s41, s41, 11
  s_add_u32 s52, s65, s41
  s_add_u32 s41, s39, 1
  s_and_b32 s41, s41, 3
  s_or_b32 s41, s41, 0
  s_mul_i32 s42, s41, 1152
  s_add_u32 s45, s62, s42
  s_lshl_b32 s41, s41, 11
  s_add_u32 s53, s65, s41
  s_add_u32 s41, s39, 2
  s_and_b32 s41, s41, 3
  s_or_b32 s41, s41, 0
  s_mul_i32 s42, s41, 1152
  s_add_u32 s46, s62, s42
  s_lshl_b32 s41, s41, 11
  s_add_u32 s54, s65, s41
  s_add_u32 s41, s39, 3
  s_and_b32 s41, s41, 3
  s_or_b32 s41, s41, 0
  s_mul_i32 s42, s41, 1152
  s_add_u32 s47, s62, s42
  s_lshl_b32 s41, s41, 11
  s_add_u32 s55, s65, s41
  s_add_u32 s41, s39, 4
  s_and_b32 s41, s41, 3
  s_or_b32 s41, s41, 4
  s_mul_i32 s42, s41, 1152
  s_add_u32 s48, s62, s42
  s_lshl_b32 s41, s41, 11
  s_add_u32 s58, s65, s41
  s_add_u32 s41, s39, 5
  s_and_b32 s41, s41, 3
  s_or_b32 s41, s41, 4
  s_mul_i32 s42, s41, 1152
  s_add_u32 s49, s62, s42
  s_lshl_b32 s41, s41, 11
  s_add_u32 s59, s65, s41
  s_add_u32 s41, s39, 6
  s_and_b32 s41, s41, 3
  s_or_b32 s41, s41, 4
  s_mul_i32 s42, s41, 1152
  s_add_u32 s50, s62, s42
  s_lshl_b32 s41, s41, 11
  s_add_u32 s60, s65, s41
  s_add_u32 s41, s39, 7
  s_and_b32 s41, s41, 3
  s_or_b32 s41, s41, 4
  s_mul_i32 s42, s41, 1152
  s_add_u32 s51, s62, s42
  s_lshl_b32 s41, s41, 11
  s_add_u32 s61, s65, s41
  s_waitcnt vmcnt(8)
  s_add_u32 m0, s65, 6144
  s_add_u32 s70, s62, 3456
  buffer_load_dwordx4 v2, s[20:23], s70 offen lds
  s_add_u32 m0, s65, 8192
  s_add_u32 s70, s62, 4608
  buffer_load_dwordx4 v2, s[20:23], s70 offen lds
  s_add_u32 m0, s65, 10240
  s_add_u32 s70, s62, 5760
  buffer_load_dwordx4 v2, s[20:23], s70 offen lds
  s_add_u32 m0, s65, 12288
  s_add_u32 s70, s62, 6912
  buffer_load_dwordx4 v2, s[20:23], s70 offen lds
  s_add_u32 m0, s65, 14336
  s_add_u32 s70, s62, 8064
  buffer_load_dwordx4 v2, s[20:23], s70 offen lds
  s_add_u32 m0, s66, 0
  s_add_u32 s70, s63, 0
  buffer_load_dwordx4 v3, s[20:23], s70 offen lds
  s_add_u32 m0, s65, 16384
  s_add_u32 s70, s62, 128
  buffer_load_dwordx4 v2, s[20:23], s70 offen lds
  s_add_u32 m0, s65, 18432
  s_add_u32 s70, s62, 1280
  buffer_load_dwordx4 v2, s[20:23], s70 offen lds
  s_add_u32 m0, s65, 20480
  s_add_u32 s70, s62, 2432
  buffer_load_dwordx4 v2, s[20:23], s70 offen lds
  s_add_u32 m0, s65, 22528
  s_add_u32 s70, s62, 3584
  buffer_load_dwordx4 v2, s[20:23], s70 offen lds
  s_waitcnt vmcnt(10)
  s_barrier
  s_add_u32 m0, s93, 24768
  s_add_u32 s70, s74, 73728
  buffer_load_dwordx4 v4, s[24:27], s70 offen lds
  s_add_u32 m0, s100, 24768
  s_add_u32 s70, s75, 73728
  buffer_load_dwordx4 v4, s[24:27], s70 offen lds
  s_add_u32 m0, s101, 24768
  s_add_u32 s70, s92, 73728
  buffer_load_dwordx4 v4, s[24:27], s70 offen lds
  s_add_u32 m0, s93, 37152
  s_add_u32 s70, s74, 110592
  buffer_load_dwordx4 v4, s[24:27], s70 offen lds
  s_add_u32 m0, s100, 37152
  s_add_u32 s70, s75, 110592
  buffer_load_dwordx4 v4, s[24:27], s70 offen lds
  s_add_u32 m0, s101, 37152
  s_add_u32 s70, s92, 110592
  buffer_load_dwordx4 v4, s[24:27], s70 offen lds
  buffer_load_dword v31, v9, s[20:23], 0 offen
  buffer_load_dword v30, v8, s[24:27], 0 offen
  s_waitcnt vmcnt(12)
  s_barrier
  s_add_u32 s70, s38, s39
  s_bitcmp1_b32 s70, 0
  s_cbranch_scc1 L_ld_w
  s_add_u32 m0, s58, 16384
  s_add_u32 s70, s48, 128
  buffer_load_dwordx4 v2, s[20:23], s70 offen lds
  s_add_u32 m0, s59, 16384
  s_add_u32 s70, s49, 128
  buffer_load_dwordx4 v2, s[20:23], s70 offen lds
  s_add_u32 m0, s60, 16384
  s_add_u32 s70, s50, 128
  buffer_load_dwordx4 v2, s[20:23], s70 offen lds
  s_add_u32 m0, s61, 16384
  s_add_u32 s70, s51, 128
  buffer_load_dwordx4 v2, s[20:23], s70 offen lds
  s_add_u32 m0, s66, 4864
  s_add_u32 s70, s63, 128
  buffer_load_dwordx4 v3, s[20:23], s70 offen lds
  s_add_u32 m0, s52, 32768
  s_add_u32 s70, s44, 256
  buffer_load_dwordx4 v2, s[20:23], s70 offen lds
  s_add_u32 m0, s53, 32768
  s_add_u32 s70, s45, 256
  buffer_load_dwordx4 v2, s[20:23], s70 offen lds
  s_add_u32 m0, s54, 32768
  s_add_u32 s70, s46, 256
  buffer_load_dwordx4 v2, s[20:23], s70 offen lds
  s_add_u32 m0, s55, 32768
  s_add_u32 s70, s47, 256
  buffer_load_dwordx4 v2, s[20:23], s70 offen lds
  global_load_short_d16_hi v20, v6, s[8:9]
  global_load_short_d16_hi v21, v6, s[10:11]
  global_load_short_d16_hi v22, v6, s[12:13]
  global_load_short_d16_hi v23, v6, s[14:15]
  s_waitcnt vmcnt(15)
  s_barrier
  s_add_u32 m0, s93, 0
  s_add_u32 s70, s74, 147456
  buffer_load_dwordx4 v4, s[24:27], s70 offen lds
  s_add_u32 m0, s100, 0
  s_add_u32 s70, s75, 147456
  buffer_load_dwordx4 v4, s[24:27], s70 offen lds
  s_add_u32 m0, s101, 0
  s_add_u32 s70, s92, 147456
  buffer_load_dwordx4 v4, s[24:27], s70 offen lds
  s_add_u32 m0, s93, 12384
  s_add_u32 s70, s74, 184320
  buffer_load_dwordx4 v4, s[24:27], s70 offen lds
  s_add_u32 m0, s100, 12384
  s_add_u32 s70, s75, 184320
  buffer_load_dwordx4 v4, s[24:27], s70 offen lds
  s_add_u32 m0, s101, 12384
  s_add_u32 s70, s92, 184320
  buffer_load_dwordx4 v4, s[24:27], s70 offen lds
  s_waitcnt vmcnt(14)
  s_barrier
  s_add_u32 m0, s58, 32768
  s_add_u32 s70, s48, 256
  buffer_load_dwordx4 v2, s[20:23], s70 offen lds
  s_add_u32 m0, s59, 32768
  s_add_u32 s70, s49, 256
  buffer_load_dwordx4 v2, s[20:23], s70 offen lds
  s_add_u32 m0, s60, 32768
  s_add_u32 s70, s50, 256
  buffer_load_dwordx4 v2, s[20:23], s70 offen lds
  s_add_u32 m0, s61, 32768
  s_add_u32 s70, s51, 256
  buffer_load_dwordx4 v2, s[20:23], s70 offen lds
  s_add_u32 m0, s66, 9728
  s_add_u32 s70, s63, 256
  buffer_load_dwordx4 v3, s[20:23], s70 offen lds
  s_add_u32 m0, s52, 0
  s_add_u32 s70, s44, 384
  buffer_load_dwordx4 v2, s[20:23], s70 offen lds
  s_add_u32 m0, s53, 0
  s_add_u32 s70, s45, 384
  buffer_load_dwordx4 v2, s[20:23], s70 offen lds
  s_add_u32 m0, s54, 0
  s_add_u32 s70, s46, 384
  buffer_load_dwordx4 v2, s[20:23], s70 offen lds
  s_add_u32 m0, s55, 0
  s_add_u32 s70, s47, 384
  buffer_load_dwordx4 v2, s[20:23], s70 offen lds
  s_waitcnt vmcnt(9)
  s_barrier
  s_add_u32 m0, s93, 24768
  s_add_u32 s70, s74, 221184
  buffer_load_dwordx4 v4, s[24:27], s70 offen lds
  s_add_u32 m0, s100, 24768
  s_add_u32 s70, s75, 221184
  buffer_load_dwordx4 v4, s[24:27], s70 offen lds
  s_add_u32 m0, s101, 24768
  s_add_u32 s70, s92, 221184
  buffer_load_dwordx4 v4, s[24:27], s70 offen lds
  s_add_u32 m0, s93, 37152
  s_add_u32 s70, s74, 258048
  buffer_load_dwordx4 v4, s[24:27], s70 offen lds
  s_add_u32 m0, s100, 37152
  s_add_u32 s70, s75, 258048
  buffer_load_dwordx4 v4, s[24:27], s70 offen lds
  s_add_u32 m0, s101, 37152
  s_add_u32 s70, s92, 258048
  buffer_load_dwordx4 v4, s[24:27], s70 offen lds
  s_waitcnt vmcnt(10)
  s_barrier
  s_add_u32 m0, s58, 0
  s_add_u32 s70, s48, 384
  buffer_load_dwordx4 v2, s[20:23], s70 offen lds
  s_add_u32 m0, s59, 0
  s_add_u32 s70, s49, 384
  buffer_load_dwordx4 v2, s[20:23], s70 offen lds
  s_add_u32 m0, s60, 0
  s_add_u32 s70, s50, 384
  buffer_load_dwordx4 v2, s[20:23], s70 offen lds
  s_add_u32 m0, s61, 0
  s_add_u32 s70, s51, 384
  buffer_load_dwordx4 v2, s[20:23], s70 offen lds
  s_add_u32 m0, s66, 0
  s_add_u32 s70, s63, 384
  buffer_load_dwordx4 v3, s[20:23], s70 offen lds
  s_add_u32 m0, s52, 16384
  s_add_u32 s70, s44, 512
  buffer_load_dwordx4 v2, s[20:23], s70 offen lds
  s_add_u32 m0, s53, 16384
  s_add_u32 s70, s45, 512
  buffer_load_dwordx4 v2, s[20:23], s70 offen lds
  s_add_u32 m0, s54, 16384
  s_add_u32 s70, s46, 512
  buffer_load_dwordx4 v2, s[20:23], s70 offen lds
  s_add_u32 m0, s55, 16384
  s_add_u32 s70, s47, 512
  buffer_load_dwordx4 v2, s[20:23], s70 offen lds
  s_waitcnt vmcnt(9)
  s_barrier
  s_add_u32 m0, s93, 0
  s_add_u32 s70, s74, 294912
  buffer_load_dwordx4 v4, s[24:27], s70 offen lds
  s_add_u32 m0, s100, 0
  s_add_u32 s70, s75, 294912
  buffer_load_dwordx4 v4, s[24:27], s70 offen lds
  s_add_u32 m0, s101, 0
  s_add_u32 s70, s92, 294912
  buffer_load_dwordx4 v4, s[24:27], s70 offen lds
  s_add_u32 m0, s93, 12384
  s_add_u32 s70, s74, 331776
  buffer_load_dwordx4 v4, s[24:27], s70 offen lds
  s_add_u32 m0, s100, 12384
  s_add_u32 s70, s75, 331776
  buffer_load_dwordx4 v4, s[24:27], s70 offen lds
  s_add_u32 m0, s101, 12384
  s_add_u32 s70, s92, 331776
  buffer_load_dwordx4 v4, s[24:27], s70 offen lds
  s_waitcnt vmcnt(10)
  s_barrier
  s_add_u32 m0, s58, 16384
  s_add_u32 s70, s48, 512
  buffer_load_dwordx4 v2, s[20:23], s70 offen lds
  s_add_u32 m0, s59, 16384
  s_add_u32 s70, s49, 512
  buffer_load_dwordx4 v2, s[20:23], s70 offen lds
  s_add_u32 m0, s60, 16384
  s_add_u32 s70, s50, 512
  buffer_load_dwordx4 v2, s[20:23], s70 offen lds
  s_add_u32 m0, s61, 16384
  s_add_u32 s70, s51, 512
  buffer_load_dwordx4 v2, s[20:23], s70 offen lds
  s_add_u32 m0, s66, 4864
  s_add_u32 s70, s63, 512
  buffer_load_dwordx4 v3, s[20:23], s70 offen lds
  s_add_u32 m0, s52, 32768
  s_add_u32 s70, s44, 640
  buffer_load_dwordx4 v2, s[20:23], s70 offen lds
  s_add_u32 m0, s53, 32768
  s_add_u32 s70, s45, 640
  buffer_load_dwordx4 v2, s[20:23], s70 offen lds
  s_add_u32 m0, s54, 32768
  s_add_u32 s70, s46, 640
  buffer_load_dwordx4 v2, s[20:23], s70 offen lds
  s_add_u32 m0, s55, 32768
  s_add_u32 s70, s47, 640
  buffer_load_dwordx4 v2, s[20:23], s70 offen lds
  s_waitcnt vmcnt(45)
  v_add_f32 v21, 0x3727c5ac, v21
  v_mul_f32 v22, s56, v22
  v_rsq_f32 v21, v21
  v_mul_f32 v23, s56, v23
  v_mul_f32 v21, v21, v22
  ds_write_b32 v7, v21
  v_fma_f32 v23, -v20, v21, v23
  ds_write_b32 v7, v23 offset:256
  s_waitcnt vmcnt(9)
  s_barrier
  s_add_u32 m0, s93, 24768
  s_add_u32 s70, s74, 368640
  buffer_load_dwordx4 v4, s[24:27], s70 offen lds
  s_add_u32 m0, s100, 24768
  s_add_u32 s70, s75, 368640
  buffer_load_dwordx4 v4, s[24:27], s70 offen lds
  s_add_u32 m0, s101, 24768
  s_add_u32 s70, s92, 368640
  buffer_load_dwordx4 v4, s[24:27], s70 offen lds
  s_add_u32 m0, s93, 37152
  s_add_u32 s70, s74, 405504
  buffer_load_dwordx4 v4, s[24:27], s70 offen lds
  s_add_u32 m0, s100, 37152
  s_add_u32 s70, s75, 405504
  buffer_load_dwordx4 v4, s[24:27], s70 offen lds
  s_add_u32 m0, s101, 37152
  s_add_u32 s70, s92, 405504
  buffer_load_dwordx4 v4, s[24:27], s70 offen lds
  s_waitcnt vmcnt(10)
  s_barrier
  s_add_u32 m0, s58, 32768
  s_add_u32 s70, s48, 640
  buffer_load_dwordx4 v2, s[20:23], s70 offen lds
  s_add_u32 m0, s59, 32768
  s_add_u32 s70, s49, 640
  buffer_load_dwordx4 v2, s[20:23], s70 offen lds
  s_add_u32 m0, s60, 32768
  s_add_u32 s70, s50, 640
  buffer_load_dwordx4 v2, s[20:23], s70 offen lds
  s_add_u32 m0, s61, 32768
  s_add_u32 s70, s51, 640
  buffer_load_dwordx4 v2, s[20:23], s70 offen lds
  s_add_u32 m0, s66, 9728
  s_add_u32 s70, s63, 640
  buffer_load_dwordx4 v3, s[20:23], s70 offen lds
  s_add_u32 m0, s52, 0
  s_add_u32 s70, s44, 768
  buffer_load_dwordx4 v2, s[20:23], s70 offen lds
  s_add_u32 m0, s53, 0
  s_add_u32 s70, s45, 768
  buffer_load_dwordx4 v2, s[20:23], s70 offen lds
  s_add_u32 m0, s54, 0
  s_add_u32 s70, s46, 768
  buffer_load_dwordx4 v2, s[20:23], s70 offen lds
  s_add_u32 m0, s55, 0
  s_add_u32 s70, s47, 768
  buffer_load_dwordx4 v2, s[20:23], s70 offen lds
  global_load_dword v30, v18, s[96:97]
  s_waitcnt vmcnt(10)
  s_barrier
  s_add_u32 m0, s93, 0
  s_add_u32 s70, s74, 442368
  buffer_load_dwordx4 v4, s[24:27], s70 offen lds
  s_add_u32 m0, s100, 0
  s_add_u32 s70, s75, 442368
  buffer_load_dwordx4 v4, s[24:27], s70 offen lds
  s_add_u32 m0, s101, 0
  s_add_u32 s70, s92, 442368
  buffer_load_dwordx4 v4, s[24:27], s70 offen lds
  s_add_u32 m0, s93, 12384
  s_add_u32 s70, s74, 479232
  buffer_load_dwordx4 v4, s[24:27], s70 offen lds
  s_add_u32 m0, s100, 12384
  s_add_u32 s70, s75, 479232
  buffer_load_dwordx4 v4, s[24:27], s70 offen lds
  s_add_u32 m0, s101, 12384
  s_add_u32 s70, s92, 479232
  buffer_load_dwordx4 v4, s[24:27], s70 offen lds
  s_waitcnt vmcnt(11)
  s_barrier
  s_add_u32 m0, s58, 0
  s_add_u32 s70, s48, 768
  buffer_load_dwordx4 v2, s[20:23], s70 offen lds
  s_add_u32 m0, s59, 0
  s_add_u32 s70, s49, 768
  buffer_load_dwordx4 v2, s[20:23], s70 offen lds
  s_add_u32 m0, s60, 0
  s_add_u32 s70, s50, 768
  buffer_load_dwordx4 v2, s[20:23], s70 offen lds
  s_add_u32 m0, s61, 0
  s_add_u32 s70, s51, 768
  buffer_load_dwordx4 v2, s[20:23], s70 offen lds
  s_add_u32 m0, s66, 0
  s_add_u32 s70, s63, 768
  buffer_load_dwordx4 v3, s[20:23], s70 offen lds
  s_add_u32 m0, s52, 16384
  s_add_u32 s70, s44, 896
  buffer_load_dwordx4 v2, s[20:23], s70 offen lds
  s_add_u32 m0, s53, 16384
  s_add_u32 s70, s45, 896
  buffer_load_dwordx4 v2, s[20:23], s70 offen lds
  s_add_u32 m0, s54, 16384
  s_add_u32 s70, s46, 896
  buffer_load_dwordx4 v2, s[20:23], s70 offen lds
  s_add_u32 m0, s55, 16384
  s_add_u32 s70, s47, 896
  buffer_load_dwordx4 v2, s[20:23], s70 offen lds
  s_waitcnt vmcnt(9)
  s_barrier
  s_add_u32 m0, s93, 24768
  s_add_u32 s70, s74, 516096
  buffer_load_dwordx4 v4, s[24:27], s70 offen lds
  s_add_u32 m0, s100, 24768
  s_add_u32 s70, s75, 516096
  buffer_load_dwordx4 v4, s[24:27], s70 offen lds
  s_add_u32 m0, s101, 24768
  s_add_u32 s70, s92, 516096
  buffer_load_dwordx4 v4, s[24:27], s70 offen lds
  s_add_u32 m0, s93, 37152
  s_add_u32 s70, s74, 552960
  buffer_load_dwordx4 v4, s[24:27], s70 offen lds
  s_add_u32 m0, s100, 37152
  s_add_u32 s70, s75, 552960
  buffer_load_dwordx4 v4, s[24:27], s70 offen lds
  s_add_u32 m0, s101, 37152
  s_add_u32 s70, s92, 552960
  buffer_load_dwordx4 v4, s[24:27], s70 offen lds
  s_add_u32 m0, s52, 32768
  s_add_u32 s70, s44, 1024
  buffer_load_dwordx4 v2, s[20:23], s70 offen lds
  s_add_u32 m0, s53, 32768
  s_add_u32 s70, s45, 1024
  buffer_load_dwordx4 v2, s[20:23], s70 offen lds
  s_add_u32 m0, s54, 32768
  s_add_u32 s70, s46, 1024
  buffer_load_dwordx4 v2, s[20:23], s70 offen lds
  s_add_u32 m0, s55, 32768
  s_add_u32 s70, s47, 1024
  buffer_load_dwordx4 v2, s[20:23], s70 offen lds
  s_waitcnt vmcnt(14)
  s_barrier
  s_add_u32 m0, s93, 0
  s_add_u32 s70, s74, 589824
  buffer_load_dwordx4 v4, s[24:27], s70 offen lds
  s_add_u32 m0, s100, 0
  s_add_u32 s70, s75, 589824
  buffer_load_dwordx4 v4, s[24:27], s70 offen lds
  s_add_u32 m0, s101, 0
  s_add_u32 s70, s92, 589824
  buffer_load_dwordx4 v4, s[24:27], s70 offen lds
  s_add_u32 m0, s93, 12384
  s_add_u32 s70, s74, 626688
  buffer_load_dwordx4 v4, s[24:27], s70 offen lds
  s_add_u32 m0, s100, 12384
  s_add_u32 s70, s75, 626688
  buffer_load_dwordx4 v4, s[24:27], s70 offen lds
  s_add_u32 m0, s101, 12384
  s_add_u32 s70, s92, 626688
  buffer_load_dwordx4 v4, s[24:27], s70 offen lds
  s_add_u32 m0, s58, 16384
  s_add_u32 s70, s48, 896
  buffer_load_dwordx4 v2, s[20:23], s70 offen lds
  s_add_u32 m0, s59, 16384
  s_add_u32 s70, s49, 896
  buffer_load_dwordx4 v2, s[20:23], s70 offen lds
  s_add_u32 m0, s60, 16384
  s_add_u32 s70, s50, 896
  buffer_load_dwordx4 v2, s[20:23], s70 offen lds
  s_add_u32 m0, s61, 16384
  s_add_u32 s70, s51, 896
  buffer_load_dwordx4 v2, s[20:23], s70 offen lds
  s_add_u32 m0, s66, 4864
  s_add_u32 s70, s63, 896
  buffer_load_dwordx4 v3, s[20:23], s70 offen lds
  s_waitcnt vmcnt(15) lgkmcnt(0)
  s_barrier
  s_add_u32 m0, s58, 32768
  s_add_u32 s70, s48, 1024
  buffer_load_dwordx4 v2, s[20:23], s70 offen lds
  s_add_u32 m0, s59, 32768
  s_add_u32 s70, s49, 1024
  buffer_load_dwordx4 v2, s[20:23], s70 offen lds
  s_add_u32 m0, s60, 32768
  s_add_u32 s70, s50, 1024
  buffer_load_dwordx4 v2, s[20:23], s70 offen lds
  s_add_u32 m0, s61, 32768
  s_add_u32 s70, s51, 1024
  buffer_load_dwordx4 v2, s[20:23], s70 offen lds
  s_add_u32 m0, s66, 9728
  s_add_u32 s70, s63, 1024
  buffer_load_dwordx4 v3, s[20:23], s70 offen lds
  s_waitcnt vmcnt(10)
  s_barrier
  s_waitcnt vmcnt(5)
  s_barrier
  s_waitcnt vmcnt(0)
  s_barrier
  s_endpgm
.fill ((2460 - (. - L_base)) & 4095) / 4, 4, 0xbf810000
L_comp:
  s_cmp_eq_u32 s35, 1
  s_cbranch_scc1 L_sp_comp
  s_lshr_b32 s41, s33, 1
  s_and_b32 s42, s33, 1
  v_and_b32 v60, 15, v0
  v_lshrrev_b32 v61, 4, v0
  s_lshl_b32 s43, s39, 7
  s_lshl_b32 s44, s42, 6
  s_add_u32 s43, s43, s44
  s_lshl_b32 s44, s42, 7
  s_add_u32 s44, s44, 162432
  v_lshl_add_u32 v10, v61, 5, s44
  v_and_b32 v62, 1, v61
  v_lshrrev_b32 v63, 1, v61
  v_mul_u32_u24 v8, 9216, v60
  v_lshl_add_u32 v8, v63, 4, v8
  v_lshl_add_u32 v8, v62, 5, v8
  v_lshrrev_b32 v71, 3, v60
  v_and_b32 v72, 7, v60
  v_mul_u32_u24 v9, 9216, v71
  v_mul_u32_u24 v64, 1152, v72
  v_add_u32 v9, v9, v64
  v_lshl_add_u32 v9, v63, 4, v9
  v_lshl_add_u32 v9, v62, 5, v9
  s_mul_i32 s44, s41, 147456
  s_add_u32 s48, s40, s44
  s_add_u32 s48, s48, s43
  s_mul_i32 s44, s41, 18432
  s_add_u32 s50, s40, s44
  s_add_u32 s50, s50, 294912
  s_add_u32 s50, s50, s43
  s_mul_i32 s44, s41, 18
  v_mad_u32_u24 v64, v71, 9, v72
  v_add_u32 v64, s44, v64
  v_add_u32 v65, 0, v64
  v_add_u32 v66, -1, v72
  v_and_b32 v66, 2, v66
  v_lshl_add_u32 v66, v71, 2, v66
  v_xor_b32 v66, v66, v61
  v_lshlrev_b32 v66, 4, v66
  v_lshl_add_u32 v66, v65, 7, v66
  v_add_u32 v3, 98304, v66
  v_xor_b32 v11, 64, v3
  v_add_u32 v65, 1, v64
  v_add_u32 v66, 0, v72
  v_and_b32 v66, 2, v66
  v_lshl_add_u32 v66, v71, 2, v66
  v_xor_b32 v66, v66, v61
  v_lshlrev_b32 v66, 4, v66
  v_lshl_add_u32 v66, v65, 7, v66
  v_add_u32 v4, 98304, v66
  v_xor_b32 v12, 64, v4
  v_add_u32 v65, 2, v64
  v_add_u32 v66, 1, v72
  v_and_b32 v66, 2, v66
  v_lshl_add_u32 v66, v71, 2, v66
  v_xor_b32 v66, v66, v61
  v_lshlrev_b32 v66, 4, v66
  v_lshl_add_u32 v66, v65, 7, v66
  v_add_u32 v5, 98304, v66
  v_xor_b32 v13, 64, v5
  v_mul_u32_u24 v8, 9216, v60
  v_lshl_add_u32 v8, v61, 4, v8
  v_mul_u32_u24 v9, 9216, v71
  v_mul_u32_u24 v64, 1152, v72
  v_add_u32 v9, v9, v64
  v_lshl_add_u32 v9, v61, 4, v9
  s_add_u32 s49, s48, 4608
  v_lshrrev_b32 v64, 1, v60
  v_xor_b32 v64, v64, v61
  v_lshlrev_b32 v64, 4, v64
  v_lshl_add_u32 v2, v60, 7, v64
  s_mul_i32 s44, s41, 49152
  v_add_u32 v2, s44, v2
  v_xor_b32 v1, 64, v2
  v_lshrrev_b32 v64, 2, v60
  v_and_b32 v65, 3, v60
  v_lshl_add_u32 v66, v61, 3, v64
  v_and_b32 v67, 2, v64
  v_lshlrev_b32 v67, 1, v67
  s_lshl_b32 s44, s42, 2
  v_add_u32 v68, s44, v65
  v_xor_b32 v68, v68, v67
  v_mul_u32_u24 v69, 1032, v61
  v_lshl_add_u32 v69, v64, 7, v69
  v_lshl_add_u32 v69, v68, 4, v69
  v_add_u32 v69, 112896, v69
  v_mov_b32 v6, v69
  v_add_u32 v7, 8, v69
  v_mov_b32 v72, 0
  v_mov_b32 v73, 0
  v_mov_b32 v74, 0
  v_mov_b32 v75, 0
  v_lshrrev_b32 v64, 3, v0
  s_lshl_b32 s44, s33, 3
  v_add_u32 v64, s44, v64
  v_min_u32 v64, 14, v64
  v_mul_u32_u24 v65, 52, v64
  v_lshrrev_b32 v65, 8, v65
  v_mul_u32_u24 v66, 5, v65
  v_sub_u32 v66, v64, v66
  v_mul_u32_u24 v65, 4864, v65
  v_mul_u32_u24 v66, 1152, v66
  v_add_u32 v65, v65, v66
  v_and_b32 v66, 7, v0
  v_lshl_add_u32 v65, v66, 4, v65
  v_add_u32 v65, 98304, v65
  ds_write_b128 v65, v[72:75]
  s_mov_b32 s30, 9437184
  s_mov_b32 s31, 0x20000
  s_waitcnt lgkmcnt(0)
  s_cmp_eq_u32 s33, 0
  s_cbranch_scc1 L_t_pu_0
  s_cmp_eq_u32 s33, 1
  s_cbranch_scc1 L_t_pu_1
  s_cmp_eq_u32 s33, 2
  s_cbranch_scc1 L_t_pu_2
L_r_pu_0:
L_r_pu_1:
L_r_pu_2:
  s_cmp_eq_u32 0, 1
  s_barrier
  ds_read_b64_tr_b16 v[16:17], v6 offset:4128
  ds_read_b64_tr_b16 v[18:19], v6 offset:4640
  ds_read_b128 v[20:23], v2 offset:0
  ds_read_b64_tr_b16 v[24:25], v6 offset:16512
  ds_read_b64_tr_b16 v[26:27], v6 offset:17024
  ds_read_b128 v[28:31], v1 offset:0
  ds_read_b64_tr_b16 v[32:33], v6 offset:8256
  ds_read_b64_tr_b16 v[34:35], v6 offset:8768
  ds_read_b128 v[36:39], v2 offset:2048
  ds_read_b64_tr_b16 v[40:41], v6 offset:20640
  ds_read_b64_tr_b16 v[42:43], v6 offset:21152
  ds_read_b128 v[44:47], v1 offset:2048
  ds_read_b64_tr_b16 v[48:49], v7 offset:20640
  ds_read_b64_tr_b16 v[50:51], v7 offset:21152
  ds_read_b64_tr_b16 v[52:53], v7 offset:8256
  ds_read_b64_tr_b16 v[54:55], v7 offset:8768
  ds_read_b64_tr_b16 v[56:57], v7 offset:16512
  ds_read_b64_tr_b16 v[58:59], v7 offset:17024
  ds_read_b64_tr_b16 v[60:61], v7 offset:4128
  ds_read_b64_tr_b16 v[62:63], v7 offset:4640
  s_waitcnt lgkmcnt(15)
  v_mfma_f32_16x16x32_bf16 v[152:155], v[16:19], v[20:23], 0
  ds_read_b64_tr_b16 v[64:65], v6 offset:0
  ds_read_b64_tr_b16 v[66:67], v6 offset:512
  s_waitcnt lgkmcnt(15)
  v_mfma_f32_16x16x32_bf16 v[152:155], v[24:27], v[28:31], v[152:155]
  ds_read_b64_tr_b16 v[68:69], v6 offset:12384
  ds_read_b64_tr_b16 v[70:71], v6 offset:12896
  s_waitcnt lgkmcnt(15)
  v_mfma_f32_16x16x32_bf16 v[152:155], v[32:35], v[36:39], v[152:155]
  ds_read_b128 v[72:75], v2 offset:4096
  s_waitcnt lgkmcnt(13)
  v_mfma_f32_16x16x32_bf16 v[152:155], v[40:43], v[44:47], v[152:155]
  ds_read_b128 v[76:79], v1 offset:4096
  s_waitcnt lgkmcnt(12)
  v_mfma_f32_16x16x32_bf16 v[156:159], v[48:51], v[44:47], 0
  ds_read_b64_tr_b16 v[80:81], v7 offset:12384
  s_waitcnt lgkmcnt(11)
  v_mfma_f32_16x16x32_bf16 v[156:159], v[52:55], v[36:39], v[156:159]
  ds_read_b64_tr_b16 v[82:83], v7 offset:12896
  s_waitcnt lgkmcnt(10)
  v_mfma_f32_16x16x32_bf16 v[156:159], v[56:59], v[28:31], v[156:159]
  ds_read_b64_tr_b16 v[84:85], v7 offset:0
  s_waitcnt lgkmcnt(9)
  v_mfma_f32_16x16x32_bf16 v[156:159], v[60:63], v[20:23], v[156:159]
  ds_read_b64_tr_b16 v[86:87], v7 offset:512
  s_waitcnt lgkmcnt(8)
  v_mfma_f32_16x16x32_bf16 v[160:163], v[64:67], v[20:23], 0
  s_waitcnt lgkmcnt(6)
  v_mfma_f32_16x16x32_bf16 v[160:163], v[68:71], v[28:31], v[160:163]
  v_mfma_f32_16x16x32_bf16 v[160:163], v[16:19], v[36:39], v[160:163]
  v_mfma_f32_16x16x32_bf16 v[160:163], v[24:27], v[44:47], v[160:163]
  s_waitcnt lgkmcnt(5)
  v_mfma_f32_16x16x32_bf16 v[160:163], v[32:35], v[72:75], v[160:163]
  s_waitcnt lgkmcnt(4)
  v_mfma_f32_16x16x32_bf16 v[160:163], v[40:43], v[76:79], v[160:163]
  v_mfma_f32_16x16x32_bf16 v[164:167], v[48:51], v[76:79], 0
  v_mfma_f32_16x16x32_bf16 v[164:167], v[52:55], v[72:75], v[164:167]
  v_mfma_f32_16x16x32_bf16 v[164:167], v[56:59], v[44:47], v[164:167]
  v_mfma_f32_16x16x32_bf16 v[164:167], v[60:63], v[36:39], v[164:167]
  s_waitcnt lgkmcnt(0)
  v_mfma_f32_16x16x32_bf16 v[164:167], v[80:83], v[28:31], v[164:167]
  s_barrier
  ds_read_b128 v[88:91], v2 offset:6144
  ds_read_b128 v[92:95], v1 offset:6144
  v_mfma_f32_16x16x32_bf16 v[164:167], v[84:87], v[20:23], v[164:167]
  ds_read_b128 v[96:99], v2 offset:8192
  v_mfma_f32_16x16x32_bf16 v[168:171], v[64:67], v[36:39], 0
  ds_read_b128 v[100:103], v1 offset:8192
  v_mfma_f32_16x16x32_bf16 v[168:171], v[68:71], v[44:47], v[168:171]
  v_mfma_f32_16x16x32_bf16 v[168:171], v[16:19], v[72:75], v[168:171]
  ds_read_b128 v[104:107], v2 offset:10240
  v_mfma_f32_16x16x32_bf16 v[168:171], v[24:27], v[76:79], v[168:171]
  ds_read_b128 v[108:111], v1 offset:10240
  s_waitcnt lgkmcnt(5)
  v_mfma_f32_16x16x32_bf16 v[168:171], v[32:35], v[88:91], v[168:171]
  s_waitcnt lgkmcnt(4)
  v_mfma_f32_16x16x32_bf16 v[168:171], v[40:43], v[92:95], v[168:171]
  v_mfma_f32_16x16x32_bf16 v[172:175], v[48:51], v[92:95], 0
  v_mfma_f32_16x16x32_bf16 v[172:175], v[52:55], v[88:91], v[172:175]
  v_mfma_f32_16x16x32_bf16 v[172:175], v[56:59], v[76:79], v[172:175]
  v_mfma_f32_16x16x32_bf16 v[172:175], v[60:63], v[72:75], v[172:175]
  v_mfma_f32_16x16x32_bf16 v[172:175], v[80:83], v[44:47], v[172:175]
  v_mfma_f32_16x16x32_bf16 v[172:175], v[84:87], v[36:39], v[172:175]
  v_mfma_f32_16x16x32_bf16 v[176:179], v[64:67], v[72:75], 0
  v_mfma_f32_16x16x32_bf16 v[176:179], v[68:71], v[76:79], v[176:179]
  v_mfma_f32_16x16x32_bf16 v[176:179], v[16:19], v[88:91], v[176:179]
  ds_read_b128 v[112:115], v2 offset:12288
  v_mfma_f32_16x16x32_bf16 v[176:179], v[24:27], v[92:95], v[176:179]
  ds_read_b128 v[116:119], v1 offset:12288
  s_waitcnt lgkmcnt(2)
  v_mfma_f32_16x16x32_bf16 v[176:179], v[32:35], v[96:99], v[176:179]
  v_mfma_f32_16x16x32_bf16 v[176:179], v[40:43], v[100:103], v[176:179]
  v_mfma_f32_16x16x32_bf16 v[180:183], v[48:51], v[100:103], 0
  v_mfma_f32_16x16x32_bf16 v[180:183], v[52:55], v[96:99], v[180:183]
  v_mfma_f32_16x16x32_bf16 v[180:183], v[56:59], v[92:95], v[180:183]
  v_mfma_f32_16x16x32_bf16 v[180:183], v[60:63], v[88:91], v[180:183]
  v_mfma_f32_16x16x32_bf16 v[180:183], v[80:83], v[76:79], v[180:183]
  v_mfma_f32_16x16x32_bf16 v[180:183], v[84:87], v[72:75], v[180:183]
  v_mfma_f32_16x16x32_bf16 v[184:187], v[64:67], v[88:91], 0
  v_mfma_f32_16x16x32_bf16 v[184:187], v[68:71], v[92:95], v[184:187]
  v_mfma_f32_16x16x32_bf16 v[184:187], v[16:19], v[96:99], v[184:187]
  ds_read_b128 v[120:123], v2 offset:14336
  v_mfma_f32_16x16x32_bf16 v[184:187], v[24:27], v[100:103], v[184:187]
  ds_read_b128 v[124:127], v1 offset:14336
  v_mfma_f32_16x16x32_bf16 v[184:187], v[32:35], v[104:107], v[184:187]
  v_mfma_f32_16x16x32_bf16 v[184:187], v[40:43], v[108:111], v[184:187]
  v_mfma_f32_16x16x32_bf16 v[188:191], v[48:51], v[108:111], 0
  v_mfma_f32_16x16x32_bf16 v[188:191], v[52:55], v[104:107], v[188:191]
  v_mfma_f32_16x16x32_bf16 v[188:191], v[56:59], v[100:103], v[188:191]
  v_mfma_f32_16x16x32_bf16 v[188:191], v[60:63], v[96:99], v[188:191]
  v_mfma_f32_16x16x32_bf16 v[188:191], v[80:83], v[92:95], v[188:191]
  v_mfma_f32_16x16x32_bf16 v[188:191], v[84:87], v[88:91], v[188:191]
  v_mfma_f32_16x16x32_bf16 v[192:195], v[64:67], v[96:99], 0
  v_mfma_f32_16x16x32_bf16 v[192:195], v[68:71], v[100:103], v[192:195]
  v_mfma_f32_16x16x32_bf16 v[192:195], v[16:19], v[104:107], v[192:195]
  v_mfma_f32_16x16x32_bf16 v[192:195], v[24:27], v[108:111], v[192:195]
  s_waitcnt lgkmcnt(0)
  v_mfma_f32_16x16x32_bf16 v[192:195], v[32:35], v[112:115], v[192:195]
  v_mfma_f32_16x16x32_bf16 v[192:195], v[40:43], v[116:119], v[192:195]
  v_mfma_f32_16x16x32_bf16 v[196:199], v[48:51], v[116:119], 0
  ds_read_b128 v[128:131], v3 offset:0
  v_mfma_f32_16x16x32_bf16 v[196:199], v[52:55], v[112:115], v[196:199]
  ds_read_b128 v[132:135], v11 offset:0
  v_mfma_f32_16x16x32_bf16 v[196:199], v[56:59], v[108:111], v[196:199]
  ds_read_b128 v[136:139], v4 offset:0
  v_mfma_f32_16x16x32_bf16 v[196:199], v[60:63], v[104:107], v[196:199]
  ds_read_b128 v[140:143], v12 offset:0
  v_mfma_f32_16x16x32_bf16 v[196:199], v[80:83], v[100:103], v[196:199]
  ds_read_b128 v[144:147], v5 offset:0
  v_mfma_f32_16x16x32_bf16 v[196:199], v[84:87], v[96:99], v[196:199]
  ds_read_b128 v[148:151], v13 offset:0
  v_mfma_f32_16x16x32_bf16 v[200:203], v[64:67], v[104:107], 0
L_t_pu_0:
  s_cbranch_scc1 L_r_pu_0
  v_mfma_f32_16x16x32_bf16 v[200:203], v[68:71], v[108:111], v[200:203]
  v_mfma_f32_16x16x32_bf16 v[200:203], v[16:19], v[112:115], v[200:203]
  v_mfma_f32_16x16x32_bf16 v[200:203], v[24:27], v[116:119], v[200:203]
  v_mfma_f32_16x16x32_bf16 v[200:203], v[32:35], v[120:123], v[200:203]
  v_mfma_f32_16x16x32_bf16 v[200:203], v[40:43], v[124:127], v[200:203]
  v_mfma_f32_16x16x32_bf16 v[204:207], v[48:51], v[124:127], 0
  v_mfma_f32_16x16x32_bf16 v[204:207], v[52:55], v[120:123], v[204:207]
  v_mfma_f32_16x16x32_bf16 v[204:207], v[56:59], v[116:119], v[204:207]
  s_waitcnt lgkmcnt(0)
  s_barrier
  ds_read_b64_tr_b16 v[244:245], v6 offset:28896
  v_mfma_f32_16x16x32_bf16 v[204:207], v[60:63], v[112:115], v[204:207]
  ds_read_b64_tr_b16 v[246:247], v6 offset:29408
  v_mfma_f32_16x16x32_bf16 v[204:207], v[80:83], v[108:111], v[204:207]
  ds_read_b128 v[248:251], v2 offset:16384
  v_mfma_f32_16x16x32_bf16 v[204:207], v[84:87], v[104:107], v[204:207]
  ds_read_b64_tr_b16 v[252:253], v6 offset:41280
  v_mfma_f32_16x16x32_bf16 v[208:211], v[64:67], v[112:115], 0
  ds_read_b64_tr_b16 v[254:255], v6 offset:41792
  v_mfma_f32_16x16x32_bf16 v[208:211], v[68:71], v[116:119], v[208:211]
  ds_read_b128 v[28:31], v1 offset:16384
  v_mfma_f32_16x16x32_bf16 v[208:211], v[16:19], v[120:123], v[208:211]
  ds_read_b64_tr_b16 v[20:21], v6 offset:33024
  v_mfma_f32_16x16x32_bf16 v[208:211], v[24:27], v[124:127], v[208:211]
  ds_read_b64_tr_b16 v[22:23], v6 offset:33536
  v_mfma_f32_16x16x32_bf16 v[212:215], v[56:59], v[124:127], 0
  ds_read_b128 v[44:47], v2 offset:18432
  v_mfma_f32_16x16x32_bf16 v[212:215], v[60:63], v[120:123], v[212:215]
  ds_read_b64_tr_b16 v[36:37], v6 offset:45408
  v_mfma_f32_16x16x32_bf16 v[212:215], v[80:83], v[116:119], v[212:215]
  ds_read_b64_tr_b16 v[38:39], v6 offset:45920
  v_mfma_f32_16x16x32_bf16 v[212:215], v[84:87], v[112:115], v[212:215]
  ds_read_b128 v[76:79], v1 offset:18432
  v_mfma_f32_16x16x32_bf16 v[216:219], v[64:67], v[128:131], 0
  ds_read_b64_tr_b16 v[72:73], v7 offset:45408
  v_mfma_f32_16x16x32_bf16 v[216:219], v[68:71], v[132:135], v[216:219]
  ds_read_b64_tr_b16 v[74:75], v7 offset:45920
  v_mfma_f32_16x16x32_bf16 v[216:219], v[16:19], v[136:139], v[216:219]
  ds_read_b64_tr_b16 v[92:93], v7 offset:33024
  v_mfma_f32_16x16x32_bf16 v[216:219], v[24:27], v[140:143], v[216:219]
  ds_read_b64_tr_b16 v[94:95], v7 offset:33536
  v_mfma_f32_16x16x32_bf16 v[216:219], v[32:35], v[144:147], v[216:219]
  ds_read_b64_tr_b16 v[88:89], v7 offset:41280
  v_mfma_f32_16x16x32_bf16 v[216:219], v[40:43], v[148:151], v[216:219]
  ds_read_b64_tr_b16 v[90:91], v7 offset:41792
  v_mfma_f32_16x16x32_bf16 v[220:223], v[48:51], v[148:151], 0
  ds_read_b64_tr_b16 v[100:101], v7 offset:28896
  v_mfma_f32_16x16x32_bf16 v[220:223], v[52:55], v[144:147], v[220:223]
  ds_read_b64_tr_b16 v[102:103], v7 offset:29408
  v_mfma_f32_16x16x32_bf16 v[220:223], v[56:59], v[140:143], v[220:223]
  ds_read_b64_tr_b16 v[96:97], v6 offset:24768
  v_mfma_f32_16x16x32_bf16 v[220:223], v[60:63], v[136:139], v[220:223]
  ds_read_b64_tr_b16 v[98:99], v6 offset:25280
  v_mfma_f32_16x16x32_bf16 v[220:223], v[80:83], v[132:135], v[220:223]
  ds_read_b64_tr_b16 v[108:109], v6 offset:37152
  v_mfma_f32_16x16x32_bf16 v[220:223], v[84:87], v[128:131], v[220:223]
  ds_read_b64_tr_b16 v[110:111], v6 offset:37664
  s_waitcnt lgkmcnt(10)
  v_mfma_f32_16x16x32_bf16 v[152:155], v[244:247], v[248:251], v[152:155]
  ds_read_b128 v[104:107], v2 offset:20480
  v_mfma_f32_16x16x32_bf16 v[152:155], v[252:255], v[28:31], v[152:155]
  ds_read_b128 v[124:127], v1 offset:20480
  v_mfma_f32_16x16x32_bf16 v[152:155], v[20:23], v[44:47], v[152:155]
  ds_read_b64_tr_b16 v[120:121], v7 offset:37152
  v_mfma_f32_16x16x32_bf16 v[152:155], v[36:39], v[76:79], v[152:155]
  ds_read_b64_tr_b16 v[122:123], v7 offset:37664
  v_mfma_f32_16x16x32_bf16 v[156:159], v[72:75], v[76:79], v[156:159]
  ds_read_b64_tr_b16 v[116:117], v7 offset:24768
  s_waitcnt lgkmcnt(10)
  v_mfma_f32_16x16x32_bf16 v[156:159], v[92:95], v[44:47], v[156:159]
  ds_read_b64_tr_b16 v[118:119], v7 offset:25280
  v_mfma_f32_16x16x32_bf16 v[156:159], v[88:91], v[28:31], v[156:159]
  ds_read_b128 v[112:115], v2 offset:22528
  s_waitcnt lgkmcnt(10)
  v_mfma_f32_16x16x32_bf16 v[156:159], v[100:103], v[248:251], v[156:159]
  ds_read_b128 v[64:67], v1 offset:22528
  s_waitcnt lgkmcnt(10)
  v_mfma_f32_16x16x32_bf16 v[160:163], v[96:99], v[248:251], v[160:163]
  s_waitcnt lgkmcnt(8)
  v_mfma_f32_16x16x32_bf16 v[160:163], v[108:111], v[28:31], v[160:163]
  v_mfma_f32_16x16x32_bf16 v[160:163], v[244:247], v[44:47], v[160:163]
  v_mfma_f32_16x16x32_bf16 v[160:163], v[252:255], v[76:79], v[160:163]
  s_waitcnt lgkmcnt(6)
  v_mfma_f32_16x16x32_bf16 v[160:163], v[20:23], v[104:107], v[160:163]
  v_mfma_f32_16x16x32_bf16 v[160:163], v[36:39], v[124:127], v[160:163]
  v_mfma_f32_16x16x32_bf16 v[164:167], v[72:75], v[124:127], v[164:167]
  v_mfma_f32_16x16x32_bf16 v[164:167], v[92:95], v[104:107], v[164:167]
  v_mfma_f32_16x16x32_bf16 v[164:167], v[88:91], v[76:79], v[164:167]
  v_mfma_f32_16x16x32_bf16 v[164:167], v[100:103], v[44:47], v[164:167]
  s_waitcnt lgkmcnt(0)
  v_mfma_f32_16x16x32_bf16 v[164:167], v[120:123], v[28:31], v[164:167]
  v_mfma_f32_16x16x32_bf16 v[164:167], v[116:119], v[248:251], v[164:167]
  v_mfma_f32_16x16x32_bf16 v[168:171], v[96:99], v[44:47], v[168:171]
  s_barrier
  ds_read_b128 v[68:71], v2 offset:24576
  v_mfma_f32_16x16x32_bf16 v[168:171], v[108:111], v[76:79], v[168:171]
  ds_read_b128 v[16:19], v1 offset:24576
  v_mfma_f32_16x16x32_bf16 v[168:171], v[244:247], v[104:107], v[168:171]
  ds_read_b128 v[24:27], v2 offset:26624
  v_mfma_f32_16x16x32_bf16 v[168:171], v[252:255], v[124:127], v[168:171]
  ds_read_b128 v[32:35], v1 offset:26624
  v_mfma_f32_16x16x32_bf16 v[168:171], v[20:23], v[112:115], v[168:171]
  v_mfma_f32_16x16x32_bf16 v[168:171], v[36:39], v[64:67], v[168:171]
  v_mfma_f32_16x16x32_bf16 v[172:175], v[72:75], v[64:67], v[172:175]
  v_mfma_f32_16x16x32_bf16 v[172:175], v[92:95], v[112:115], v[172:175]
  v_mfma_f32_16x16x32_bf16 v[172:175], v[88:91], v[124:127], v[172:175]
  v_mfma_f32_16x16x32_bf16 v[172:175], v[100:103], v[104:107], v[172:175]
  v_mfma_f32_16x16x32_bf16 v[172:175], v[120:123], v[76:79], v[172:175]
  v_mfma_f32_16x16x32_bf16 v[172:175], v[116:119], v[44:47], v[172:175]
  v_mfma_f32_16x16x32_bf16 v[176:179], v[96:99], v[104:107], v[176:179]
  v_mfma_f32_16x16x32_bf16 v[176:179], v[108:111], v[124:127], v[176:179]
  v_mfma_f32_16x16x32_bf16 v[176:179], v[244:247], v[112:115], v[176:179]
  ds_read_b128 v[40:43], v2 offset:28672
  v_mfma_f32_16x16x32_bf16 v[176:179], v[252:255], v[64:67], v[176:179]
  ds_read_b128 v[48:51], v1 offset:28672
  s_waitcnt lgkmcnt(2)
  v_mfma_f32_16x16x32_bf16 v[176:179], v[20:23], v[68:71], v[176:179]
  v_mfma_f32_16x16x32_bf16 v[176:179], v[36:39], v[16:19], v[176:179]
  v_mfma_f32_16x16x32_bf16 v[180:183], v[72:75], v[16:19], v[180:183]
  v_mfma_f32_16x16x32_bf16 v[180:183], v[92:95], v[68:71], v[180:183]
  v_mfma_f32_16x16x32_bf16 v[180:183], v[88:91], v[64:67], v[180:183]
  v_mfma_f32_16x16x32_bf16 v[180:183], v[100:103], v[112:115], v[180:183]
  v_mfma_f32_16x16x32_bf16 v[180:183], v[120:123], v[124:127], v[180:183]
  v_mfma_f32_16x16x32_bf16 v[180:183], v[116:119], v[104:107], v[180:183]
  v_mfma_f32_16x16x32_bf16 v[184:187], v[96:99], v[112:115], v[184:187]
  v_mfma_f32_16x16x32_bf16 v[184:187], v[108:111], v[64:67], v[184:187]
  v_mfma_f32_16x16x32_bf16 v[184:187], v[244:247], v[68:71], v[184:187]
  ds_read_b128 v[148:151], v2 offset:30720
  v_mfma_f32_16x16x32_bf16 v[184:187], v[252:255], v[16:19], v[184:187]
  ds_read_b128 v[52:55], v1 offset:30720
  v_mfma_f32_16x16x32_bf16 v[184:187], v[20:23], v[24:27], v[184:187]
  v_mfma_f32_16x16x32_bf16 v[184:187], v[36:39], v[32:35], v[184:187]
  v_mfma_f32_16x16x32_bf16 v[188:191], v[72:75], v[32:35], v[188:191]
  v_mfma_f32_16x16x32_bf16 v[188:191], v[92:95], v[24:27], v[188:191]
  v_mfma_f32_16x16x32_bf16 v[188:191], v[88:91], v[16:19], v[188:191]
  v_mfma_f32_16x16x32_bf16 v[188:191], v[100:103], v[68:71], v[188:191]
  v_mfma_f32_16x16x32_bf16 v[188:191], v[120:123], v[64:67], v[188:191]
  v_mfma_f32_16x16x32_bf16 v[188:191], v[116:119], v[112:115], v[188:191]
  v_mfma_f32_16x16x32_bf16 v[192:195], v[96:99], v[68:71], v[192:195]
  v_mfma_f32_16x16x32_bf16 v[192:195], v[108:111], v[16:19], v[192:195]
  v_mfma_f32_16x16x32_bf16 v[192:195], v[244:247], v[24:27], v[192:195]
  v_mfma_f32_16x16x32_bf16 v[192:195], v[252:255], v[32:35], v[192:195]
  s_waitcnt lgkmcnt(0)
  v_mfma_f32_16x16x32_bf16 v[192:195], v[20:23], v[40:43], v[192:195]
  v_mfma_f32_16x16x32_bf16 v[192:195], v[36:39], v[48:51], v[192:195]
  v_mfma_f32_16x16x32_bf16 v[196:199], v[72:75], v[48:51], v[196:199]
  ds_read_b128 v[144:147], v3 offset:4864
  v_mfma_f32_16x16x32_bf16 v[196:199], v[92:95], v[40:43], v[196:199]
  ds_read_b128 v[56:59], v11 offset:4864
  v_mfma_f32_16x16x32_bf16 v[196:199], v[88:91], v[32:35], v[196:199]
  ds_read_b128 v[140:143], v4 offset:4864
  v_mfma_f32_16x16x32_bf16 v[196:199], v[100:103], v[24:27], v[196:199]
  ds_read_b128 v[60:63], v12 offset:4864
  v_mfma_f32_16x16x32_bf16 v[196:199], v[120:123], v[16:19], v[196:199]
  ds_read_b128 v[136:139], v5 offset:4864
  v_mfma_f32_16x16x32_bf16 v[196:199], v[116:119], v[68:71], v[196:199]
  ds_read_b128 v[80:83], v13 offset:4864
  v_mfma_f32_16x16x32_bf16 v[200:203], v[96:99], v[24:27], v[200:203]
  v_mfma_f32_16x16x32_bf16 v[200:203], v[108:111], v[32:35], v[200:203]
  v_mfma_f32_16x16x32_bf16 v[200:203], v[244:247], v[40:43], v[200:203]
  v_mfma_f32_16x16x32_bf16 v[200:203], v[252:255], v[48:51], v[200:203]
  v_mfma_f32_16x16x32_bf16 v[200:203], v[20:23], v[148:151], v[200:203]
  v_mfma_f32_16x16x32_bf16 v[200:203], v[36:39], v[52:55], v[200:203]
  v_mfma_f32_16x16x32_bf16 v[204:207], v[72:75], v[52:55], v[204:207]
  v_mfma_f32_16x16x32_bf16 v[204:207], v[92:95], v[148:151], v[204:207]
  v_mfma_f32_16x16x32_bf16 v[204:207], v[88:91], v[48:51], v[204:207]
  s_waitcnt lgkmcnt(0)
  s_barrier
  ds_read_b64_tr_b16 v[132:133], v6 offset:4128
  v_mfma_f32_16x16x32_bf16 v[204:207], v[100:103], v[40:43], v[204:207]
  ds_read_b64_tr_b16 v[134:135], v6 offset:4640
  v_mfma_f32_16x16x32_bf16 v[204:207], v[120:123], v[32:35], v[204:207]
  ds_read_b128 v[84:87], v2 offset:32768
  v_mfma_f32_16x16x32_bf16 v[204:207], v[116:119], v[24:27], v[204:207]
  ds_read_b64_tr_b16 v[128:129], v6 offset:16512
  v_mfma_f32_16x16x32_bf16 v[208:211], v[96:99], v[40:43], v[208:211]
  ds_read_b64_tr_b16 v[130:131], v6 offset:17024
  v_mfma_f32_16x16x32_bf16 v[208:211], v[108:111], v[48:51], v[208:211]
  ds_read_b128 v[28:31], v1 offset:32768
  v_mfma_f32_16x16x32_bf16 v[208:211], v[244:247], v[148:151], v[208:211]
  ds_read_b64_tr_b16 v[248:249], v6 offset:8256
  v_mfma_f32_16x16x32_bf16 v[208:211], v[252:255], v[52:55], v[208:211]
  ds_read_b64_tr_b16 v[250:251], v6 offset:8768
  v_mfma_f32_16x16x32_bf16 v[212:215], v[88:91], v[52:55], v[212:215]
  ds_read_b128 v[76:79], v2 offset:34816
  v_mfma_f32_16x16x32_bf16 v[212:215], v[100:103], v[148:151], v[212:215]
  ds_read_b64_tr_b16 v[44:45], v6 offset:20640
  v_mfma_f32_16x16x32_bf16 v[212:215], v[120:123], v[48:51], v[212:215]
  ds_read_b64_tr_b16 v[46:47], v6 offset:21152
  v_mfma_f32_16x16x32_bf16 v[212:215], v[116:119], v[40:43], v[212:215]
  ds_read_b128 v[124:127], v1 offset:34816
  v_mfma_f32_16x16x32_bf16 v[216:219], v[96:99], v[144:147], v[216:219]
  ds_read_b64_tr_b16 v[104:105], v7 offset:20640
  v_mfma_f32_16x16x32_bf16 v[216:219], v[108:111], v[56:59], v[216:219]
  ds_read_b64_tr_b16 v[106:107], v7 offset:21152
  v_mfma_f32_16x16x32_bf16 v[216:219], v[244:247], v[140:143], v[216:219]
  ds_read_b64_tr_b16 v[64:65], v7 offset:8256
  v_mfma_f32_16x16x32_bf16 v[216:219], v[252:255], v[60:63], v[216:219]
  ds_read_b64_tr_b16 v[66:67], v7 offset:8768
  v_mfma_f32_16x16x32_bf16 v[216:219], v[20:23], v[136:139], v[216:219]
  ds_read_b64_tr_b16 v[112:113], v7 offset:16512
  v_mfma_f32_16x16x32_bf16 v[216:219], v[36:39], v[80:83], v[216:219]
  ds_read_b64_tr_b16 v[114:115], v7 offset:17024
  v_mfma_f32_16x16x32_bf16 v[220:223], v[72:75], v[80:83], v[220:223]
  ds_read_b64_tr_b16 v[16:17], v7 offset:4128
  v_mfma_f32_16x16x32_bf16 v[220:223], v[92:95], v[136:139], v[220:223]
  ds_read_b64_tr_b16 v[18:19], v7 offset:4640
  v_mfma_f32_16x16x32_bf16 v[220:223], v[88:91], v[60:63], v[220:223]
  ds_read_b64_tr_b16 v[68:69], v6 offset:0
  v_mfma_f32_16x16x32_bf16 v[220:223], v[100:103], v[140:143], v[220:223]
  ds_read_b64_tr_b16 v[70:71], v6 offset:512
  v_mfma_f32_16x16x32_bf16 v[220:223], v[120:123], v[56:59], v[220:223]
  ds_read_b64_tr_b16 v[32:33], v6 offset:12384
  v_mfma_f32_16x16x32_bf16 v[220:223], v[116:119], v[144:147], v[220:223]
  ds_read_b64_tr_b16 v[34:35], v6 offset:12896
  s_waitcnt lgkmcnt(10)
  v_mfma_f32_16x16x32_bf16 v[152:155], v[132:135], v[84:87], v[152:155]
  ds_read_b128 v[24:27], v2 offset:36864
  v_mfma_f32_16x16x32_bf16 v[152:155], v[128:131], v[28:31], v[152:155]
  ds_read_b128 v[52:55], v1 offset:36864
  v_mfma_f32_16x16x32_bf16 v[152:155], v[248:251], v[76:79], v[152:155]
  ds_read_b64_tr_b16 v[148:149], v7 offset:12384
  v_mfma_f32_16x16x32_bf16 v[152:155], v[44:47], v[124:127], v[152:155]
  ds_read_b64_tr_b16 v[150:151], v7 offset:12896
  v_mfma_f32_16x16x32_bf16 v[156:159], v[104:107], v[124:127], v[156:159]
  ds_read_b64_tr_b16 v[48:49], v7 offset:0
  s_waitcnt lgkmcnt(10)
  v_mfma_f32_16x16x32_bf16 v[156:159], v[64:67], v[76:79], v[156:159]
  ds_read_b64_tr_b16 v[50:51], v7 offset:512
  v_mfma_f32_16x16x32_bf16 v[156:159], v[112:115], v[28:31], v[156:159]
  ds_read_b128 v[40:43], v2 offset:38912
  s_waitcnt lgkmcnt(10)
  v_mfma_f32_16x16x32_bf16 v[156:159], v[16:19], v[84:87], v[156:159]
  ds_read_b128 v[96:99], v1 offset:38912
  s_waitcnt lgkmcnt(10)
  v_mfma_f32_16x16x32_bf16 v[160:163], v[68:71], v[84:87], v[160:163]
  s_waitcnt lgkmcnt(8)
  v_mfma_f32_16x16x32_bf16 v[160:163], v[32:35], v[28:31], v[160:163]
  v_mfma_f32_16x16x32_bf16 v[160:163], v[132:135], v[76:79], v[160:163]
  v_mfma_f32_16x16x32_bf16 v[160:163], v[128:131], v[124:127], v[160:163]
  s_waitcnt lgkmcnt(6)
  v_mfma_f32_16x16x32_bf16 v[160:163], v[248:251], v[24:27], v[160:163]
  v_mfma_f32_16x16x32_bf16 v[160:163], v[44:47], v[52:55], v[160:163]
  v_mfma_f32_16x16x32_bf16 v[164:167], v[104:107], v[52:55], v[164:167]
  v_mfma_f32_16x16x32_bf16 v[164:167], v[64:67], v[24:27], v[164:167]
  v_mfma_f32_16x16x32_bf16 v[164:167], v[112:115], v[124:127], v[164:167]
  v_mfma_f32_16x16x32_bf16 v[164:167], v[16:19], v[76:79], v[164:167]
  s_waitcnt lgkmcnt(0)
  v_mfma_f32_16x16x32_bf16 v[164:167], v[148:151], v[28:31], v[164:167]
  v_mfma_f32_16x16x32_bf16 v[164:167], v[48:51], v[84:87], v[164:167]
  v_mfma_f32_16x16x32_bf16 v[168:171], v[68:71], v[76:79], v[168:171]
  s_barrier
  ds_read_b128 v[108:111], v2 offset:40960
  v_mfma_f32_16x16x32_bf16 v[168:171], v[32:35], v[124:127], v[168:171]
  ds_read_b128 v[244:247], v1 offset:40960
  v_mfma_f32_16x16x32_bf16 v[168:171], v[132:135], v[24:27], v[168:171]
  ds_read_b128 v[252:255], v2 offset:43008
  v_mfma_f32_16x16x32_bf16 v[168:171], v[128:131], v[52:55], v[168:171]
  ds_read_b128 v[20:23], v1 offset:43008
  v_mfma_f32_16x16x32_bf16 v[168:171], v[248:251], v[40:43], v[168:171]
  v_mfma_f32_16x16x32_bf16 v[168:171], v[44:47], v[96:99], v[168:171]
  v_mfma_f32_16x16x32_bf16 v[172:175], v[104:107], v[96:99], v[172:175]
  v_mfma_f32_16x16x32_bf16 v[172:175], v[64:67], v[40:43], v[172:175]
  v_mfma_f32_16x16x32_bf16 v[172:175], v[112:115], v[52:55], v[172:175]
  v_mfma_f32_16x16x32_bf16 v[172:175], v[16:19], v[24:27], v[172:175]
  v_mfma_f32_16x16x32_bf16 v[172:175], v[148:151], v[124:127], v[172:175]
  v_mfma_f32_16x16x32_bf16 v[172:175], v[48:51], v[76:79], v[172:175]
  v_mfma_f32_16x16x32_bf16 v[176:179], v[68:71], v[24:27], v[176:179]
  v_mfma_f32_16x16x32_bf16 v[176:179], v[32:35], v[52:55], v[176:179]
  v_mfma_f32_16x16x32_bf16 v[176:179], v[132:135], v[40:43], v[176:179]
  ds_read_b128 v[36:39], v2 offset:45056
  v_mfma_f32_16x16x32_bf16 v[176:179], v[128:131], v[96:99], v[176:179]
  ds_read_b128 v[72:75], v1 offset:45056
  s_waitcnt lgkmcnt(2)
  v_mfma_f32_16x16x32_bf16 v[176:179], v[248:251], v[108:111], v[176:179]
  v_mfma_f32_16x16x32_bf16 v[176:179], v[44:47], v[244:247], v[176:179]
  v_mfma_f32_16x16x32_bf16 v[180:183], v[104:107], v[244:247], v[180:183]
  v_mfma_f32_16x16x32_bf16 v[180:183], v[64:67], v[108:111], v[180:183]
  v_mfma_f32_16x16x32_bf16 v[180:183], v[112:115], v[96:99], v[180:183]
  v_mfma_f32_16x16x32_bf16 v[180:183], v[16:19], v[40:43], v[180:183]
  v_mfma_f32_16x16x32_bf16 v[180:183], v[148:151], v[52:55], v[180:183]
  v_mfma_f32_16x16x32_bf16 v[180:183], v[48:51], v[24:27], v[180:183]
  v_mfma_f32_16x16x32_bf16 v[184:187], v[68:71], v[40:43], v[184:187]
  v_mfma_f32_16x16x32_bf16 v[184:187], v[32:35], v[96:99], v[184:187]
  v_mfma_f32_16x16x32_bf16 v[184:187], v[132:135], v[108:111], v[184:187]
  ds_read_b128 v[80:83], v2 offset:47104
  v_mfma_f32_16x16x32_bf16 v[184:187], v[128:131], v[244:247], v[184:187]
  ds_read_b128 v[92:95], v1 offset:47104
  v_mfma_f32_16x16x32_bf16 v[184:187], v[248:251], v[252:255], v[184:187]
  v_mfma_f32_16x16x32_bf16 v[184:187], v[44:47], v[20:23], v[184:187]
  v_mfma_f32_16x16x32_bf16 v[188:191], v[104:107], v[20:23], v[188:191]
  v_mfma_f32_16x16x32_bf16 v[188:191], v[64:67], v[252:255], v[188:191]
  v_mfma_f32_16x16x32_bf16 v[188:191], v[112:115], v[244:247], v[188:191]
  v_mfma_f32_16x16x32_bf16 v[188:191], v[16:19], v[108:111], v[188:191]
  v_mfma_f32_16x16x32_bf16 v[188:191], v[148:151], v[96:99], v[188:191]
  v_mfma_f32_16x16x32_bf16 v[188:191], v[48:51], v[40:43], v[188:191]
  v_mfma_f32_16x16x32_bf16 v[192:195], v[68:71], v[108:111], v[192:195]
  v_mfma_f32_16x16x32_bf16 v[192:195], v[32:35], v[244:247], v[192:195]
  v_mfma_f32_16x16x32_bf16 v[192:195], v[132:135], v[252:255], v[192:195]
  v_mfma_f32_16x16x32_bf16 v[192:195], v[128:131], v[20:23], v[192:195]
  s_waitcnt lgkmcnt(0)
  v_mfma_f32_16x16x32_bf16 v[192:195], v[248:251], v[36:39], v[192:195]
  v_mfma_f32_16x16x32_bf16 v[192:195], v[44:47], v[72:75], v[192:195]
  v_mfma_f32_16x16x32_bf16 v[196:199], v[104:107], v[72:75], v[196:199]
  ds_read_b128 v[136:139], v3 offset:9728
  v_mfma_f32_16x16x32_bf16 v[196:199], v[64:67], v[36:39], v[196:199]
  ds_read_b128 v[88:91], v11 offset:9728
  v_mfma_f32_16x16x32_bf16 v[196:199], v[112:115], v[20:23], v[196:199]
  ds_read_b128 v[60:63], v4 offset:9728
  v_mfma_f32_16x16x32_bf16 v[196:199], v[16:19], v[252:255], v[196:199]
  ds_read_b128 v[100:103], v12 offset:9728
  v_mfma_f32_16x16x32_bf16 v[196:199], v[148:151], v[244:247], v[196:199]
  ds_read_b128 v[140:143], v5 offset:9728
  v_mfma_f32_16x16x32_bf16 v[196:199], v[48:51], v[108:111], v[196:199]
  ds_read_b128 v[120:123], v13 offset:9728
  v_mfma_f32_16x16x32_bf16 v[200:203], v[68:71], v[252:255], v[200:203]
  v_mfma_f32_16x16x32_bf16 v[200:203], v[32:35], v[20:23], v[200:203]
  v_mfma_f32_16x16x32_bf16 v[200:203], v[132:135], v[36:39], v[200:203]
  v_mfma_f32_16x16x32_bf16 v[200:203], v[128:131], v[72:75], v[200:203]
  v_mfma_f32_16x16x32_bf16 v[200:203], v[248:251], v[80:83], v[200:203]
  v_mfma_f32_16x16x32_bf16 v[200:203], v[44:47], v[92:95], v[200:203]
  v_mfma_f32_16x16x32_bf16 v[204:207], v[104:107], v[92:95], v[204:207]
  v_mfma_f32_16x16x32_bf16 v[204:207], v[64:67], v[80:83], v[204:207]
  v_mfma_f32_16x16x32_bf16 v[204:207], v[112:115], v[72:75], v[204:207]
  s_waitcnt lgkmcnt(0)
  s_barrier
  ds_read_b64_tr_b16 v[56:57], v6 offset:28896
  v_mfma_f32_16x16x32_bf16 v[204:207], v[16:19], v[36:39], v[204:207]
  ds_read_b64_tr_b16 v[58:59], v6 offset:29408
  v_mfma_f32_16x16x32_bf16 v[204:207], v[148:151], v[20:23], v[204:207]
  ds_read_b128 v[116:119], v2 offset:0
  v_mfma_f32_16x16x32_bf16 v[204:207], v[48:51], v[252:255], v[204:207]
  ds_read_b64_tr_b16 v[144:145], v6 offset:41280
  v_mfma_f32_16x16x32_bf16 v[208:211], v[68:71], v[36:39], v[208:211]
  ds_read_b64_tr_b16 v[146:147], v6 offset:41792
  v_mfma_f32_16x16x32_bf16 v[208:211], v[32:35], v[72:75], v[208:211]
  ds_read_b128 v[28:31], v1 offset:0
  v_mfma_f32_16x16x32_bf16 v[208:211], v[132:135], v[80:83], v[208:211]
  ds_read_b64_tr_b16 v[84:85], v6 offset:33024
  v_mfma_f32_16x16x32_bf16 v[208:211], v[128:131], v[92:95], v[208:211]
  ds_read_b64_tr_b16 v[86:87], v6 offset:33536
  v_mfma_f32_16x16x32_bf16 v[212:215], v[112:115], v[92:95], v[212:215]
  ds_read_b128 v[124:127], v2 offset:2048
  v_mfma_f32_16x16x32_bf16 v[212:215], v[16:19], v[80:83], v[212:215]
  ds_read_b64_tr_b16 v[76:77], v6 offset:45408
  v_mfma_f32_16x16x32_bf16 v[212:215], v[148:151], v[72:75], v[212:215]
  ds_read_b64_tr_b16 v[78:79], v6 offset:45920
  v_mfma_f32_16x16x32_bf16 v[212:215], v[48:51], v[36:39], v[212:215]
  ds_read_b128 v[52:55], v1 offset:2048
  v_mfma_f32_16x16x32_bf16 v[216:219], v[68:71], v[136:139], v[216:219]
  ds_read_b64_tr_b16 v[24:25], v7 offset:45408
  v_mfma_f32_16x16x32_bf16 v[216:219], v[32:35], v[88:91], v[216:219]
  ds_read_b64_tr_b16 v[26:27], v7 offset:45920
  v_mfma_f32_16x16x32_bf16 v[216:219], v[132:135], v[60:63], v[216:219]
  ds_read_b64_tr_b16 v[96:97], v7 offset:33024
  v_mfma_f32_16x16x32_bf16 v[216:219], v[128:131], v[100:103], v[216:219]
  ds_read_b64_tr_b16 v[98:99], v7 offset:33536
  v_mfma_f32_16x16x32_bf16 v[216:219], v[248:251], v[140:143], v[216:219]
  ds_read_b64_tr_b16 v[40:41], v7 offset:41280
  v_mfma_f32_16x16x32_bf16 v[216:219], v[44:47], v[120:123], v[216:219]
  ds_read_b64_tr_b16 v[42:43], v7 offset:41792
  v_mfma_f32_16x16x32_bf16 v[220:223], v[104:107], v[120:123], v[220:223]
  ds_read_b64_tr_b16 v[244:245], v7 offset:28896
  v_mfma_f32_16x16x32_bf16 v[220:223], v[64:67], v[140:143], v[220:223]
  ds_read_b64_tr_b16 v[246:247], v7 offset:29408
  v_mfma_f32_16x16x32_bf16 v[220:223], v[112:115], v[100:103], v[220:223]
  ds_read_b64_tr_b16 v[108:109], v6 offset:24768
  v_mfma_f32_16x16x32_bf16 v[220:223], v[16:19], v[60:63], v[220:223]
  ds_read_b64_tr_b16 v[110:111], v6 offset:25280
  v_mfma_f32_16x16x32_bf16 v[220:223], v[148:151], v[88:91], v[220:223]
  ds_read_b64_tr_b16 v[20:21], v6 offset:37152
  v_mfma_f32_16x16x32_bf16 v[220:223], v[48:51], v[136:139], v[220:223]
  ds_read_b64_tr_b16 v[22:23], v6 offset:37664
  s_waitcnt lgkmcnt(10)
  v_mfma_f32_16x16x32_bf16 v[152:155], v[56:59], v[116:119], v[152:155]
  ds_read_b128 v[252:255], v2 offset:4096
  v_mfma_f32_16x16x32_bf16 v[152:155], v[144:147], v[28:31], v[152:155]
  ds_read_b128 v[92:95], v1 offset:4096
  v_mfma_f32_16x16x32_bf16 v[152:155], v[84:87], v[124:127], v[152:155]
  ds_read_b64_tr_b16 v[80:81], v7 offset:37152
  v_mfma_f32_16x16x32_bf16 v[152:155], v[76:79], v[52:55], v[152:155]
  ds_read_b64_tr_b16 v[82:83], v7 offset:37664
  v_mfma_f32_16x16x32_bf16 v[156:159], v[24:27], v[52:55], v[156:159]
  ds_read_b64_tr_b16 v[72:73], v7 offset:24768
  s_waitcnt lgkmcnt(10)
  v_mfma_f32_16x16x32_bf16 v[156:159], v[96:99], v[124:127], v[156:159]
  ds_read_b64_tr_b16 v[74:75], v7 offset:25280
  v_mfma_f32_16x16x32_bf16 v[156:159], v[40:43], v[28:31], v[156:159]
  ds_read_b128 v[36:39], v2 offset:6144
  s_waitcnt lgkmcnt(10)
  v_mfma_f32_16x16x32_bf16 v[156:159], v[244:247], v[116:119], v[156:159]
  ds_read_b128 v[68:71], v1 offset:6144
  s_waitcnt lgkmcnt(10)
  v_mfma_f32_16x16x32_bf16 v[160:163], v[108:111], v[116:119], v[160:163]
  s_waitcnt lgkmcnt(8)
  v_mfma_f32_16x16x32_bf16 v[160:163], v[20:23], v[28:31], v[160:163]
  v_mfma_f32_16x16x32_bf16 v[160:163], v[56:59], v[124:127], v[160:163]
  v_mfma_f32_16x16x32_bf16 v[160:163], v[144:147], v[52:55], v[160:163]
  s_waitcnt lgkmcnt(6)
  v_mfma_f32_16x16x32_bf16 v[160:163], v[84:87], v[252:255], v[160:163]
  v_mfma_f32_16x16x32_bf16 v[160:163], v[76:79], v[92:95], v[160:163]
  v_mfma_f32_16x16x32_bf16 v[164:167], v[24:27], v[92:95], v[164:167]
  v_mfma_f32_16x16x32_bf16 v[164:167], v[96:99], v[252:255], v[164:167]
  v_mfma_f32_16x16x32_bf16 v[164:167], v[40:43], v[52:55], v[164:167]
  v_mfma_f32_16x16x32_bf16 v[164:167], v[244:247], v[124:127], v[164:167]
  s_waitcnt lgkmcnt(0)
  v_mfma_f32_16x16x32_bf16 v[164:167], v[80:83], v[28:31], v[164:167]
  v_mfma_f32_16x16x32_bf16 v[164:167], v[72:75], v[116:119], v[164:167]
  v_mfma_f32_16x16x32_bf16 v[168:171], v[108:111], v[124:127], v[168:171]
  s_barrier
  ds_read_b128 v[32:35], v2 offset:8192
  v_mfma_f32_16x16x32_bf16 v[168:171], v[20:23], v[52:55], v[168:171]
  ds_read_b128 v[132:135], v1 offset:8192
  v_mfma_f32_16x16x32_bf16 v[168:171], v[56:59], v[252:255], v[168:171]
  ds_read_b128 v[128:131], v2 offset:10240
  v_mfma_f32_16x16x32_bf16 v[168:171], v[144:147], v[92:95], v[168:171]
  ds_read_b128 v[248:251], v1 offset:10240
  v_mfma_f32_16x16x32_bf16 v[168:171], v[84:87], v[36:39], v[168:171]
  v_mfma_f32_16x16x32_bf16 v[168:171], v[76:79], v[68:71], v[168:171]
  v_mfma_f32_16x16x32_bf16 v[172:175], v[24:27], v[68:71], v[172:175]
  v_mfma_f32_16x16x32_bf16 v[172:175], v[96:99], v[36:39], v[172:175]
  v_mfma_f32_16x16x32_bf16 v[172:175], v[40:43], v[92:95], v[172:175]
  v_mfma_f32_16x16x32_bf16 v[172:175], v[244:247], v[252:255], v[172:175]
  v_mfma_f32_16x16x32_bf16 v[172:175], v[80:83], v[52:55], v[172:175]
  v_mfma_f32_16x16x32_bf16 v[172:175], v[72:75], v[124:127], v[172:175]
  v_mfma_f32_16x16x32_bf16 v[176:179], v[108:111], v[252:255], v[176:179]
  v_mfma_f32_16x16x32_bf16 v[176:179], v[20:23], v[92:95], v[176:179]
  v_mfma_f32_16x16x32_bf16 v[176:179], v[56:59], v[36:39], v[176:179]
  ds_read_b128 v[44:47], v2 offset:12288
  v_mfma_f32_16x16x32_bf16 v[176:179], v[144:147], v[68:71], v[176:179]
  ds_read_b128 v[104:107], v1 offset:12288
  s_waitcnt lgkmcnt(2)
  v_mfma_f32_16x16x32_bf16 v[176:179], v[84:87], v[32:35], v[176:179]
  v_mfma_f32_16x16x32_bf16 v[176:179], v[76:79], v[132:135], v[176:179]
  v_mfma_f32_16x16x32_bf16 v[180:183], v[24:27], v[132:135], v[180:183]
  v_mfma_f32_16x16x32_bf16 v[180:183], v[96:99], v[32:35], v[180:183]
  v_mfma_f32_16x16x32_bf16 v[180:183], v[40:43], v[68:71], v[180:183]
  v_mfma_f32_16x16x32_bf16 v[180:183], v[244:247], v[36:39], v[180:183]
  v_mfma_f32_16x16x32_bf16 v[180:183], v[80:83], v[92:95], v[180:183]
  v_mfma_f32_16x16x32_bf16 v[180:183], v[72:75], v[252:255], v[180:183]
  v_mfma_f32_16x16x32_bf16 v[184:187], v[108:111], v[36:39], v[184:187]
  v_mfma_f32_16x16x32_bf16 v[184:187], v[20:23], v[68:71], v[184:187]
  v_mfma_f32_16x16x32_bf16 v[184:187], v[56:59], v[32:35], v[184:187]
  ds_read_b128 v[120:123], v2 offset:14336
  v_mfma_f32_16x16x32_bf16 v[184:187], v[144:147], v[132:135], v[184:187]
  ds_read_b128 v[64:67], v1 offset:14336
  v_mfma_f32_16x16x32_bf16 v[184:187], v[84:87], v[128:131], v[184:187]
  v_mfma_f32_16x16x32_bf16 v[184:187], v[76:79], v[248:251], v[184:187]
  v_mfma_f32_16x16x32_bf16 v[188:191], v[24:27], v[248:251], v[188:191]
  v_mfma_f32_16x16x32_bf16 v[188:191], v[96:99], v[128:131], v[188:191]
  v_mfma_f32_16x16x32_bf16 v[188:191], v[40:43], v[132:135], v[188:191]
  v_mfma_f32_16x16x32_bf16 v[188:191], v[244:247], v[32:35], v[188:191]
  v_mfma_f32_16x16x32_bf16 v[188:191], v[80:83], v[68:71], v[188:191]
  v_mfma_f32_16x16x32_bf16 v[188:191], v[72:75], v[36:39], v[188:191]
  v_mfma_f32_16x16x32_bf16 v[192:195], v[108:111], v[32:35], v[192:195]
  v_mfma_f32_16x16x32_bf16 v[192:195], v[20:23], v[132:135], v[192:195]
  v_mfma_f32_16x16x32_bf16 v[192:195], v[56:59], v[128:131], v[192:195]
  v_mfma_f32_16x16x32_bf16 v[192:195], v[144:147], v[248:251], v[192:195]
  s_waitcnt lgkmcnt(0)
  v_mfma_f32_16x16x32_bf16 v[192:195], v[84:87], v[44:47], v[192:195]
  v_mfma_f32_16x16x32_bf16 v[192:195], v[76:79], v[104:107], v[192:195]
  v_mfma_f32_16x16x32_bf16 v[196:199], v[24:27], v[104:107], v[196:199]
  ds_read_b128 v[140:143], v3 offset:0
  v_mfma_f32_16x16x32_bf16 v[196:199], v[96:99], v[44:47], v[196:199]
  ds_read_b128 v[112:115], v11 offset:0
  v_mfma_f32_16x16x32_bf16 v[196:199], v[40:43], v[248:251], v[196:199]
  ds_read_b128 v[100:103], v4 offset:0
  v_mfma_f32_16x16x32_bf16 v[196:199], v[244:247], v[128:131], v[196:199]
  ds_read_b128 v[16:19], v12 offset:0
  v_mfma_f32_16x16x32_bf16 v[196:199], v[80:83], v[132:135], v[196:199]
  ds_read_b128 v[60:63], v5 offset:0
  v_mfma_f32_16x16x32_bf16 v[196:199], v[72:75], v[32:35], v[196:199]
  ds_read_b128 v[148:151], v13 offset:0
  v_mfma_f32_16x16x32_bf16 v[200:203], v[108:111], v[128:131], v[200:203]
  v_mfma_f32_16x16x32_bf16 v[200:203], v[20:23], v[248:251], v[200:203]
  v_mfma_f32_16x16x32_bf16 v[200:203], v[56:59], v[44:47], v[200:203]
  v_mfma_f32_16x16x32_bf16 v[200:203], v[144:147], v[104:107], v[200:203]
  v_mfma_f32_16x16x32_bf16 v[200:203], v[84:87], v[120:123], v[200:203]
  v_mfma_f32_16x16x32_bf16 v[200:203], v[76:79], v[64:67], v[200:203]
  v_mfma_f32_16x16x32_bf16 v[204:207], v[24:27], v[64:67], v[204:207]
  v_mfma_f32_16x16x32_bf16 v[204:207], v[96:99], v[120:123], v[204:207]
  v_mfma_f32_16x16x32_bf16 v[204:207], v[40:43], v[104:107], v[204:207]
  s_waitcnt lgkmcnt(0)
  s_barrier
  ds_read_b64_tr_b16 v[88:89], v6 offset:4128
  v_mfma_f32_16x16x32_bf16 v[204:207], v[244:247], v[44:47], v[204:207]
  ds_read_b64_tr_b16 v[90:91], v6 offset:4640
  v_mfma_f32_16x16x32_bf16 v[204:207], v[80:83], v[248:251], v[204:207]
  ds_read_b128 v[48:51], v2 offset:16384
  v_mfma_f32_16x16x32_bf16 v[204:207], v[72:75], v[128:131], v[204:207]
  ds_read_b64_tr_b16 v[136:137], v6 offset:16512
  v_mfma_f32_16x16x32_bf16 v[208:211], v[108:111], v[44:47], v[208:211]
  ds_read_b64_tr_b16 v[138:139], v6 offset:17024
  v_mfma_f32_16x16x32_bf16 v[208:211], v[20:23], v[104:107], v[208:211]
  ds_read_b128 v[28:31], v1 offset:16384
  v_mfma_f32_16x16x32_bf16 v[208:211], v[56:59], v[120:123], v[208:211]
  ds_read_b64_tr_b16 v[116:117], v6 offset:8256
  v_mfma_f32_16x16x32_bf16 v[208:211], v[144:147], v[64:67], v[208:211]
  ds_read_b64_tr_b16 v[118:119], v6 offset:8768
  v_mfma_f32_16x16x32_bf16 v[212:215], v[40:43], v[64:67], v[212:215]
  ds_read_b128 v[52:55], v2 offset:18432
  v_mfma_f32_16x16x32_bf16 v[212:215], v[244:247], v[120:123], v[212:215]
  ds_read_b64_tr_b16 v[124:125], v6 offset:20640
  v_mfma_f32_16x16x32_bf16 v[212:215], v[80:83], v[104:107], v[212:215]
  ds_read_b64_tr_b16 v[126:127], v6 offset:21152
  v_mfma_f32_16x16x32_bf16 v[212:215], v[72:75], v[44:47], v[212:215]
  ds_read_b128 v[92:95], v1 offset:18432
  v_mfma_f32_16x16x32_bf16 v[216:219], v[108:111], v[140:143], v[216:219]
  ds_read_b64_tr_b16 v[252:253], v7 offset:20640
  v_mfma_f32_16x16x32_bf16 v[216:219], v[20:23], v[112:115], v[216:219]
  ds_read_b64_tr_b16 v[254:255], v7 offset:21152
  v_mfma_f32_16x16x32_bf16 v[216:219], v[56:59], v[100:103], v[216:219]
  ds_read_b64_tr_b16 v[68:69], v7 offset:8256
  v_mfma_f32_16x16x32_bf16 v[216:219], v[144:147], v[16:19], v[216:219]
  ds_read_b64_tr_b16 v[70:71], v7 offset:8768
  v_mfma_f32_16x16x32_bf16 v[216:219], v[84:87], v[60:63], v[216:219]
  ds_read_b64_tr_b16 v[36:37], v7 offset:16512
  v_mfma_f32_16x16x32_bf16 v[216:219], v[76:79], v[148:151], v[216:219]
  ds_read_b64_tr_b16 v[38:39], v7 offset:17024
  v_mfma_f32_16x16x32_bf16 v[220:223], v[24:27], v[148:151], v[220:223]
  ds_read_b64_tr_b16 v[132:133], v7 offset:4128
  v_mfma_f32_16x16x32_bf16 v[220:223], v[96:99], v[60:63], v[220:223]
  ds_read_b64_tr_b16 v[134:135], v7 offset:4640
  v_mfma_f32_16x16x32_bf16 v[220:223], v[40:43], v[16:19], v[220:223]
  ds_read_b64_tr_b16 v[32:33], v6 offset:0
  v_mfma_f32_16x16x32_bf16 v[220:223], v[244:247], v[100:103], v[220:223]
  ds_read_b64_tr_b16 v[34:35], v6 offset:512
  v_mfma_f32_16x16x32_bf16 v[220:223], v[80:83], v[112:115], v[220:223]
  ds_read_b64_tr_b16 v[248:249], v6 offset:12384
  v_mfma_f32_16x16x32_bf16 v[220:223], v[72:75], v[140:143], v[220:223]
  ds_read_b64_tr_b16 v[250:251], v6 offset:12896
L_t_pu_1:
  s_cbranch_scc1 L_r_pu_1
  s_waitcnt lgkmcnt(10)
  v_mfma_f32_16x16x32_bf16 v[152:155], v[88:91], v[48:51], v[152:155]
  ds_read_b128 v[128:131], v2 offset:20480
  v_mfma_f32_16x16x32_bf16 v[152:155], v[136:139], v[28:31], v[152:155]
  ds_read_b128 v[64:67], v1 offset:20480
  v_mfma_f32_16x16x32_bf16 v[152:155], v[116:119], v[52:55], v[152:155]
  ds_read_b64_tr_b16 v[120:121], v7 offset:12384
  v_mfma_f32_16x16x32_bf16 v[152:155], v[124:127], v[92:95], v[152:155]
  ds_read_b64_tr_b16 v[122:123], v7 offset:12896
  v_mfma_f32_16x16x32_bf16 v[156:159], v[252:255], v[92:95], v[156:159]
  ds_read_b64_tr_b16 v[104:105], v7 offset:0
  s_waitcnt lgkmcnt(10)
  v_mfma_f32_16x16x32_bf16 v[156:159], v[68:71], v[52:55], v[156:159]
  ds_read_b64_tr_b16 v[106:107], v7 offset:512
  v_mfma_f32_16x16x32_bf16 v[156:159], v[36:39], v[28:31], v[156:159]
  ds_read_b128 v[44:47], v2 offset:22528
  s_waitcnt lgkmcnt(10)
  v_mfma_f32_16x16x32_bf16 v[156:159], v[132:135], v[48:51], v[156:159]
  ds_read_b128 v[108:111], v1 offset:22528
  s_waitcnt lgkmcnt(10)
  v_mfma_f32_16x16x32_bf16 v[160:163], v[32:35], v[48:51], v[160:163]
  s_waitcnt lgkmcnt(8)
  v_mfma_f32_16x16x32_bf16 v[160:163], v[248:251], v[28:31], v[160:163]
  v_mfma_f32_16x16x32_bf16 v[160:163], v[88:91], v[52:55], v[160:163]
  v_mfma_f32_16x16x32_bf16 v[160:163], v[136:139], v[92:95], v[160:163]
  s_waitcnt lgkmcnt(6)
  v_mfma_f32_16x16x32_bf16 v[160:163], v[116:119], v[128:131], v[160:163]
  v_mfma_f32_16x16x32_bf16 v[160:163], v[124:127], v[64:67], v[160:163]
  v_mfma_f32_16x16x32_bf16 v[164:167], v[252:255], v[64:67], v[164:167]
  v_mfma_f32_16x16x32_bf16 v[164:167], v[68:71], v[128:131], v[164:167]
  v_mfma_f32_16x16x32_bf16 v[164:167], v[36:39], v[92:95], v[164:167]
  v_mfma_f32_16x16x32_bf16 v[164:167], v[132:135], v[52:55], v[164:167]
  s_waitcnt lgkmcnt(0)
  v_mfma_f32_16x16x32_bf16 v[164:167], v[120:123], v[28:31], v[164:167]
  v_mfma_f32_16x16x32_bf16 v[164:167], v[104:107], v[48:51], v[164:167]
  v_mfma_f32_16x16x32_bf16 v[168:171], v[32:35], v[52:55], v[168:171]
  s_barrier
  ds_read_b128 v[20:23], v2 offset:24576
  v_mfma_f32_16x16x32_bf16 v[168:171], v[248:251], v[92:95], v[168:171]
  ds_read_b128 v[56:59], v1 offset:24576
  v_mfma_f32_16x16x32_bf16 v[168:171], v[88:91], v[128:131], v[168:171]
  ds_read_b128 v[144:147], v2 offset:26624
  v_mfma_f32_16x16x32_bf16 v[168:171], v[136:139], v[64:67], v[168:171]
  ds_read_b128 v[84:87], v1 offset:26624
  v_mfma_f32_16x16x32_bf16 v[168:171], v[116:119], v[44:47], v[168:171]
  v_mfma_f32_16x16x32_bf16 v[168:171], v[124:127], v[108:111], v[168:171]
  v_mfma_f32_16x16x32_bf16 v[172:175], v[252:255], v[108:111], v[172:175]
  v_mfma_f32_16x16x32_bf16 v[172:175], v[68:71], v[44:47], v[172:175]
  v_mfma_f32_16x16x32_bf16 v[172:175], v[36:39], v[64:67], v[172:175]
  v_mfma_f32_16x16x32_bf16 v[172:175], v[132:135], v[128:131], v[172:175]
  v_mfma_f32_16x16x32_bf16 v[172:175], v[120:123], v[92:95], v[172:175]
  v_mfma_f32_16x16x32_bf16 v[172:175], v[104:107], v[52:55], v[172:175]
  v_mfma_f32_16x16x32_bf16 v[176:179], v[32:35], v[128:131], v[176:179]
  v_mfma_f32_16x16x32_bf16 v[176:179], v[248:251], v[64:67], v[176:179]
  v_mfma_f32_16x16x32_bf16 v[176:179], v[88:91], v[44:47], v[176:179]
  ds_read_b128 v[76:79], v2 offset:28672
  v_mfma_f32_16x16x32_bf16 v[176:179], v[136:139], v[108:111], v[176:179]
  ds_read_b128 v[24:27], v1 offset:28672
  s_waitcnt lgkmcnt(2)
  v_mfma_f32_16x16x32_bf16 v[176:179], v[116:119], v[20:23], v[176:179]
  v_mfma_f32_16x16x32_bf16 v[176:179], v[124:127], v[56:59], v[176:179]
  v_mfma_f32_16x16x32_bf16 v[180:183], v[252:255], v[56:59], v[180:183]
  v_mfma_f32_16x16x32_bf16 v[180:183], v[68:71], v[20:23], v[180:183]
  v_mfma_f32_16x16x32_bf16 v[180:183], v[36:39], v[108:111], v[180:183]
  v_mfma_f32_16x16x32_bf16 v[180:183], v[132:135], v[44:47], v[180:183]
  v_mfma_f32_16x16x32_bf16 v[180:183], v[120:123], v[64:67], v[180:183]
  v_mfma_f32_16x16x32_bf16 v[180:183], v[104:107], v[128:131], v[180:183]
  v_mfma_f32_16x16x32_bf16 v[184:187], v[32:35], v[44:47], v[184:187]
  v_mfma_f32_16x16x32_bf16 v[184:187], v[248:251], v[108:111], v[184:187]
  v_mfma_f32_16x16x32_bf16 v[184:187], v[88:91], v[20:23], v[184:187]
  ds_read_b128 v[148:151], v2 offset:30720
  v_mfma_f32_16x16x32_bf16 v[184:187], v[136:139], v[56:59], v[184:187]
  ds_read_b128 v[96:99], v1 offset:30720
  v_mfma_f32_16x16x32_bf16 v[184:187], v[116:119], v[144:147], v[184:187]
  v_mfma_f32_16x16x32_bf16 v[184:187], v[124:127], v[84:87], v[184:187]
  v_mfma_f32_16x16x32_bf16 v[188:191], v[252:255], v[84:87], v[188:191]
  v_mfma_f32_16x16x32_bf16 v[188:191], v[68:71], v[144:147], v[188:191]
  v_mfma_f32_16x16x32_bf16 v[188:191], v[36:39], v[56:59], v[188:191]
  v_mfma_f32_16x16x32_bf16 v[188:191], v[132:135], v[20:23], v[188:191]
  v_mfma_f32_16x16x32_bf16 v[188:191], v[120:123], v[108:111], v[188:191]
  v_mfma_f32_16x16x32_bf16 v[188:191], v[104:107], v[44:47], v[188:191]
  v_mfma_f32_16x16x32_bf16 v[192:195], v[32:35], v[20:23], v[192:195]
  v_mfma_f32_16x16x32_bf16 v[192:195], v[248:251], v[56:59], v[192:195]
  v_mfma_f32_16x16x32_bf16 v[192:195], v[88:91], v[144:147], v[192:195]
  v_mfma_f32_16x16x32_bf16 v[192:195], v[136:139], v[84:87], v[192:195]
  s_waitcnt lgkmcnt(0)
  v_mfma_f32_16x16x32_bf16 v[192:195], v[116:119], v[76:79], v[192:195]
  v_mfma_f32_16x16x32_bf16 v[192:195], v[124:127], v[24:27], v[192:195]
  v_mfma_f32_16x16x32_bf16 v[196:199], v[252:255], v[24:27], v[196:199]
  ds_read_b128 v[60:63], v3 offset:4864
  v_mfma_f32_16x16x32_bf16 v[196:199], v[68:71], v[76:79], v[196:199]
  ds_read_b128 v[40:43], v11 offset:4864
  v_mfma_f32_16x16x32_bf16 v[196:199], v[36:39], v[84:87], v[196:199]
  ds_read_b128 v[16:19], v4 offset:4864
  v_mfma_f32_16x16x32_bf16 v[196:199], v[132:135], v[144:147], v[196:199]
  ds_read_b128 v[244:247], v12 offset:4864
  v_mfma_f32_16x16x32_bf16 v[196:199], v[120:123], v[56:59], v[196:199]
  ds_read_b128 v[100:103], v5 offset:4864
  v_mfma_f32_16x16x32_bf16 v[196:199], v[104:107], v[20:23], v[196:199]
  ds_read_b128 v[80:83], v13 offset:4864
  v_mfma_f32_16x16x32_bf16 v[200:203], v[32:35], v[144:147], v[200:203]
  v_mfma_f32_16x16x32_bf16 v[200:203], v[248:251], v[84:87], v[200:203]
  v_mfma_f32_16x16x32_bf16 v[200:203], v[88:91], v[76:79], v[200:203]
  v_mfma_f32_16x16x32_bf16 v[200:203], v[136:139], v[24:27], v[200:203]
  v_mfma_f32_16x16x32_bf16 v[200:203], v[116:119], v[148:151], v[200:203]
  v_mfma_f32_16x16x32_bf16 v[200:203], v[124:127], v[96:99], v[200:203]
  v_mfma_f32_16x16x32_bf16 v[204:207], v[252:255], v[96:99], v[204:207]
  v_mfma_f32_16x16x32_bf16 v[204:207], v[68:71], v[148:151], v[204:207]
  v_mfma_f32_16x16x32_bf16 v[204:207], v[36:39], v[24:27], v[204:207]
  s_waitcnt lgkmcnt(0)
  s_barrier
  ds_read_b64_tr_b16 v[112:113], v6 offset:28896
  v_mfma_f32_16x16x32_bf16 v[204:207], v[132:135], v[76:79], v[204:207]
  ds_read_b64_tr_b16 v[114:115], v6 offset:29408
  v_mfma_f32_16x16x32_bf16 v[204:207], v[120:123], v[84:87], v[204:207]
  ds_read_b128 v[72:75], v2 offset:32768
  v_mfma_f32_16x16x32_bf16 v[204:207], v[104:107], v[144:147], v[204:207]
  ds_read_b64_tr_b16 v[140:141], v6 offset:41280
  v_mfma_f32_16x16x32_bf16 v[208:211], v[32:35], v[76:79], v[208:211]
  ds_read_b64_tr_b16 v[142:143], v6 offset:41792
  v_mfma_f32_16x16x32_bf16 v[208:211], v[248:251], v[24:27], v[208:211]
  ds_read_b128 v[28:31], v1 offset:32768
  v_mfma_f32_16x16x32_bf16 v[208:211], v[88:91], v[148:151], v[208:211]
  ds_read_b64_tr_b16 v[48:49], v6 offset:33024
  v_mfma_f32_16x16x32_bf16 v[208:211], v[136:139], v[96:99], v[208:211]
  ds_read_b64_tr_b16 v[50:51], v6 offset:33536
  v_mfma_f32_16x16x32_bf16 v[212:215], v[36:39], v[96:99], v[212:215]
  ds_read_b128 v[92:95], v2 offset:34816
  v_mfma_f32_16x16x32_bf16 v[212:215], v[132:135], v[148:151], v[212:215]
  ds_read_b64_tr_b16 v[52:53], v6 offset:45408
  v_mfma_f32_16x16x32_bf16 v[212:215], v[120:123], v[24:27], v[212:215]
  ds_read_b64_tr_b16 v[54:55], v6 offset:45920
  v_mfma_f32_16x16x32_bf16 v[212:215], v[104:107], v[76:79], v[212:215]
  ds_read_b128 v[64:67], v1 offset:34816
  v_mfma_f32_16x16x32_bf16 v[216:219], v[32:35], v[60:63], v[216:219]
  ds_read_b64_tr_b16 v[128:129], v7 offset:45408
  v_mfma_f32_16x16x32_bf16 v[216:219], v[248:251], v[40:43], v[216:219]
  ds_read_b64_tr_b16 v[130:131], v7 offset:45920
  v_mfma_f32_16x16x32_bf16 v[216:219], v[88:91], v[16:19], v[216:219]
  ds_read_b64_tr_b16 v[108:109], v7 offset:33024
  v_mfma_f32_16x16x32_bf16 v[216:219], v[136:139], v[244:247], v[216:219]
  ds_read_b64_tr_b16 v[110:111], v7 offset:33536
  v_mfma_f32_16x16x32_bf16 v[216:219], v[116:119], v[100:103], v[216:219]
  ds_read_b64_tr_b16 v[44:45], v7 offset:41280
  v_mfma_f32_16x16x32_bf16 v[216:219], v[124:127], v[80:83], v[216:219]
  ds_read_b64_tr_b16 v[46:47], v7 offset:41792
  v_mfma_f32_16x16x32_bf16 v[220:223], v[252:255], v[80:83], v[220:223]
  ds_read_b64_tr_b16 v[56:57], v7 offset:28896
  v_mfma_f32_16x16x32_bf16 v[220:223], v[68:71], v[100:103], v[220:223]
  ds_read_b64_tr_b16 v[58:59], v7 offset:29408
  v_mfma_f32_16x16x32_bf16 v[220:223], v[36:39], v[244:247], v[220:223]
  ds_read_b64_tr_b16 v[20:21], v6 offset:24768
  v_mfma_f32_16x16x32_bf16 v[220:223], v[132:135], v[16:19], v[220:223]
  ds_read_b64_tr_b16 v[22:23], v6 offset:25280
  v_mfma_f32_16x16x32_bf16 v[220:223], v[120:123], v[40:43], v[220:223]
  ds_read_b64_tr_b16 v[84:85], v6 offset:37152
  v_mfma_f32_16x16x32_bf16 v[220:223], v[104:107], v[60:63], v[220:223]
  ds_read_b64_tr_b16 v[86:87], v6 offset:37664
  s_waitcnt lgkmcnt(10)
  v_mfma_f32_16x16x32_bf16 v[152:155], v[112:115], v[72:75], v[152:155]
  ds_read_b128 v[144:147], v2 offset:36864
  v_mfma_f32_16x16x32_bf16 v[152:155], v[140:143], v[28:31], v[152:155]
  ds_read_b128 v[96:99], v1 offset:36864
  v_mfma_f32_16x16x32_bf16 v[152:155], v[48:51], v[92:95], v[152:155]
  ds_read_b64_tr_b16 v[148:149], v7 offset:37152
  v_mfma_f32_16x16x32_bf16 v[152:155], v[52:55], v[64:67], v[152:155]
  ds_read_b64_tr_b16 v[150:151], v7 offset:37664
  v_mfma_f32_16x16x32_bf16 v[156:159], v[128:131], v[64:67], v[156:159]
  ds_read_b64_tr_b16 v[24:25], v7 offset:24768
  s_waitcnt lgkmcnt(10)
  v_mfma_f32_16x16x32_bf16 v[156:159], v[108:111], v[92:95], v[156:159]
  ds_read_b64_tr_b16 v[26:27], v7 offset:25280
  v_mfma_f32_16x16x32_bf16 v[156:159], v[44:47], v[28:31], v[156:159]
  ds_read_b128 v[76:79], v2 offset:38912
  s_waitcnt lgkmcnt(10)
  v_mfma_f32_16x16x32_bf16 v[156:159], v[56:59], v[72:75], v[156:159]
  ds_read_b128 v[32:35], v1 offset:38912
  s_waitcnt lgkmcnt(10)
  v_mfma_f32_16x16x32_bf16 v[160:163], v[20:23], v[72:75], v[160:163]
  s_waitcnt lgkmcnt(8)
  v_mfma_f32_16x16x32_bf16 v[160:163], v[84:87], v[28:31], v[160:163]
  v_mfma_f32_16x16x32_bf16 v[160:163], v[112:115], v[92:95], v[160:163]
  v_mfma_f32_16x16x32_bf16 v[160:163], v[140:143], v[64:67], v[160:163]
  s_waitcnt lgkmcnt(6)
  v_mfma_f32_16x16x32_bf16 v[160:163], v[48:51], v[144:147], v[160:163]
  v_mfma_f32_16x16x32_bf16 v[160:163], v[52:55], v[96:99], v[160:163]
  v_mfma_f32_16x16x32_bf16 v[164:167], v[128:131], v[96:99], v[164:167]
  v_mfma_f32_16x16x32_bf16 v[164:167], v[108:111], v[144:147], v[164:167]
  v_mfma_f32_16x16x32_bf16 v[164:167], v[44:47], v[64:67], v[164:167]
  v_mfma_f32_16x16x32_bf16 v[164:167], v[56:59], v[92:95], v[164:167]
  s_waitcnt lgkmcnt(0)
  v_mfma_f32_16x16x32_bf16 v[164:167], v[148:151], v[28:31], v[164:167]
  v_mfma_f32_16x16x32_bf16 v[164:167], v[24:27], v[72:75], v[164:167]
  v_mfma_f32_16x16x32_bf16 v[168:171], v[20:23], v[92:95], v[168:171]
  s_barrier
  ds_read_b128 v[248:251], v2 offset:40960
  v_mfma_f32_16x16x32_bf16 v[168:171], v[84:87], v[64:67], v[168:171]
  ds_read_b128 v[88:91], v1 offset:40960
  v_mfma_f32_16x16x32_bf16 v[168:171], v[112:115], v[144:147], v[168:171]
  ds_read_b128 v[136:139], v2 offset:43008
  v_mfma_f32_16x16x32_bf16 v[168:171], v[140:143], v[96:99], v[168:171]
  ds_read_b128 v[116:119], v1 offset:43008
  v_mfma_f32_16x16x32_bf16 v[168:171], v[48:51], v[76:79], v[168:171]
  v_mfma_f32_16x16x32_bf16 v[168:171], v[52:55], v[32:35], v[168:171]
  v_mfma_f32_16x16x32_bf16 v[172:175], v[128:131], v[32:35], v[172:175]
  v_mfma_f32_16x16x32_bf16 v[172:175], v[108:111], v[76:79], v[172:175]
  v_mfma_f32_16x16x32_bf16 v[172:175], v[44:47], v[96:99], v[172:175]
  v_mfma_f32_16x16x32_bf16 v[172:175], v[56:59], v[144:147], v[172:175]
  v_mfma_f32_16x16x32_bf16 v[172:175], v[148:151], v[64:67], v[172:175]
  v_mfma_f32_16x16x32_bf16 v[172:175], v[24:27], v[92:95], v[172:175]
  v_mfma_f32_16x16x32_bf16 v[176:179], v[20:23], v[144:147], v[176:179]
  v_mfma_f32_16x16x32_bf16 v[176:179], v[84:87], v[96:99], v[176:179]
  v_mfma_f32_16x16x32_bf16 v[176:179], v[112:115], v[76:79], v[176:179]
  ds_read_b128 v[124:127], v2 offset:45056
  v_mfma_f32_16x16x32_bf16 v[176:179], v[140:143], v[32:35], v[176:179]
  ds_read_b128 v[252:255], v1 offset:45056
  s_waitcnt lgkmcnt(2)
  v_mfma_f32_16x16x32_bf16 v[176:179], v[48:51], v[248:251], v[176:179]
  v_mfma_f32_16x16x32_bf16 v[176:179], v[52:55], v[88:91], v[176:179]
  v_mfma_f32_16x16x32_bf16 v[180:183], v[128:131], v[88:91], v[180:183]
  v_mfma_f32_16x16x32_bf16 v[180:183], v[108:111], v[248:251], v[180:183]
  v_mfma_f32_16x16x32_bf16 v[180:183], v[44:47], v[32:35], v[180:183]
  v_mfma_f32_16x16x32_bf16 v[180:183], v[56:59], v[76:79], v[180:183]
  v_mfma_f32_16x16x32_bf16 v[180:183], v[148:151], v[96:99], v[180:183]
  v_mfma_f32_16x16x32_bf16 v[180:183], v[24:27], v[144:147], v[180:183]
  v_mfma_f32_16x16x32_bf16 v[184:187], v[20:23], v[76:79], v[184:187]
  v_mfma_f32_16x16x32_bf16 v[184:187], v[84:87], v[32:35], v[184:187]
  v_mfma_f32_16x16x32_bf16 v[184:187], v[112:115], v[248:251], v[184:187]
  ds_read_b128 v[80:83], v2 offset:47104
  v_mfma_f32_16x16x32_bf16 v[184:187], v[140:143], v[88:91], v[184:187]
  ds_read_b128 v[68:71], v1 offset:47104
  v_mfma_f32_16x16x32_bf16 v[184:187], v[48:51], v[136:139], v[184:187]
  v_mfma_f32_16x16x32_bf16 v[184:187], v[52:55], v[116:119], v[184:187]
  v_mfma_f32_16x16x32_bf16 v[188:191], v[128:131], v[116:119], v[188:191]
  v_mfma_f32_16x16x32_bf16 v[188:191], v[108:111], v[136:139], v[188:191]
  v_mfma_f32_16x16x32_bf16 v[188:191], v[44:47], v[88:91], v[188:191]
  v_mfma_f32_16x16x32_bf16 v[188:191], v[56:59], v[248:251], v[188:191]
  v_mfma_f32_16x16x32_bf16 v[188:191], v[148:151], v[32:35], v[188:191]
  v_mfma_f32_16x16x32_bf16 v[188:191], v[24:27], v[76:79], v[188:191]
  v_mfma_f32_16x16x32_bf16 v[192:195], v[20:23], v[248:251], v[192:195]
  v_mfma_f32_16x16x32_bf16 v[192:195], v[84:87], v[88:91], v[192:195]
  v_mfma_f32_16x16x32_bf16 v[192:195], v[112:115], v[136:139], v[192:195]
  v_mfma_f32_16x16x32_bf16 v[192:195], v[140:143], v[116:119], v[192:195]
  s_waitcnt lgkmcnt(0)
  v_mfma_f32_16x16x32_bf16 v[192:195], v[48:51], v[124:127], v[192:195]
  v_mfma_f32_16x16x32_bf16 v[192:195], v[52:55], v[252:255], v[192:195]
  v_mfma_f32_16x16x32_bf16 v[196:199], v[128:131], v[252:255], v[196:199]
  ds_read_b128 v[100:103], v3 offset:9728
  v_mfma_f32_16x16x32_bf16 v[196:199], v[108:111], v[124:127], v[196:199]
  ds_read_b128 v[36:39], v11 offset:9728
  v_mfma_f32_16x16x32_bf16 v[196:199], v[44:47], v[116:119], v[196:199]
  ds_read_b128 v[244:247], v4 offset:9728
  v_mfma_f32_16x16x32_bf16 v[196:199], v[56:59], v[136:139], v[196:199]
  ds_read_b128 v[132:135], v12 offset:9728
  v_mfma_f32_16x16x32_bf16 v[196:199], v[148:151], v[88:91], v[196:199]
  ds_read_b128 v[16:19], v5 offset:9728
  v_mfma_f32_16x16x32_bf16 v[196:199], v[24:27], v[248:251], v[196:199]
  ds_read_b128 v[120:123], v13 offset:9728
  v_mfma_f32_16x16x32_bf16 v[200:203], v[20:23], v[136:139], v[200:203]
  v_mfma_f32_16x16x32_bf16 v[200:203], v[84:87], v[116:119], v[200:203]
  v_mfma_f32_16x16x32_bf16 v[200:203], v[112:115], v[124:127], v[200:203]
  v_mfma_f32_16x16x32_bf16 v[200:203], v[140:143], v[252:255], v[200:203]
  v_mfma_f32_16x16x32_bf16 v[200:203], v[48:51], v[80:83], v[200:203]
  v_mfma_f32_16x16x32_bf16 v[200:203], v[52:55], v[68:71], v[200:203]
  v_mfma_f32_16x16x32_bf16 v[204:207], v[128:131], v[68:71], v[204:207]
  v_mfma_f32_16x16x32_bf16 v[204:207], v[108:111], v[80:83], v[204:207]
  v_mfma_f32_16x16x32_bf16 v[204:207], v[44:47], v[252:255], v[204:207]
  s_waitcnt lgkmcnt(0)
  s_barrier
  ds_read_b64_tr_b16 v[40:41], v6 offset:4128
  v_mfma_f32_16x16x32_bf16 v[204:207], v[56:59], v[124:127], v[204:207]
  ds_read_b64_tr_b16 v[42:43], v6 offset:4640
  v_mfma_f32_16x16x32_bf16 v[204:207], v[148:151], v[116:119], v[204:207]
  ds_read_b128 v[104:107], v2 offset:0
  v_mfma_f32_16x16x32_bf16 v[204:207], v[24:27], v[136:139], v[204:207]
  ds_read_b64_tr_b16 v[60:61], v6 offset:16512
  v_mfma_f32_16x16x32_bf16 v[208:211], v[20:23], v[124:127], v[208:211]
  ds_read_b64_tr_b16 v[62:63], v6 offset:17024
  v_mfma_f32_16x16x32_bf16 v[208:211], v[84:87], v[252:255], v[208:211]
  ds_read_b128 v[28:31], v1 offset:0
  v_mfma_f32_16x16x32_bf16 v[208:211], v[112:115], v[80:83], v[208:211]
  ds_read_b64_tr_b16 v[72:73], v6 offset:8256
  v_mfma_f32_16x16x32_bf16 v[208:211], v[140:143], v[68:71], v[208:211]
  ds_read_b64_tr_b16 v[74:75], v6 offset:8768
  v_mfma_f32_16x16x32_bf16 v[212:215], v[44:47], v[68:71], v[212:215]
  ds_read_b128 v[64:67], v2 offset:2048
  v_mfma_f32_16x16x32_bf16 v[212:215], v[56:59], v[80:83], v[212:215]
  ds_read_b64_tr_b16 v[92:93], v6 offset:20640
  v_mfma_f32_16x16x32_bf16 v[212:215], v[148:151], v[252:255], v[212:215]
  ds_read_b64_tr_b16 v[94:95], v6 offset:21152
  v_mfma_f32_16x16x32_bf16 v[212:215], v[24:27], v[124:127], v[212:215]
  ds_read_b128 v[96:99], v1 offset:2048
  v_mfma_f32_16x16x32_bf16 v[216:219], v[20:23], v[100:103], v[216:219]
  ds_read_b64_tr_b16 v[144:145], v7 offset:20640
  v_mfma_f32_16x16x32_bf16 v[216:219], v[84:87], v[36:39], v[216:219]
  ds_read_b64_tr_b16 v[146:147], v7 offset:21152
  v_mfma_f32_16x16x32_bf16 v[216:219], v[112:115], v[244:247], v[216:219]
  ds_read_b64_tr_b16 v[32:33], v7 offset:8256
  v_mfma_f32_16x16x32_bf16 v[216:219], v[140:143], v[132:135], v[216:219]
  ds_read_b64_tr_b16 v[34:35], v7 offset:8768
  v_mfma_f32_16x16x32_bf16 v[216:219], v[48:51], v[16:19], v[216:219]
  ds_read_b64_tr_b16 v[76:77], v7 offset:16512
  v_mfma_f32_16x16x32_bf16 v[216:219], v[52:55], v[120:123], v[216:219]
  ds_read_b64_tr_b16 v[78:79], v7 offset:17024
  v_mfma_f32_16x16x32_bf16 v[220:223], v[128:131], v[120:123], v[220:223]
  ds_read_b64_tr_b16 v[88:89], v7 offset:4128
  v_mfma_f32_16x16x32_bf16 v[220:223], v[108:111], v[16:19], v[220:223]
  ds_read_b64_tr_b16 v[90:91], v7 offset:4640
  v_mfma_f32_16x16x32_bf16 v[220:223], v[44:47], v[132:135], v[220:223]
  ds_read_b64_tr_b16 v[248:249], v6 offset:0
  v_mfma_f32_16x16x32_bf16 v[220:223], v[56:59], v[244:247], v[220:223]
  ds_read_b64_tr_b16 v[250:251], v6 offset:512
  v_mfma_f32_16x16x32_bf16 v[220:223], v[148:151], v[36:39], v[220:223]
  ds_read_b64_tr_b16 v[116:117], v6 offset:12384
  v_mfma_f32_16x16x32_bf16 v[220:223], v[24:27], v[100:103], v[220:223]
  ds_read_b64_tr_b16 v[118:119], v6 offset:12896
  s_waitcnt lgkmcnt(10)
  v_mfma_f32_16x16x32_bf16 v[152:155], v[40:43], v[104:107], v[152:155]
  ds_read_b128 v[136:139], v2 offset:4096
  v_mfma_f32_16x16x32_bf16 v[152:155], v[60:63], v[28:31], v[152:155]
  ds_read_b128 v[68:71], v1 offset:4096
  v_mfma_f32_16x16x32_bf16 v[152:155], v[72:75], v[64:67], v[152:155]
  ds_read_b64_tr_b16 v[80:81], v7 offset:12384
  v_mfma_f32_16x16x32_bf16 v[152:155], v[92:95], v[96:99], v[152:155]
  ds_read_b64_tr_b16 v[82:83], v7 offset:12896
  v_mfma_f32_16x16x32_bf16 v[156:159], v[144:147], v[96:99], v[156:159]
  ds_read_b64_tr_b16 v[252:253], v7 offset:0
  s_waitcnt lgkmcnt(10)
  v_mfma_f32_16x16x32_bf16 v[156:159], v[32:35], v[64:67], v[156:159]
  ds_read_b64_tr_b16 v[254:255], v7 offset:512
  v_mfma_f32_16x16x32_bf16 v[156:159], v[76:79], v[28:31], v[156:159]
  ds_read_b128 v[124:127], v2 offset:6144
  s_waitcnt lgkmcnt(10)
  v_mfma_f32_16x16x32_bf16 v[156:159], v[88:91], v[104:107], v[156:159]
  ds_read_b128 v[20:23], v1 offset:6144
  s_waitcnt lgkmcnt(10)
  v_mfma_f32_16x16x32_bf16 v[160:163], v[248:251], v[104:107], v[160:163]
  s_waitcnt lgkmcnt(8)
  v_mfma_f32_16x16x32_bf16 v[160:163], v[116:119], v[28:31], v[160:163]
  v_mfma_f32_16x16x32_bf16 v[160:163], v[40:43], v[64:67], v[160:163]
  v_mfma_f32_16x16x32_bf16 v[160:163], v[60:63], v[96:99], v[160:163]
  s_waitcnt lgkmcnt(6)
  v_mfma_f32_16x16x32_bf16 v[160:163], v[72:75], v[136:139], v[160:163]
  v_mfma_f32_16x16x32_bf16 v[160:163], v[92:95], v[68:71], v[160:163]
  v_mfma_f32_16x16x32_bf16 v[164:167], v[144:147], v[68:71], v[164:167]
  v_mfma_f32_16x16x32_bf16 v[164:167], v[32:35], v[136:139], v[164:167]
  v_mfma_f32_16x16x32_bf16 v[164:167], v[76:79], v[96:99], v[164:167]
  v_mfma_f32_16x16x32_bf16 v[164:167], v[88:91], v[64:67], v[164:167]
  s_waitcnt lgkmcnt(0)
  v_mfma_f32_16x16x32_bf16 v[164:167], v[80:83], v[28:31], v[164:167]
  v_mfma_f32_16x16x32_bf16 v[164:167], v[252:255], v[104:107], v[164:167]
  v_mfma_f32_16x16x32_bf16 v[168:171], v[248:251], v[64:67], v[168:171]
  s_barrier
  ds_read_b128 v[84:87], v2 offset:8192
  v_mfma_f32_16x16x32_bf16 v[168:171], v[116:119], v[96:99], v[168:171]
  ds_read_b128 v[112:115], v1 offset:8192
  v_mfma_f32_16x16x32_bf16 v[168:171], v[40:43], v[136:139], v[168:171]
  ds_read_b128 v[140:143], v2 offset:10240
  v_mfma_f32_16x16x32_bf16 v[168:171], v[60:63], v[68:71], v[168:171]
  ds_read_b128 v[48:51], v1 offset:10240
  v_mfma_f32_16x16x32_bf16 v[168:171], v[72:75], v[124:127], v[168:171]
  v_mfma_f32_16x16x32_bf16 v[168:171], v[92:95], v[20:23], v[168:171]
  v_mfma_f32_16x16x32_bf16 v[172:175], v[144:147], v[20:23], v[172:175]
  v_mfma_f32_16x16x32_bf16 v[172:175], v[32:35], v[124:127], v[172:175]
  v_mfma_f32_16x16x32_bf16 v[172:175], v[76:79], v[68:71], v[172:175]
  v_mfma_f32_16x16x32_bf16 v[172:175], v[88:91], v[136:139], v[172:175]
  v_mfma_f32_16x16x32_bf16 v[172:175], v[80:83], v[96:99], v[172:175]
  v_mfma_f32_16x16x32_bf16 v[172:175], v[252:255], v[64:67], v[172:175]
  v_mfma_f32_16x16x32_bf16 v[176:179], v[248:251], v[136:139], v[176:179]
  v_mfma_f32_16x16x32_bf16 v[176:179], v[116:119], v[68:71], v[176:179]
  v_mfma_f32_16x16x32_bf16 v[176:179], v[40:43], v[124:127], v[176:179]
  ds_read_b128 v[52:55], v2 offset:12288
  v_mfma_f32_16x16x32_bf16 v[176:179], v[60:63], v[20:23], v[176:179]
  ds_read_b128 v[128:131], v1 offset:12288
  s_waitcnt lgkmcnt(2)
  v_mfma_f32_16x16x32_bf16 v[176:179], v[72:75], v[84:87], v[176:179]
  v_mfma_f32_16x16x32_bf16 v[176:179], v[92:95], v[112:115], v[176:179]
  v_mfma_f32_16x16x32_bf16 v[180:183], v[144:147], v[112:115], v[180:183]
  v_mfma_f32_16x16x32_bf16 v[180:183], v[32:35], v[84:87], v[180:183]
  v_mfma_f32_16x16x32_bf16 v[180:183], v[76:79], v[20:23], v[180:183]
  v_mfma_f32_16x16x32_bf16 v[180:183], v[88:91], v[124:127], v[180:183]
  v_mfma_f32_16x16x32_bf16 v[180:183], v[80:83], v[68:71], v[180:183]
  v_mfma_f32_16x16x32_bf16 v[180:183], v[252:255], v[136:139], v[180:183]
  v_mfma_f32_16x16x32_bf16 v[184:187], v[248:251], v[124:127], v[184:187]
  v_mfma_f32_16x16x32_bf16 v[184:187], v[116:119], v[20:23], v[184:187]
  v_mfma_f32_16x16x32_bf16 v[184:187], v[40:43], v[84:87], v[184:187]
  ds_read_b128 v[120:123], v2 offset:14336
  v_mfma_f32_16x16x32_bf16 v[184:187], v[60:63], v[112:115], v[184:187]
  ds_read_b128 v[108:111], v1 offset:14336
  v_mfma_f32_16x16x32_bf16 v[184:187], v[72:75], v[140:143], v[184:187]
  v_mfma_f32_16x16x32_bf16 v[184:187], v[92:95], v[48:51], v[184:187]
  v_mfma_f32_16x16x32_bf16 v[188:191], v[144:147], v[48:51], v[188:191]
  v_mfma_f32_16x16x32_bf16 v[188:191], v[32:35], v[140:143], v[188:191]
  v_mfma_f32_16x16x32_bf16 v[188:191], v[76:79], v[112:115], v[188:191]
  v_mfma_f32_16x16x32_bf16 v[188:191], v[88:91], v[84:87], v[188:191]
  v_mfma_f32_16x16x32_bf16 v[188:191], v[80:83], v[20:23], v[188:191]
  v_mfma_f32_16x16x32_bf16 v[188:191], v[252:255], v[124:127], v[188:191]
  v_mfma_f32_16x16x32_bf16 v[192:195], v[248:251], v[84:87], v[192:195]
  v_mfma_f32_16x16x32_bf16 v[192:195], v[116:119], v[112:115], v[192:195]
  v_mfma_f32_16x16x32_bf16 v[192:195], v[40:43], v[140:143], v[192:195]
  v_mfma_f32_16x16x32_bf16 v[192:195], v[60:63], v[48:51], v[192:195]
  s_waitcnt lgkmcnt(0)
  v_mfma_f32_16x16x32_bf16 v[192:195], v[72:75], v[52:55], v[192:195]
  v_mfma_f32_16x16x32_bf16 v[192:195], v[92:95], v[128:131], v[192:195]
  v_mfma_f32_16x16x32_bf16 v[196:199], v[144:147], v[128:131], v[196:199]
  ds_read_b128 v[16:19], v3 offset:0
  v_mfma_f32_16x16x32_bf16 v[196:199], v[32:35], v[52:55], v[196:199]
  ds_read_b128 v[44:47], v11 offset:0
  v_mfma_f32_16x16x32_bf16 v[196:199], v[76:79], v[48:51], v[196:199]
  ds_read_b128 v[132:135], v4 offset:0
  v_mfma_f32_16x16x32_bf16 v[196:199], v[88:91], v[140:143], v[196:199]
  ds_read_b128 v[56:59], v12 offset:0
  v_mfma_f32_16x16x32_bf16 v[196:199], v[80:83], v[112:115], v[196:199]
  ds_read_b128 v[244:247], v5 offset:0
  v_mfma_f32_16x16x32_bf16 v[196:199], v[252:255], v[84:87], v[196:199]
  ds_read_b128 v[148:151], v13 offset:0
  v_mfma_f32_16x16x32_bf16 v[200:203], v[248:251], v[140:143], v[200:203]
  v_mfma_f32_16x16x32_bf16 v[200:203], v[116:119], v[48:51], v[200:203]
  v_mfma_f32_16x16x32_bf16 v[200:203], v[40:43], v[52:55], v[200:203]
  v_mfma_f32_16x16x32_bf16 v[200:203], v[60:63], v[128:131], v[200:203]
  v_mfma_f32_16x16x32_bf16 v[200:203], v[72:75], v[120:123], v[200:203]
  v_mfma_f32_16x16x32_bf16 v[200:203], v[92:95], v[108:111], v[200:203]
  v_mfma_f32_16x16x32_bf16 v[204:207], v[144:147], v[108:111], v[204:207]
  v_mfma_f32_16x16x32_bf16 v[204:207], v[32:35], v[120:123], v[204:207]
  v_mfma_f32_16x16x32_bf16 v[204:207], v[76:79], v[128:131], v[204:207]
  s_barrier
  ds_read_b64_tr_b16 v[36:37], v6 offset:28896
  v_mfma_f32_16x16x32_bf16 v[204:207], v[88:91], v[52:55], v[204:207]
  ds_read_b64_tr_b16 v[38:39], v6 offset:29408
  v_mfma_f32_16x16x32_bf16 v[204:207], v[80:83], v[48:51], v[204:207]
  ds_read_b128 v[24:27], v2 offset:16384
  v_mfma_f32_16x16x32_bf16 v[204:207], v[252:255], v[140:143], v[204:207]
  ds_read_b64_tr_b16 v[100:101], v6 offset:41280
  v_mfma_f32_16x16x32_bf16 v[208:211], v[248:251], v[52:55], v[208:211]
  ds_read_b64_tr_b16 v[102:103], v6 offset:41792
  v_mfma_f32_16x16x32_bf16 v[208:211], v[116:119], v[128:131], v[208:211]
  ds_read_b128 v[28:31], v1 offset:16384
  v_mfma_f32_16x16x32_bf16 v[208:211], v[40:43], v[120:123], v[208:211]
  ds_read_b64_tr_b16 v[104:105], v6 offset:33024
  v_mfma_f32_16x16x32_bf16 v[208:211], v[60:63], v[108:111], v[208:211]
  ds_read_b64_tr_b16 v[106:107], v6 offset:33536
  v_mfma_f32_16x16x32_bf16 v[212:215], v[76:79], v[108:111], v[212:215]
  ds_read_b128 v[96:99], v2 offset:18432
  v_mfma_f32_16x16x32_bf16 v[212:215], v[88:91], v[120:123], v[212:215]
  ds_read_b64_tr_b16 v[64:65], v6 offset:45408
  v_mfma_f32_16x16x32_bf16 v[212:215], v[80:83], v[128:131], v[212:215]
  ds_read_b64_tr_b16 v[66:67], v6 offset:45920
  v_mfma_f32_16x16x32_bf16 v[212:215], v[252:255], v[52:55], v[212:215]
  ds_read_b128 v[68:71], v1 offset:18432
  s_waitcnt lgkmcnt(10)
  v_mfma_f32_16x16x32_bf16 v[216:219], v[248:251], v[16:19], v[216:219]
  ds_read_b64_tr_b16 v[136:137], v7 offset:28896
  v_mfma_f32_16x16x32_bf16 v[216:219], v[116:119], v[44:47], v[216:219]
  ds_read_b64_tr_b16 v[138:139], v7 offset:29408
  v_mfma_f32_16x16x32_bf16 v[216:219], v[40:43], v[132:135], v[216:219]
  ds_read_b64_tr_b16 v[20:21], v7 offset:41280
  v_mfma_f32_16x16x32_bf16 v[216:219], v[60:63], v[56:59], v[216:219]
  ds_read_b64_tr_b16 v[22:23], v7 offset:41792
  v_mfma_f32_16x16x32_bf16 v[216:219], v[72:75], v[244:247], v[216:219]
  ds_read_b64_tr_b16 v[124:125], v7 offset:33024
  v_mfma_f32_16x16x32_bf16 v[216:219], v[92:95], v[148:151], v[216:219]
  ds_read_b64_tr_b16 v[126:127], v7 offset:33536
  v_mfma_f32_16x16x32_bf16 v[220:223], v[144:147], v[148:151], v[220:223]
  ds_read_b64_tr_b16 v[112:113], v7 offset:45408
  v_mfma_f32_16x16x32_bf16 v[220:223], v[32:35], v[244:247], v[220:223]
  ds_read_b64_tr_b16 v[114:115], v7 offset:45920
  v_mfma_f32_16x16x32_bf16 v[220:223], v[76:79], v[56:59], v[220:223]
  ds_read_b64_tr_b16 v[84:85], v6 offset:24768
  v_mfma_f32_16x16x32_bf16 v[220:223], v[88:91], v[132:135], v[220:223]
  ds_read_b64_tr_b16 v[86:87], v6 offset:25280
  v_mfma_f32_16x16x32_bf16 v[220:223], v[80:83], v[44:47], v[220:223]
  ds_read_b64_tr_b16 v[48:49], v6 offset:37152
  v_mfma_f32_16x16x32_bf16 v[220:223], v[252:255], v[16:19], v[220:223]
  ds_read_b64_tr_b16 v[50:51], v6 offset:37664
  s_waitcnt lgkmcnt(10)
  v_mfma_f32_16x16x32_bf16 v[152:155], v[36:39], v[24:27], v[152:155]
  ds_read_b128 v[140:143], v2 offset:20480
  v_mfma_f32_16x16x32_bf16 v[152:155], v[100:103], v[28:31], v[152:155]
  ds_read_b128 v[108:111], v1 offset:20480
  v_mfma_f32_16x16x32_bf16 v[152:155], v[104:107], v[96:99], v[152:155]
  ds_read_b64_tr_b16 v[120:121], v7 offset:24768
  v_mfma_f32_16x16x32_bf16 v[152:155], v[64:67], v[68:71], v[152:155]
  ds_read_b64_tr_b16 v[122:123], v7 offset:25280
  v_mfma_f32_16x16x32_bf16 v[156:159], v[136:139], v[24:27], v[156:159]
  ds_read_b64_tr_b16 v[128:129], v7 offset:37152
  s_waitcnt lgkmcnt(10)
  v_mfma_f32_16x16x32_bf16 v[156:159], v[20:23], v[28:31], v[156:159]
  ds_read_b64_tr_b16 v[130:131], v7 offset:37664
  v_mfma_f32_16x16x32_bf16 v[156:159], v[124:127], v[96:99], v[156:159]
  ds_read_b128 v[224:227], v10 offset:0
  s_waitcnt lgkmcnt(10)
  v_mfma_f32_16x16x32_bf16 v[156:159], v[112:115], v[68:71], v[156:159]
  ds_read_b128 v[232:235], v10 offset:256
  s_waitcnt lgkmcnt(10)
  v_mfma_f32_16x16x32_bf16 v[160:163], v[84:87], v[24:27], v[160:163]
  ds_read_b128 v[228:231], v10 offset:16
  s_waitcnt lgkmcnt(9)
  v_mfma_f32_16x16x32_bf16 v[160:163], v[48:51], v[28:31], v[160:163]
  ds_read_b128 v[236:239], v10 offset:272
  v_mfma_f32_16x16x32_bf16 v[160:163], v[36:39], v[96:99], v[160:163]
  s_barrier
  ds_read_b64_tr_b16 v[52:53], v6 offset:4128
  ds_read_b64_tr_b16 v[54:55], v6 offset:4640
  v_mfma_f32_16x16x32_bf16 v[160:163], v[100:103], v[68:71], v[160:163]
  ds_read_b128 v[116:119], v2 offset:32768
  ds_read_b64_tr_b16 v[40:41], v6 offset:16512
  s_waitcnt lgkmcnt(12)
  v_mfma_f32_16x16x32_bf16 v[160:163], v[104:107], v[140:143], v[160:163]
  ds_read_b64_tr_b16 v[42:43], v6 offset:17024
  ds_read_b128 v[60:63], v1 offset:32768
  v_mfma_f32_16x16x32_bf16 v[160:163], v[64:67], v[108:111], v[160:163]
  ds_read_b64_tr_b16 v[72:73], v6 offset:8256
  ds_read_b64_tr_b16 v[74:75], v6 offset:8768
  s_waitcnt lgkmcnt(14)
  v_mfma_f32_16x16x32_bf16 v[164:167], v[120:123], v[24:27], v[164:167]
  ds_read_b128 v[92:95], v2 offset:34816
  ds_read_b64_tr_b16 v[144:145], v6 offset:20640
  s_waitcnt lgkmcnt(14)
  v_mfma_f32_16x16x32_bf16 v[164:167], v[128:131], v[28:31], v[164:167]
  ds_read_b64_tr_b16 v[146:147], v6 offset:21152
  ds_read_b128 v[148:151], v1 offset:34816
  v_mfma_f32_16x16x32_bf16 v[164:167], v[136:139], v[96:99], v[164:167]
  ds_read_b64_tr_b16 v[32:33], v7 offset:4128
  ds_read_b64_tr_b16 v[34:35], v7 offset:4640
  v_mfma_f32_16x16x32_bf16 v[164:167], v[20:23], v[68:71], v[164:167]
  ds_read_b64_tr_b16 v[244:245], v7 offset:16512
  ds_read_b64_tr_b16 v[246:247], v7 offset:17024
  v_mfma_f32_16x16x32_bf16 v[164:167], v[124:127], v[140:143], v[164:167]
  ds_read_b64_tr_b16 v[76:77], v7 offset:8256
  ds_read_b64_tr_b16 v[78:79], v7 offset:8768
  v_mfma_f32_16x16x32_bf16 v[164:167], v[112:115], v[108:111], v[164:167]
  ds_read_b64_tr_b16 v[56:57], v7 offset:20640
  ds_read_b64_tr_b16 v[58:59], v7 offset:21152
  s_waitcnt lgkmcnt(15)
L_t_pu_2:
  s_cbranch_scc1 L_r_pu_2
  v_mfma_f32_16x16x32_bf16 v[152:155], v[52:55], v[116:119], v[152:155]
  s_barrier
  ds_read_b128 v[88:91], v2 offset:22528
  s_waitcnt lgkmcnt(15)
  v_mfma_f32_16x16x32_bf16 v[152:155], v[40:43], v[60:63], v[152:155]
  ds_read_b128 v[132:135], v1 offset:22528
  s_waitcnt lgkmcnt(13)
  v_mfma_f32_16x16x32_bf16 v[152:155], v[72:75], v[92:95], v[152:155]
  ds_read_b64_tr_b16 v[80:81], v6 offset:0
  s_waitcnt lgkmcnt(11)
  v_mfma_f32_16x16x32_bf16 v[152:155], v[144:147], v[148:151], v[152:155]
  ds_read_b64_tr_b16 v[82:83], v6 offset:512
  s_waitcnt lgkmcnt(10)
  v_mfma_f32_16x16x32_bf16 v[156:159], v[32:35], v[116:119], v[156:159]
  ds_read_b64_tr_b16 v[44:45], v6 offset:12384
  s_waitcnt lgkmcnt(9)
  v_mfma_f32_16x16x32_bf16 v[156:159], v[244:247], v[60:63], v[156:159]
  ds_read_b64_tr_b16 v[46:47], v6 offset:12896
  s_waitcnt lgkmcnt(8)
  v_mfma_f32_16x16x32_bf16 v[156:159], v[76:79], v[92:95], v[156:159]
  ds_read_b128 v[16:19], v2 offset:36864
  s_waitcnt lgkmcnt(7)
  v_mfma_f32_16x16x32_bf16 v[156:159], v[56:59], v[148:151], v[156:159]
  ds_read_b128 v[24:27], v1 offset:36864
  v_mfma_f32_16x16x32_bf16 v[168:171], v[84:87], v[96:99], v[168:171]
  ds_read_b64_tr_b16 v[28:29], v7 offset:0
  v_mfma_f32_16x16x32_bf16 v[168:171], v[48:51], v[68:71], v[168:171]
  ds_read_b64_tr_b16 v[30:31], v7 offset:512
  v_mfma_f32_16x16x32_bf16 v[168:171], v[36:39], v[140:143], v[168:171]
  v_mfma_f32_16x16x32_bf16 v[168:171], v[100:103], v[108:111], v[168:171]
  s_waitcnt lgkmcnt(8)
  v_mfma_f32_16x16x32_bf16 v[168:171], v[104:107], v[88:91], v[168:171]
  v_fma_f32 v152, v152, v224, v232
  v_fma_f32 v153, v153, v225, v233
  v_mfma_f32_16x16x32_bf16 v[168:171], v[64:67], v[132:135], v[168:171]
  v_fma_f32 v154, v154, v226, v234
  v_fma_f32 v155, v155, v227, v235
  v_exp_f32 v248, v152
  v_mfma_f32_16x16x32_bf16 v[172:175], v[120:123], v[96:99], v[172:175]
  ds_read_b64_tr_b16 v[96:97], v7 offset:12384
  v_exp_f32 v249, v153
  v_mfma_f32_16x16x32_bf16 v[172:175], v[128:131], v[68:71], v[172:175]
  ds_read_b64_tr_b16 v[98:99], v7 offset:12896
  v_exp_f32 v250, v154
  v_mfma_f32_16x16x32_bf16 v[172:175], v[136:139], v[140:143], v[172:175]
  ds_read_b128 v[68:71], v2 offset:24576
  v_exp_f32 v251, v155
  v_mfma_f32_16x16x32_bf16 v[172:175], v[20:23], v[108:111], v[172:175]
  v_fma_f32 v156, v156, v228, v236
  v_fma_f32 v157, v157, v229, v237
  v_mfma_f32_16x16x32_bf16 v[172:175], v[124:127], v[88:91], v[172:175]
  v_fma_f32 v158, v158, v230, v238
  v_fma_f32 v159, v159, v231, v239
  v_mfma_f32_16x16x32_bf16 v[172:175], v[112:115], v[132:135], v[172:175]
  v_exp_f32 v252, v156
  v_exp_f32 v253, v157
  s_waitcnt lgkmcnt(3)
  v_mfma_f32_16x16x32_bf16 v[160:163], v[80:83], v[116:119], v[160:163]
  v_exp_f32 v254, v158
  v_mfma_f32_16x16x32_bf16 v[160:163], v[44:47], v[60:63], v[160:163]
  v_exp_f32 v255, v159
  v_mfma_f32_16x16x32_bf16 v[160:163], v[52:55], v[92:95], v[160:163]
  v_fma_f32 v248, v248, s56, s56
  v_fma_f32 v249, v249, s56, s56
  v_fma_f32 v250, v250, s56, s56
  v_mfma_f32_16x16x32_bf16 v[160:163], v[40:43], v[148:151], v[160:163]
  v_fma_f32 v251, v251, s56, s56
  v_rcp_f32 v248, v248
  v_mfma_f32_16x16x32_bf16 v[160:163], v[72:75], v[16:19], v[160:163]
  v_rcp_f32 v249, v249
  v_mfma_f32_16x16x32_bf16 v[160:163], v[144:147], v[24:27], v[160:163]
  v_rcp_f32 v250, v250
  v_rcp_f32 v251, v251
  v_mfma_f32_16x16x32_bf16 v[164:167], v[28:31], v[116:119], v[164:167]
  ds_read_b128 v[116:119], v1 offset:24576
  v_fma_f32 v252, v252, s56, s56
  s_waitcnt lgkmcnt(1)
  v_mfma_f32_16x16x32_bf16 v[164:167], v[96:99], v[60:63], v[164:167]
  ds_read_b128 v[60:63], v2 offset:38912
  v_fma_f32 v253, v253, s56, s56
  v_mfma_f32_16x16x32_bf16 v[164:167], v[32:35], v[92:95], v[164:167]
  v_fma_f32 v254, v254, s56, s56
  v_fma_f32 v255, v255, s56, s56
  v_rcp_f32 v252, v252
  v_mfma_f32_16x16x32_bf16 v[164:167], v[244:247], v[148:151], v[164:167]
  v_rcp_f32 v253, v253
  v_mfma_f32_16x16x32_bf16 v[164:167], v[76:79], v[16:19], v[164:167]
  v_rcp_f32 v254, v254
  v_mfma_f32_16x16x32_bf16 v[164:167], v[56:59], v[24:27], v[164:167]
  v_rcp_f32 v255, v255
  v_mul_f32 v152, v152, v248
  v_mfma_f32_16x16x32_bf16 v[176:179], v[84:87], v[140:143], v[176:179]
  v_mul_f32 v153, v153, v249
  v_mul_f32 v154, v154, v250
  v_mfma_f32_16x16x32_bf16 v[176:179], v[48:51], v[108:111], v[176:179]
  v_mul_f32 v155, v155, v251
  v_cvt_pk_bf16_f32 v240, v152, v153
  v_mfma_f32_16x16x32_bf16 v[176:179], v[36:39], v[88:91], v[176:179]
  v_cvt_pk_bf16_f32 v241, v154, v155
  v_mul_f32 v156, v156, v252
  v_mul_f32 v157, v157, v253
  v_mfma_f32_16x16x32_bf16 v[176:179], v[100:103], v[132:135], v[176:179]
  v_mul_f32 v158, v158, v254
  v_mul_f32 v159, v159, v255
  v_mfma_f32_16x16x32_bf16 v[176:179], v[104:107], v[68:71], v[176:179]
  v_cvt_pk_bf16_f32 v242, v156, v157
  v_cvt_pk_bf16_f32 v243, v158, v159
  s_waitcnt lgkmcnt(1)
  v_mfma_f32_16x16x32_bf16 v[176:179], v[64:67], v[116:119], v[176:179]
  ds_read_b128 v[156:159], v1 offset:38912
  buffer_store_dwordx4 v[240:243], v8, s[28:31], s48 offen offset:0 sc1
  v_fma_f32 v160, v160, v224, v232
  v_mfma_f32_16x16x32_bf16 v[180:183], v[120:123], v[140:143], v[180:183]
  ds_read_b128 v[140:143], v2 offset:26624
  v_fma_f32 v161, v161, v225, v233
  v_mfma_f32_16x16x32_bf16 v[180:183], v[128:131], v[108:111], v[180:183]
  ds_read_b128 v[108:111], v1 offset:26624
  v_fma_f32 v162, v162, v226, v234
  v_mfma_f32_16x16x32_bf16 v[180:183], v[136:139], v[88:91], v[180:183]
  v_fma_f32 v163, v163, v227, v235
  v_exp_f32 v248, v160
  v_mfma_f32_16x16x32_bf16 v[180:183], v[20:23], v[132:135], v[180:183]
  v_exp_f32 v249, v161
  v_mfma_f32_16x16x32_bf16 v[180:183], v[124:127], v[68:71], v[180:183]
  v_exp_f32 v250, v162
  v_mfma_f32_16x16x32_bf16 v[180:183], v[112:115], v[116:119], v[180:183]
  v_exp_f32 v251, v163
  v_fma_f32 v164, v164, v228, v236
  v_mfma_f32_16x16x32_bf16 v[168:171], v[80:83], v[92:95], v[168:171]
  v_fma_f32 v165, v165, v229, v237
  v_fma_f32 v166, v166, v230, v238
  v_mfma_f32_16x16x32_bf16 v[168:171], v[44:47], v[148:151], v[168:171]
  v_fma_f32 v167, v167, v231, v239
  v_exp_f32 v252, v164
  v_mfma_f32_16x16x32_bf16 v[168:171], v[52:55], v[16:19], v[168:171]
  v_exp_f32 v253, v165
  v_exp_f32 v254, v166
  v_mfma_f32_16x16x32_bf16 v[168:171], v[40:43], v[24:27], v[168:171]
  v_exp_f32 v255, v167
  s_waitcnt lgkmcnt(2)
  v_mfma_f32_16x16x32_bf16 v[168:171], v[72:75], v[60:63], v[168:171]
  v_fma_f32 v248, v248, s56, s56
  v_fma_f32 v249, v249, s56, s56
  v_mfma_f32_16x16x32_bf16 v[168:171], v[144:147], v[156:159], v[168:171]
  v_fma_f32 v250, v250, s56, s56
  v_fma_f32 v251, v251, s56, s56
  v_rcp_f32 v248, v248
  v_mfma_f32_16x16x32_bf16 v[172:175], v[28:31], v[92:95], v[172:175]
  v_rcp_f32 v249, v249
  v_mfma_f32_16x16x32_bf16 v[172:175], v[96:99], v[148:151], v[172:175]
  v_rcp_f32 v250, v250
  v_mfma_f32_16x16x32_bf16 v[172:175], v[32:35], v[16:19], v[172:175]
  v_rcp_f32 v251, v251
  v_fma_f32 v252, v252, s56, s56
  v_mfma_f32_16x16x32_bf16 v[172:175], v[244:247], v[24:27], v[172:175]
  v_fma_f32 v253, v253, s56, s56
  v_fma_f32 v254, v254, s56, s56
  v_mfma_f32_16x16x32_bf16 v[172:175], v[76:79], v[60:63], v[172:175]
  v_fma_f32 v255, v255, s56, s56
  v_rcp_f32 v252, v252
  v_mfma_f32_16x16x32_bf16 v[172:175], v[56:59], v[156:159], v[172:175]
  v_rcp_f32 v253, v253
  v_rcp_f32 v254, v254
  v_mfma_f32_16x16x32_bf16 v[184:187], v[84:87], v[88:91], v[184:187]
  v_rcp_f32 v255, v255
  v_mfma_f32_16x16x32_bf16 v[184:187], v[48:51], v[132:135], v[184:187]
  v_mul_f32 v160, v160, v248
  v_mul_f32 v161, v161, v249
  v_mfma_f32_16x16x32_bf16 v[184:187], v[36:39], v[68:71], v[184:187]
  s_barrier
  ds_read_b128 v[92:95], v2 offset:40960
  v_mul_f32 v162, v162, v250
  v_mul_f32 v163, v163, v251
  v_mfma_f32_16x16x32_bf16 v[184:187], v[100:103], v[116:119], v[184:187]
  ds_read_b128 v[148:151], v1 offset:40960
  v_cvt_pk_bf16_f32 v152, v160, v161
  s_waitcnt lgkmcnt(2)
  v_mfma_f32_16x16x32_bf16 v[184:187], v[104:107], v[140:143], v[184:187]
  v_cvt_pk_bf16_f32 v153, v162, v163
  v_mul_f32 v164, v164, v252
  v_mfma_f32_16x16x32_bf16 v[184:187], v[64:67], v[108:111], v[184:187]
  v_mul_f32 v165, v165, v253
  v_mul_f32 v166, v166, v254
  v_mul_f32 v167, v167, v255
  v_mfma_f32_16x16x32_bf16 v[188:191], v[120:123], v[88:91], v[188:191]
  ds_read_b128 v[88:91], v2 offset:28672
  v_cvt_pk_bf16_f32 v154, v164, v165
  v_mfma_f32_16x16x32_bf16 v[188:191], v[128:131], v[132:135], v[188:191]
  ds_read_b128 v[132:135], v1 offset:28672
  v_cvt_pk_bf16_f32 v155, v166, v167
  v_mfma_f32_16x16x32_bf16 v[188:191], v[136:139], v[68:71], v[188:191]
  buffer_store_dwordx4 v[152:155], v8, s[28:31], s48 offen offset:1152 sc1
  v_fma_f32 v168, v168, v224, v232
  v_fma_f32 v169, v169, v225, v233
  v_mfma_f32_16x16x32_bf16 v[188:191], v[20:23], v[116:119], v[188:191]
  v_fma_f32 v170, v170, v226, v234
  v_fma_f32 v171, v171, v227, v235
  v_mfma_f32_16x16x32_bf16 v[188:191], v[124:127], v[140:143], v[188:191]
  v_exp_f32 v248, v168
  v_mfma_f32_16x16x32_bf16 v[188:191], v[112:115], v[108:111], v[188:191]
  v_exp_f32 v249, v169
  v_exp_f32 v250, v170
  v_mfma_f32_16x16x32_bf16 v[176:179], v[80:83], v[16:19], v[176:179]
  v_exp_f32 v251, v171
  v_mfma_f32_16x16x32_bf16 v[176:179], v[44:47], v[24:27], v[176:179]
  v_fma_f32 v172, v172, v228, v236
  v_fma_f32 v173, v173, v229, v237
  v_mfma_f32_16x16x32_bf16 v[176:179], v[52:55], v[60:63], v[176:179]
  ds_read_b128 v[164:167], v2 offset:43008
  v_fma_f32 v174, v174, v230, v238
  v_fma_f32 v175, v175, v231, v239
  v_mfma_f32_16x16x32_bf16 v[176:179], v[40:43], v[156:159], v[176:179]
  ds_read_b128 v[152:155], v1 offset:43008
  v_exp_f32 v252, v172
  s_waitcnt lgkmcnt(4)
  v_mfma_f32_16x16x32_bf16 v[176:179], v[72:75], v[92:95], v[176:179]
  v_exp_f32 v253, v173
  v_mfma_f32_16x16x32_bf16 v[176:179], v[144:147], v[148:151], v[176:179]
  v_exp_f32 v254, v174
  v_exp_f32 v255, v175
  v_mfma_f32_16x16x32_bf16 v[180:183], v[28:31], v[16:19], v[180:183]
  v_fma_f32 v248, v248, s56, s56
  v_fma_f32 v249, v249, s56, s56
  v_mfma_f32_16x16x32_bf16 v[180:183], v[96:99], v[24:27], v[180:183]
  v_fma_f32 v250, v250, s56, s56
  v_fma_f32 v251, v251, s56, s56
  v_mfma_f32_16x16x32_bf16 v[180:183], v[32:35], v[60:63], v[180:183]
  v_rcp_f32 v248, v248
  v_rcp_f32 v249, v249
  v_mfma_f32_16x16x32_bf16 v[180:183], v[244:247], v[156:159], v[180:183]
  v_rcp_f32 v250, v250
  v_mfma_f32_16x16x32_bf16 v[180:183], v[76:79], v[92:95], v[180:183]
  v_rcp_f32 v251, v251
  v_mfma_f32_16x16x32_bf16 v[180:183], v[56:59], v[148:151], v[180:183]
  v_fma_f32 v252, v252, s56, s56
  v_fma_f32 v253, v253, s56, s56
  v_fma_f32 v254, v254, s56, s56
  v_mfma_f32_16x16x32_bf16 v[192:195], v[84:87], v[68:71], v[192:195]
  v_fma_f32 v255, v255, s56, s56
  v_rcp_f32 v252, v252
  v_mfma_f32_16x16x32_bf16 v[192:195], v[48:51], v[116:119], v[192:195]
  v_rcp_f32 v253, v253
  v_mfma_f32_16x16x32_bf16 v[192:195], v[36:39], v[140:143], v[192:195]
  ds_read_b128 v[16:19], v2 offset:30720
  v_rcp_f32 v254, v254
  v_mfma_f32_16x16x32_bf16 v[192:195], v[100:103], v[108:111], v[192:195]
  ds_read_b128 v[24:27], v1 offset:30720
  v_rcp_f32 v255, v255
  s_waitcnt lgkmcnt(2)
  v_mfma_f32_16x16x32_bf16 v[192:195], v[104:107], v[88:91], v[192:195]
  v_mul_f32 v168, v168, v248
  v_mul_f32 v169, v169, v249
  v_mfma_f32_16x16x32_bf16 v[192:195], v[64:67], v[132:135], v[192:195]
  v_mul_f32 v170, v170, v250
  v_mul_f32 v171, v171, v251
  v_cvt_pk_bf16_f32 v160, v168, v169
  v_mfma_f32_16x16x32_bf16 v[196:199], v[120:123], v[68:71], v[196:199]
  v_cvt_pk_bf16_f32 v161, v170, v171
  v_mul_f32 v172, v172, v252
  v_mfma_f32_16x16x32_bf16 v[196:199], v[128:131], v[116:119], v[196:199]
  v_mul_f32 v173, v173, v253
  v_mul_f32 v174, v174, v254
  v_mfma_f32_16x16x32_bf16 v[196:199], v[136:139], v[140:143], v[196:199]
  v_mul_f32 v175, v175, v255
  v_cvt_pk_bf16_f32 v162, v172, v173
  v_cvt_pk_bf16_f32 v163, v174, v175
  v_mfma_f32_16x16x32_bf16 v[196:199], v[20:23], v[108:111], v[196:199]
  buffer_store_dwordx4 v[160:163], v8, s[28:31], s48 offen offset:2304 sc1
  v_fma_f32 v176, v176, v224, v232
  v_mfma_f32_16x16x32_bf16 v[196:199], v[124:127], v[88:91], v[196:199]
  v_fma_f32 v177, v177, v225, v233
  v_fma_f32 v178, v178, v226, v234
  v_mfma_f32_16x16x32_bf16 v[196:199], v[112:115], v[132:135], v[196:199]
  v_fma_f32 v179, v179, v227, v235
  v_exp_f32 v248, v176
  v_mfma_f32_16x16x32_bf16 v[184:187], v[80:83], v[60:63], v[184:187]
  v_exp_f32 v249, v177
  v_mfma_f32_16x16x32_bf16 v[184:187], v[44:47], v[156:159], v[184:187]
  v_exp_f32 v250, v178
  v_mfma_f32_16x16x32_bf16 v[184:187], v[52:55], v[92:95], v[184:187]
  ds_read_b128 v[68:71], v2 offset:45056
  v_exp_f32 v251, v179
  v_mfma_f32_16x16x32_bf16 v[184:187], v[40:43], v[148:151], v[184:187]
  ds_read_b128 v[116:119], v1 offset:45056
  v_fma_f32 v180, v180, v228, v236
  v_mfma_f32_16x16x32_bf16 v[184:187], v[72:75], v[164:167], v[184:187]
  v_fma_f32 v181, v181, v229, v237
  v_fma_f32 v182, v182, v230, v238
  v_mfma_f32_16x16x32_bf16 v[184:187], v[144:147], v[152:155], v[184:187]
  v_fma_f32 v183, v183, v231, v239
  v_exp_f32 v252, v180
  v_mfma_f32_16x16x32_bf16 v[188:191], v[28:31], v[60:63], v[188:191]
  v_exp_f32 v253, v181
  v_mfma_f32_16x16x32_bf16 v[188:191], v[96:99], v[156:159], v[188:191]
  v_exp_f32 v254, v182
  v_mfma_f32_16x16x32_bf16 v[188:191], v[32:35], v[92:95], v[188:191]
  v_exp_f32 v255, v183
  v_fma_f32 v248, v248, s56, s56
  v_mfma_f32_16x16x32_bf16 v[188:191], v[244:247], v[148:151], v[188:191]
  v_fma_f32 v249, v249, s56, s56
  v_fma_f32 v250, v250, s56, s56
  v_mfma_f32_16x16x32_bf16 v[188:191], v[76:79], v[164:167], v[188:191]
  v_fma_f32 v251, v251, s56, s56
  v_rcp_f32 v248, v248
  v_mfma_f32_16x16x32_bf16 v[188:191], v[56:59], v[152:155], v[188:191]
  v_rcp_f32 v249, v249
  v_rcp_f32 v250, v250
  v_mfma_f32_16x16x32_bf16 v[200:203], v[84:87], v[140:143], v[200:203]
  v_rcp_f32 v251, v251
  v_mfma_f32_16x16x32_bf16 v[200:203], v[48:51], v[108:111], v[200:203]
  v_fma_f32 v252, v252, s56, s56
  v_fma_f32 v253, v253, s56, s56
  v_mfma_f32_16x16x32_bf16 v[200:203], v[36:39], v[88:91], v[200:203]
  v_fma_f32 v254, v254, s56, s56
  v_fma_f32 v255, v255, s56, s56
  v_rcp_f32 v252, v252
  v_mfma_f32_16x16x32_bf16 v[200:203], v[100:103], v[132:135], v[200:203]
  v_rcp_f32 v253, v253
  s_waitcnt lgkmcnt(0)
  v_mfma_f32_16x16x32_bf16 v[200:203], v[104:107], v[16:19], v[200:203]
  v_rcp_f32 v254, v254
  v_mfma_f32_16x16x32_bf16 v[200:203], v[64:67], v[24:27], v[200:203]
  v_rcp_f32 v255, v255
  v_mul_f32 v176, v176, v248
  v_mfma_f32_16x16x32_bf16 v[204:207], v[120:123], v[140:143], v[204:207]
  v_mul_f32 v177, v177, v249
  v_mul_f32 v178, v178, v250
  v_mfma_f32_16x16x32_bf16 v[204:207], v[128:131], v[108:111], v[204:207]
  v_mul_f32 v179, v179, v251
  v_cvt_pk_bf16_f32 v168, v176, v177
  v_mfma_f32_16x16x32_bf16 v[204:207], v[136:139], v[88:91], v[204:207]
  v_cvt_pk_bf16_f32 v169, v178, v179
  v_mul_f32 v180, v180, v252
  v_mul_f32 v181, v181, v253
  v_mfma_f32_16x16x32_bf16 v[204:207], v[20:23], v[132:135], v[204:207]
  v_mul_f32 v182, v182, v254
  v_mul_f32 v183, v183, v255
  v_mfma_f32_16x16x32_bf16 v[204:207], v[124:127], v[16:19], v[204:207]
  ds_read_b128 v[172:175], v2 offset:47104
  v_cvt_pk_bf16_f32 v170, v180, v181
  v_mfma_f32_16x16x32_bf16 v[204:207], v[112:115], v[24:27], v[204:207]
  ds_read_b128 v[160:163], v1 offset:47104
  v_cvt_pk_bf16_f32 v171, v182, v183
  buffer_store_dwordx4 v[168:171], v8, s[28:31], s48 offen offset:3456 sc1
  v_mfma_f32_16x16x32_bf16 v[192:195], v[80:83], v[92:95], v[192:195]
  v_fma_f32 v184, v184, v224, v232
  v_fma_f32 v185, v185, v225, v233
  v_mfma_f32_16x16x32_bf16 v[192:195], v[44:47], v[148:151], v[192:195]
  v_fma_f32 v186, v186, v226, v234
  v_fma_f32 v187, v187, v227, v235
  v_mfma_f32_16x16x32_bf16 v[192:195], v[52:55], v[164:167], v[192:195]
  v_exp_f32 v248, v184
  v_exp_f32 v249, v185
  v_mfma_f32_16x16x32_bf16 v[192:195], v[40:43], v[152:155], v[192:195]
  v_exp_f32 v250, v186
  v_mfma_f32_16x16x32_bf16 v[192:195], v[72:75], v[68:71], v[192:195]
  v_exp_f32 v251, v187
  v_mfma_f32_16x16x32_bf16 v[192:195], v[144:147], v[116:119], v[192:195]
  v_fma_f32 v188, v188, v228, v236
  v_fma_f32 v189, v189, v229, v237
  v_fma_f32 v190, v190, v230, v238
  v_mfma_f32_16x16x32_bf16 v[196:199], v[28:31], v[92:95], v[196:199]
  ds_read_b128 v[60:63], v3 offset:4864
  v_fma_f32 v191, v191, v231, v239
  v_mfma_f32_16x16x32_bf16 v[196:199], v[96:99], v[148:151], v[196:199]
  ds_read_b128 v[156:159], v11 offset:4864
  v_exp_f32 v252, v188
  v_mfma_f32_16x16x32_bf16 v[196:199], v[32:35], v[164:167], v[196:199]
  ds_read_b128 v[140:143], v4 offset:4864
  v_exp_f32 v253, v189
  v_mfma_f32_16x16x32_bf16 v[196:199], v[244:247], v[152:155], v[196:199]
  ds_read_b128 v[108:111], v12 offset:4864
  v_exp_f32 v254, v190
  v_mfma_f32_16x16x32_bf16 v[196:199], v[76:79], v[68:71], v[196:199]
  ds_read_b128 v[180:183], v5 offset:4864
  v_exp_f32 v255, v191
  v_mfma_f32_16x16x32_bf16 v[196:199], v[56:59], v[116:119], v[196:199]
  ds_read_b128 v[168:171], v13 offset:4864
  v_fma_f32 v248, v248, s56, s56
  v_fma_f32 v249, v249, s56, s56
  v_mfma_f32_16x16x32_bf16 v[208:211], v[84:87], v[88:91], v[208:211]
  v_fma_f32 v250, v250, s56, s56
  v_fma_f32 v251, v251, s56, s56
  v_mfma_f32_16x16x32_bf16 v[208:211], v[48:51], v[132:135], v[208:211]
  v_rcp_f32 v248, v248
  v_mfma_f32_16x16x32_bf16 v[208:211], v[36:39], v[16:19], v[208:211]
  v_rcp_f32 v249, v249
  v_rcp_f32 v250, v250
  v_mfma_f32_16x16x32_bf16 v[208:211], v[100:103], v[24:27], v[208:211]
  v_rcp_f32 v251, v251
  v_mfma_f32_16x16x32_bf16 v[212:215], v[120:123], v[88:91], v[212:215]
  v_fma_f32 v252, v252, s56, s56
  v_fma_f32 v253, v253, s56, s56
  v_mfma_f32_16x16x32_bf16 v[212:215], v[128:131], v[132:135], v[212:215]
  v_fma_f32 v254, v254, s56, s56
  v_fma_f32 v255, v255, s56, s56
  v_rcp_f32 v252, v252
  v_mfma_f32_16x16x32_bf16 v[212:215], v[136:139], v[16:19], v[212:215]
  v_rcp_f32 v253, v253
  v_mfma_f32_16x16x32_bf16 v[212:215], v[20:23], v[24:27], v[212:215]
  v_rcp_f32 v254, v254
  v_mfma_f32_16x16x32_bf16 v[200:203], v[80:83], v[164:167], v[200:203]
  v_rcp_f32 v255, v255
  v_mul_f32 v184, v184, v248
  v_mfma_f32_16x16x32_bf16 v[200:203], v[44:47], v[152:155], v[200:203]
  v_mul_f32 v185, v185, v249
  v_mul_f32 v186, v186, v250
  v_mfma_f32_16x16x32_bf16 v[200:203], v[52:55], v[68:71], v[200:203]
  v_mul_f32 v187, v187, v251
  v_cvt_pk_bf16_f32 v176, v184, v185
  v_mfma_f32_16x16x32_bf16 v[200:203], v[40:43], v[116:119], v[200:203]
  v_cvt_pk_bf16_f32 v177, v186, v187
  v_mul_f32 v188, v188, v252
  v_mul_f32 v189, v189, v253
  s_waitcnt lgkmcnt(0)
  v_mfma_f32_16x16x32_bf16 v[200:203], v[72:75], v[172:175], v[200:203]
  v_mul_f32 v190, v190, v254
  v_mul_f32 v191, v191, v255
  v_mfma_f32_16x16x32_bf16 v[200:203], v[144:147], v[160:163], v[200:203]
  v_cvt_pk_bf16_f32 v178, v188, v189
  v_cvt_pk_bf16_f32 v179, v190, v191
  v_mfma_f32_16x16x32_bf16 v[204:207], v[28:31], v[164:167], v[204:207]
  ds_read_b128 v[92:95], v3 offset:9728
  buffer_store_dwordx4 v[176:179], v8, s[28:31], s49 offen offset:0 sc1
  v_fma_f32 v192, v192, v224, v232
  v_mfma_f32_16x16x32_bf16 v[204:207], v[96:99], v[152:155], v[204:207]
  ds_read_b128 v[148:151], v11 offset:9728
  v_fma_f32 v193, v193, v225, v233
  v_mfma_f32_16x16x32_bf16 v[204:207], v[32:35], v[68:71], v[204:207]
  ds_read_b128 v[88:91], v4 offset:9728
  v_fma_f32 v194, v194, v226, v234
  v_mfma_f32_16x16x32_bf16 v[204:207], v[244:247], v[116:119], v[204:207]
  ds_read_b128 v[132:135], v12 offset:9728
  v_fma_f32 v195, v195, v227, v235
  v_exp_f32 v248, v192
  v_mfma_f32_16x16x32_bf16 v[204:207], v[76:79], v[172:175], v[204:207]
  ds_read_b128 v[16:19], v5 offset:9728
  v_exp_f32 v249, v193
  v_mfma_f32_16x16x32_bf16 v[204:207], v[56:59], v[160:163], v[204:207]
  ds_read_b128 v[24:27], v13 offset:9728
  v_exp_f32 v250, v194
  v_mfma_f32_16x16x32_bf16 v[216:219], v[84:87], v[60:63], v[216:219]
  v_exp_f32 v251, v195
  v_fma_f32 v196, v196, v228, v236
  v_mfma_f32_16x16x32_bf16 v[216:219], v[48:51], v[156:159], v[216:219]
  v_fma_f32 v197, v197, v229, v237
  v_fma_f32 v198, v198, v230, v238
  v_mfma_f32_16x16x32_bf16 v[216:219], v[36:39], v[140:143], v[216:219]
  v_fma_f32 v199, v199, v231, v239
  v_exp_f32 v252, v196
  v_mfma_f32_16x16x32_bf16 v[216:219], v[100:103], v[108:111], v[216:219]
  v_exp_f32 v253, v197
  v_exp_f32 v254, v198
  v_mfma_f32_16x16x32_bf16 v[216:219], v[104:107], v[180:183], v[216:219]
  v_exp_f32 v255, v199
  v_mfma_f32_16x16x32_bf16 v[216:219], v[64:67], v[168:171], v[216:219]
  v_fma_f32 v248, v248, s56, s56
  v_fma_f32 v249, v249, s56, s56
  v_mfma_f32_16x16x32_bf16 v[220:223], v[120:123], v[60:63], v[220:223]
  v_fma_f32 v250, v250, s56, s56
  v_fma_f32 v251, v251, s56, s56
  v_rcp_f32 v248, v248
  v_mfma_f32_16x16x32_bf16 v[220:223], v[128:131], v[156:159], v[220:223]
  v_rcp_f32 v249, v249
  v_mfma_f32_16x16x32_bf16 v[220:223], v[136:139], v[140:143], v[220:223]
  v_rcp_f32 v250, v250
  v_mfma_f32_16x16x32_bf16 v[220:223], v[20:23], v[108:111], v[220:223]
  v_rcp_f32 v251, v251
  v_fma_f32 v252, v252, s56, s56
  v_mfma_f32_16x16x32_bf16 v[220:223], v[124:127], v[180:183], v[220:223]
  v_fma_f32 v253, v253, s56, s56
  v_fma_f32 v254, v254, s56, s56
  v_mfma_f32_16x16x32_bf16 v[220:223], v[112:115], v[168:171], v[220:223]
  v_fma_f32 v255, v255, s56, s56
  v_rcp_f32 v252, v252
  v_mfma_f32_16x16x32_bf16 v[208:211], v[80:83], v[68:71], v[208:211]
  v_rcp_f32 v253, v253
  v_rcp_f32 v254, v254
  v_mfma_f32_16x16x32_bf16 v[208:211], v[44:47], v[116:119], v[208:211]
  v_rcp_f32 v255, v255
  v_mfma_f32_16x16x32_bf16 v[208:211], v[52:55], v[172:175], v[208:211]
  v_mul_f32 v192, v192, v248
  v_mul_f32 v193, v193, v249
  v_mfma_f32_16x16x32_bf16 v[208:211], v[40:43], v[160:163], v[208:211]
  v_mul_f32 v194, v194, v250
  v_mul_f32 v195, v195, v251
  v_cvt_pk_bf16_f32 v184, v192, v193
  v_mfma_f32_16x16x32_bf16 v[212:215], v[28:31], v[68:71], v[212:215]
  v_cvt_pk_bf16_f32 v185, v194, v195
  v_mul_f32 v196, v196, v252
  v_mfma_f32_16x16x32_bf16 v[212:215], v[96:99], v[116:119], v[212:215]
  v_mul_f32 v197, v197, v253
  v_mul_f32 v198, v198, v254
  v_mfma_f32_16x16x32_bf16 v[212:215], v[32:35], v[172:175], v[212:215]
  v_mul_f32 v199, v199, v255
  v_cvt_pk_bf16_f32 v186, v196, v197
  v_cvt_pk_bf16_f32 v187, v198, v199
  v_mfma_f32_16x16x32_bf16 v[212:215], v[244:247], v[160:163], v[212:215]
  buffer_store_dwordx4 v[184:187], v8, s[28:31], s49 offen offset:1152 sc1
  v_fma_f32 v200, v200, v224, v232
  s_waitcnt lgkmcnt(0)
  v_mfma_f32_16x16x32_bf16 v[216:219], v[80:83], v[92:95], v[216:219]
  v_fma_f32 v201, v201, v225, v233
  v_fma_f32 v202, v202, v226, v234
  v_mfma_f32_16x16x32_bf16 v[216:219], v[44:47], v[148:151], v[216:219]
  v_fma_f32 v203, v203, v227, v235
  v_exp_f32 v248, v200
  v_mfma_f32_16x16x32_bf16 v[216:219], v[52:55], v[88:91], v[216:219]
  v_exp_f32 v249, v201
  v_mfma_f32_16x16x32_bf16 v[216:219], v[40:43], v[132:135], v[216:219]
  v_exp_f32 v250, v202
  v_mfma_f32_16x16x32_bf16 v[216:219], v[72:75], v[16:19], v[216:219]
  v_exp_f32 v251, v203
  v_fma_f32 v204, v204, v228, v236
  v_mfma_f32_16x16x32_bf16 v[216:219], v[144:147], v[24:27], v[216:219]
  v_fma_f32 v205, v205, v229, v237
  v_fma_f32 v206, v206, v230, v238
  v_mfma_f32_16x16x32_bf16 v[220:223], v[28:31], v[92:95], v[220:223]
  v_fma_f32 v207, v207, v231, v239
  v_exp_f32 v252, v204
  v_mfma_f32_16x16x32_bf16 v[220:223], v[96:99], v[148:151], v[220:223]
  v_exp_f32 v253, v205
  v_exp_f32 v254, v206
  v_mfma_f32_16x16x32_bf16 v[220:223], v[32:35], v[88:91], v[220:223]
  v_exp_f32 v255, v207
  v_mfma_f32_16x16x32_bf16 v[220:223], v[244:247], v[132:135], v[220:223]
  v_fma_f32 v248, v248, s56, s56
  v_fma_f32 v249, v249, s56, s56
  v_mfma_f32_16x16x32_bf16 v[220:223], v[76:79], v[16:19], v[220:223]
  v_fma_f32 v250, v250, s56, s56
  v_fma_f32 v251, v251, s56, s56
  v_rcp_f32 v248, v248
  v_mfma_f32_16x16x32_bf16 v[220:223], v[56:59], v[24:27], v[220:223]
  v_rcp_f32 v249, v249
  v_rcp_f32 v250, v250
  v_rcp_f32 v251, v251
  v_pk_fma_f32 v[252:253], v[252:253], s[56:57], s[56:57]
  v_pk_fma_f32 v[254:255], v[254:255], s[56:57], s[56:57]
  v_rcp_f32 v252, v252
  v_rcp_f32 v253, v253
  v_rcp_f32 v254, v254
  v_rcp_f32 v255, v255
  v_pk_mul_f32 v[200:201], v[200:201], v[248:249]
  v_pk_mul_f32 v[202:203], v[202:203], v[250:251]
  v_cvt_pk_bf16_f32 v192, v200, v201
  v_cvt_pk_bf16_f32 v193, v202, v203
  v_pk_mul_f32 v[204:205], v[204:205], v[252:253]
  v_pk_mul_f32 v[206:207], v[206:207], v[254:255]
  v_cvt_pk_bf16_f32 v194, v204, v205
  v_cvt_pk_bf16_f32 v195, v206, v207
  buffer_store_dwordx4 v[192:195], v8, s[28:31], s49 offen offset:2304 sc1
  v_pk_fma_f32 v[208:209], v[208:209], v[224:225], v[232:233]
  v_pk_fma_f32 v[210:211], v[210:211], v[226:227], v[234:235]
  v_exp_f32 v248, v208
  v_exp_f32 v249, v209
  v_exp_f32 v250, v210
  v_exp_f32 v251, v211
  v_pk_fma_f32 v[212:213], v[212:213], v[228:229], v[236:237]
  v_pk_fma_f32 v[214:215], v[214:215], v[230:231], v[238:239]
  v_exp_f32 v252, v212
  v_exp_f32 v253, v213
  v_exp_f32 v254, v214
  v_exp_f32 v255, v215
  v_pk_fma_f32 v[248:249], v[248:249], s[56:57], s[56:57]
  v_pk_fma_f32 v[250:251], v[250:251], s[56:57], s[56:57]
  v_rcp_f32 v248, v248
  v_rcp_f32 v249, v249
  v_rcp_f32 v250, v250
  v_rcp_f32 v251, v251
  v_pk_fma_f32 v[252:253], v[252:253], s[56:57], s[56:57]
  v_pk_fma_f32 v[254:255], v[254:255], s[56:57], s[56:57]
  v_rcp_f32 v252, v252
  v_rcp_f32 v253, v253
  v_rcp_f32 v254, v254
  v_rcp_f32 v255, v255
  v_pk_mul_f32 v[208:209], v[208:209], v[248:249]
  v_pk_mul_f32 v[210:211], v[210:211], v[250:251]
  v_cvt_pk_bf16_f32 v200, v208, v209
  v_cvt_pk_bf16_f32 v201, v210, v211
  v_pk_mul_f32 v[212:213], v[212:213], v[252:253]
  v_pk_mul_f32 v[214:215], v[214:215], v[254:255]
  v_cvt_pk_bf16_f32 v202, v212, v213
  v_cvt_pk_bf16_f32 v203, v214, v215
  buffer_store_dwordx4 v[200:203], v8, s[28:31], s49 offen offset:3456 sc1
  v_pk_fma_f32 v[216:217], v[216:217], v[224:225], v[232:233]
  v_pk_fma_f32 v[218:219], v[218:219], v[226:227], v[234:235]
  v_exp_f32 v248, v216
  v_exp_f32 v249, v217
  v_exp_f32 v250, v218
  v_exp_f32 v251, v219
  v_pk_fma_f32 v[220:221], v[220:221], v[228:229], v[236:237]
  v_pk_fma_f32 v[222:223], v[222:223], v[230:231], v[238:239]
  v_exp_f32 v252, v220
  v_exp_f32 v253, v221
  v_exp_f32 v254, v222
  v_exp_f32 v255, v223
  v_pk_fma_f32 v[248:249], v[248:249], s[56:57], s[56:57]
  v_pk_fma_f32 v[250:251], v[250:251], s[56:57], s[56:57]
  v_rcp_f32 v248, v248
  v_rcp_f32 v249, v249
  v_rcp_f32 v250, v250
  v_rcp_f32 v251, v251
  v_pk_fma_f32 v[252:253], v[252:253], s[56:57], s[56:57]
  v_pk_fma_f32 v[254:255], v[254:255], s[56:57], s[56:57]
  v_rcp_f32 v252, v252
  v_rcp_f32 v253, v253
  v_rcp_f32 v254, v254
  v_rcp_f32 v255, v255
  v_pk_mul_f32 v[216:217], v[216:217], v[248:249]
  v_pk_mul_f32 v[218:219], v[218:219], v[250:251]
  v_cvt_pk_bf16_f32 v208, v216, v217
  v_cvt_pk_bf16_f32 v209, v218, v219
  v_pk_mul_f32 v[220:221], v[220:221], v[252:253]
  v_pk_mul_f32 v[222:223], v[222:223], v[254:255]
  v_cvt_pk_bf16_f32 v210, v220, v221
  v_cvt_pk_bf16_f32 v211, v222, v223
  buffer_store_dwordx4 v[208:211], v9, s[28:31], s50 offen sc1
  s_endpgm
L_ld_w:
  s_add_u32 m0, s58, 16384
  s_add_u32 s70, s48, 128
  buffer_load_dwordx4 v2, s[20:23], s70 offen lds
  s_add_u32 m0, s59, 16384
  s_add_u32 s70, s49, 128
  buffer_load_dwordx4 v2, s[20:23], s70 offen lds
  s_add_u32 m0, s60, 16384
  s_add_u32 s70, s50, 128
  buffer_load_dwordx4 v2, s[20:23], s70 offen lds
  s_add_u32 m0, s61, 16384
  s_add_u32 s70, s51, 128
  buffer_load_dwordx4 v2, s[20:23], s70 offen lds
  s_add_u32 m0, s66, 4864
  s_add_u32 s70, s63, 128
  buffer_load_dwordx4 v3, s[20:23], s70 offen lds
  s_add_u32 m0, s93, 0
  s_add_u32 s70, s74, 147456
  buffer_load_dwordx4 v4, s[24:27], s70 offen lds
  s_add_u32 m0, s100, 0
  s_add_u32 s70, s75, 147456
  buffer_load_dwordx4 v4, s[24:27], s70 offen lds
  s_add_u32 m0, s101, 0
  s_add_u32 s70, s92, 147456
  buffer_load_dwordx4 v4, s[24:27], s70 offen lds
  s_add_u32 m0, s93, 12384
  s_add_u32 s70, s74, 184320
  buffer_load_dwordx4 v4, s[24:27], s70 offen lds
  s_add_u32 m0, s100, 12384
  s_add_u32 s70, s75, 184320
  buffer_load_dwordx4 v4, s[24:27], s70 offen lds
  s_add_u32 m0, s101, 12384
  s_add_u32 s70, s92, 184320
  buffer_load_dwordx4 v4, s[24:27], s70 offen lds
  s_waitcnt vmcnt(13)
  s_barrier
  s_add_u32 m0, s52, 32768
  s_add_u32 s70, s44, 256
  buffer_load_dwordx4 v2, s[20:23], s70 offen lds
  s_add_u32 m0, s53, 32768
  s_add_u32 s70, s45, 256
  buffer_load_dwordx4 v2, s[20:23], s70 offen lds
  s_add_u32 m0, s54, 32768
  s_add_u32 s70, s46, 256
  buffer_load_dwordx4 v2, s[20:23], s70 offen lds
  s_add_u32 m0, s55, 32768
  s_add_u32 s70, s47, 256
  buffer_load_dwordx4 v2, s[20:23], s70 offen lds
  s_add_u32 m0, s58, 32768
  s_add_u32 s70, s48, 256
  buffer_load_dwordx4 v2, s[20:23], s70 offen lds
  s_add_u32 m0, s59, 32768
  s_add_u32 s70, s49, 256
  buffer_load_dwordx4 v2, s[20:23], s70 offen lds
  s_add_u32 m0, s60, 32768
  s_add_u32 s70, s50, 256
  buffer_load_dwordx4 v2, s[20:23], s70 offen lds
  s_add_u32 m0, s61, 32768
  s_add_u32 s70, s51, 256
  buffer_load_dwordx4 v2, s[20:23], s70 offen lds
  s_add_u32 m0, s66, 9728
  s_add_u32 s70, s63, 256
  buffer_load_dwordx4 v3, s[20:23], s70 offen lds
  global_load_short_d16_hi v20, v6, s[8:9]
  global_load_short_d16_hi v21, v6, s[10:11]
  s_waitcnt vmcnt(17)
  s_barrier
  s_add_u32 m0, s93, 24768
  s_add_u32 s70, s74, 221184
  buffer_load_dwordx4 v4, s[24:27], s70 offen lds
  s_add_u32 m0, s100, 24768
  s_add_u32 s70, s75, 221184
  buffer_load_dwordx4 v4, s[24:27], s70 offen lds
  s_add_u32 m0, s101, 24768
  s_add_u32 s70, s92, 221184
  buffer_load_dwordx4 v4, s[24:27], s70 offen lds
  s_add_u32 m0, s93, 37152
  s_add_u32 s70, s74, 258048
  buffer_load_dwordx4 v4, s[24:27], s70 offen lds
  s_add_u32 m0, s100, 37152
  s_add_u32 s70, s75, 258048
  buffer_load_dwordx4 v4, s[24:27], s70 offen lds
  s_add_u32 m0, s101, 37152
  s_add_u32 s70, s92, 258048
  buffer_load_dwordx4 v4, s[24:27], s70 offen lds
  s_waitcnt vmcnt(13)
  s_barrier
  s_add_u32 m0, s52, 0
  s_add_u32 s70, s44, 384
  buffer_load_dwordx4 v2, s[20:23], s70 offen lds
  s_add_u32 m0, s53, 0
  s_add_u32 s70, s45, 384
  buffer_load_dwordx4 v2, s[20:23], s70 offen lds
  s_add_u32 m0, s54, 0
  s_add_u32 s70, s46, 384
  buffer_load_dwordx4 v2, s[20:23], s70 offen lds
  s_add_u32 m0, s55, 0
  s_add_u32 s70, s47, 384
  buffer_load_dwordx4 v2, s[20:23], s70 offen lds
  s_add_u32 m0, s58, 0
  s_add_u32 s70, s48, 384
  buffer_load_dwordx4 v2, s[20:23], s70 offen lds
  s_add_u32 m0, s59, 0
  s_add_u32 s70, s49, 384
  buffer_load_dwordx4 v2, s[20:23], s70 offen lds
  s_add_u32 m0, s60, 0
  s_add_u32 s70, s50, 384
  buffer_load_dwordx4 v2, s[20:23], s70 offen lds
  s_add_u32 m0, s61, 0
  s_add_u32 s70, s51, 384
  buffer_load_dwordx4 v2, s[20:23], s70 offen lds
  s_add_u32 m0, s66, 0
  s_add_u32 s70, s63, 384
  buffer_load_dwordx4 v3, s[20:23], s70 offen lds
  s_waitcnt vmcnt(17)
  s_barrier
  s_add_u32 m0, s93, 0
  s_add_u32 s70, s74, 294912
  buffer_load_dwordx4 v4, s[24:27], s70 offen lds
  s_add_u32 m0, s100, 0
  s_add_u32 s70, s75, 294912
  buffer_load_dwordx4 v4, s[24:27], s70 offen lds
  s_add_u32 m0, s101, 0
  s_add_u32 s70, s92, 294912
  buffer_load_dwordx4 v4, s[24:27], s70 offen lds
  s_add_u32 m0, s93, 12384
  s_add_u32 s70, s74, 331776
  buffer_load_dwordx4 v4, s[24:27], s70 offen lds
  s_add_u32 m0, s100, 12384
  s_add_u32 s70, s75, 331776
  buffer_load_dwordx4 v4, s[24:27], s70 offen lds
  s_add_u32 m0, s101, 12384
  s_add_u32 s70, s92, 331776
  buffer_load_dwordx4 v4, s[24:27], s70 offen lds
  global_load_short_d16_hi v22, v6, s[12:13]
  global_load_short_d16_hi v23, v6, s[14:15]
  s_waitcnt vmcnt(13)
  s_barrier
  s_add_u32 m0, s52, 16384
  s_add_u32 s70, s44, 512
  buffer_load_dwordx4 v2, s[20:23], s70 offen lds
  s_add_u32 m0, s53, 16384
  s_add_u32 s70, s45, 512
  buffer_load_dwordx4 v2, s[20:23], s70 offen lds
  s_add_u32 m0, s54, 16384
  s_add_u32 s70, s46, 512
  buffer_load_dwordx4 v2, s[20:23], s70 offen lds
  s_add_u32 m0, s55, 16384
  s_add_u32 s70, s47, 512
  buffer_load_dwordx4 v2, s[20:23], s70 offen lds
  s_add_u32 m0, s58, 16384
  s_add_u32 s70, s48, 512
  buffer_load_dwordx4 v2, s[20:23], s70 offen lds
  s_add_u32 m0, s59, 16384
  s_add_u32 s70, s49, 512
  buffer_load_dwordx4 v2, s[20:23], s70 offen lds
  s_add_u32 m0, s60, 16384
  s_add_u32 s70, s50, 512
  buffer_load_dwordx4 v2, s[20:23], s70 offen lds
  s_add_u32 m0, s61, 16384
  s_add_u32 s70, s51, 512
  buffer_load_dwordx4 v2, s[20:23], s70 offen lds
  s_add_u32 m0, s66, 4864
  s_add_u32 s70, s63, 512
  buffer_load_dwordx4 v3, s[20:23], s70 offen lds
  s_waitcnt vmcnt(17)
  s_barrier
  s_add_u32 m0, s93, 24768
  s_add_u32 s70, s74, 368640
  buffer_load_dwordx4 v4, s[24:27], s70 offen lds
  s_add_u32 m0, s100, 24768
  s_add_u32 s70, s75, 368640
  buffer_load_dwordx4 v4, s[24:27], s70 offen lds
  s_add_u32 m0, s101, 24768
  s_add_u32 s70, s92, 368640
  buffer_load_dwordx4 v4, s[24:27], s70 offen lds
  s_add_u32 m0, s93, 37152
  s_add_u32 s70, s74, 405504
  buffer_load_dwordx4 v4, s[24:27], s70 offen lds
  s_add_u32 m0, s100, 37152
  s_add_u32 s70, s75, 405504
  buffer_load_dwordx4 v4, s[24:27], s70 offen lds
  s_add_u32 m0, s101, 37152
  s_add_u32 s70, s92, 405504
  buffer_load_dwordx4 v4, s[24:27], s70 offen lds
  s_waitcnt vmcnt(15)
  v_add_f32 v21, 0x3727c5ac, v21
  v_mul_f32 v22, s56, v22
  v_rsq_f32 v21, v21
  v_mul_f32 v23, s56, v23
  v_mul_f32 v21, v21, v22
  ds_write_b32 v7, v21
  v_fma_f32 v23, -v20, v21, v23
  ds_write_b32 v7, v23 offset:256
  s_waitcnt vmcnt(11)
  s_barrier
  s_add_u32 m0, s52, 32768
  s_add_u32 s70, s44, 640
  buffer_load_dwordx4 v2, s[20:23], s70 offen lds
  s_add_u32 m0, s53, 32768
  s_add_u32 s70, s45, 640
  buffer_load_dwordx4 v2, s[20:23], s70 offen lds
  s_add_u32 m0, s54, 32768
  s_add_u32 s70, s46, 640
  buffer_load_dwordx4 v2, s[20:23], s70 offen lds
  s_add_u32 m0, s55, 32768
  s_add_u32 s70, s47, 640
  buffer_load_dwordx4 v2, s[20:23], s70 offen lds
  s_add_u32 m0, s58, 32768
  s_add_u32 s70, s48, 640
  buffer_load_dwordx4 v2, s[20:23], s70 offen lds
  s_add_u32 m0, s59, 32768
  s_add_u32 s70, s49, 640
  buffer_load_dwordx4 v2, s[20:23], s70 offen lds
  s_add_u32 m0, s60, 32768
  s_add_u32 s70, s50, 640
  buffer_load_dwordx4 v2, s[20:23], s70 offen lds
  s_add_u32 m0, s61, 32768
  s_add_u32 s70, s51, 640
  buffer_load_dwordx4 v2, s[20:23], s70 offen lds
  s_add_u32 m0, s66, 9728
  s_add_u32 s70, s63, 640
  buffer_load_dwordx4 v3, s[20:23], s70 offen lds
  s_waitcnt vmcnt(15)
  s_barrier
  s_add_u32 m0, s93, 0
  s_add_u32 s70, s74, 442368
  buffer_load_dwordx4 v4, s[24:27], s70 offen lds
  s_add_u32 m0, s100, 0
  s_add_u32 s70, s75, 442368
  buffer_load_dwordx4 v4, s[24:27], s70 offen lds
  s_add_u32 m0, s101, 0
  s_add_u32 s70, s92, 442368
  buffer_load_dwordx4 v4, s[24:27], s70 offen lds
  s_add_u32 m0, s93, 12384
  s_add_u32 s70, s74, 479232
  buffer_load_dwordx4 v4, s[24:27], s70 offen lds
  s_add_u32 m0, s100, 12384
  s_add_u32 s70, s75, 479232
  buffer_load_dwordx4 v4, s[24:27], s70 offen lds
  s_add_u32 m0, s101, 12384
  s_add_u32 s70, s92, 479232
  buffer_load_dwordx4 v4, s[24:27], s70 offen lds
  global_load_dword v30, v18, s[96:97]
  s_waitcnt vmcnt(12)
  s_barrier
  s_add_u32 m0, s52, 0
  s_add_u32 s70, s44, 768
  buffer_load_dwordx4 v2, s[20:23], s70 offen lds
  s_add_u32 m0, s53, 0
  s_add_u32 s70, s45, 768
  buffer_load_dwordx4 v2, s[20:23], s70 offen lds
  s_add_u32 m0, s54, 0
  s_add_u32 s70, s46, 768
  buffer_load_dwordx4 v2, s[20:23], s70 offen lds
  s_add_u32 m0, s55, 0
  s_add_u32 s70, s47, 768
  buffer_load_dwordx4 v2, s[20:23], s70 offen lds
  s_add_u32 m0, s58, 0
  s_add_u32 s70, s48, 768
  buffer_load_dwordx4 v2, s[20:23], s70 offen lds
  s_add_u32 m0, s59, 0
  s_add_u32 s70, s49, 768
  buffer_load_dwordx4 v2, s[20:23], s70 offen lds
  s_add_u32 m0, s60, 0
  s_add_u32 s70, s50, 768
  buffer_load_dwordx4 v2, s[20:23], s70 offen lds
  s_add_u32 m0, s61, 0
  s_add_u32 s70, s51, 768
  buffer_load_dwordx4 v2, s[20:23], s70 offen lds
  s_add_u32 m0, s66, 0
  s_add_u32 s70, s63, 768
  buffer_load_dwordx4 v3, s[20:23], s70 offen lds
  s_waitcnt vmcnt(16)
  s_barrier
  s_add_u32 m0, s93, 24768
  s_add_u32 s70, s74, 516096
  buffer_load_dwordx4 v4, s[24:27], s70 offen lds
  s_add_u32 m0, s100, 24768
  s_add_u32 s70, s75, 516096
  buffer_load_dwordx4 v4, s[24:27], s70 offen lds
  s_add_u32 m0, s101, 24768
  s_add_u32 s70, s92, 516096
  buffer_load_dwordx4 v4, s[24:27], s70 offen lds
  s_add_u32 m0, s93, 37152
  s_add_u32 s70, s74, 552960
  buffer_load_dwordx4 v4, s[24:27], s70 offen lds
  s_add_u32 m0, s100, 37152
  s_add_u32 s70, s75, 552960
  buffer_load_dwordx4 v4, s[24:27], s70 offen lds
  s_add_u32 m0, s101, 37152
  s_add_u32 s70, s92, 552960
  buffer_load_dwordx4 v4, s[24:27], s70 offen lds
  s_waitcnt vmcnt(11)
  s_barrier
  s_add_u32 m0, s52, 16384
  s_add_u32 s70, s44, 896
  buffer_load_dwordx4 v2, s[20:23], s70 offen lds
  s_add_u32 m0, s53, 16384
  s_add_u32 s70, s45, 896
  buffer_load_dwordx4 v2, s[20:23], s70 offen lds
  s_add_u32 m0, s54, 16384
  s_add_u32 s70, s46, 896
  buffer_load_dwordx4 v2, s[20:23], s70 offen lds
  s_add_u32 m0, s55, 16384
  s_add_u32 s70, s47, 896
  buffer_load_dwordx4 v2, s[20:23], s70 offen lds
  s_add_u32 m0, s58, 16384
  s_add_u32 s70, s48, 896
  buffer_load_dwordx4 v2, s[20:23], s70 offen lds
  s_add_u32 m0, s59, 16384
  s_add_u32 s70, s49, 896
  buffer_load_dwordx4 v2, s[20:23], s70 offen lds
  s_add_u32 m0, s60, 16384
  s_add_u32 s70, s50, 896
  buffer_load_dwordx4 v2, s[20:23], s70 offen lds
  s_add_u32 m0, s61, 16384
  s_add_u32 s70, s51, 896
  buffer_load_dwordx4 v2, s[20:23], s70 offen lds
  s_add_u32 m0, s66, 4864
  s_add_u32 s70, s63, 896
  buffer_load_dwordx4 v3, s[20:23], s70 offen lds
  s_waitcnt vmcnt(15)
  s_barrier
  s_add_u32 m0, s52, 32768
  s_add_u32 s70, s44, 1024
  buffer_load_dwordx4 v2, s[20:23], s70 offen lds
  s_add_u32 m0, s53, 32768
  s_add_u32 s70, s45, 1024
  buffer_load_dwordx4 v2, s[20:23], s70 offen lds
  s_add_u32 m0, s54, 32768
  s_add_u32 s70, s46, 1024
  buffer_load_dwordx4 v2, s[20:23], s70 offen lds
  s_add_u32 m0, s55, 32768
  s_add_u32 s70, s47, 1024
  buffer_load_dwordx4 v2, s[20:23], s70 offen lds
  s_add_u32 m0, s93, 0
  s_add_u32 s70, s74, 589824
  buffer_load_dwordx4 v4, s[24:27], s70 offen lds
  s_add_u32 m0, s100, 0
  s_add_u32 s70, s75, 589824
  buffer_load_dwordx4 v4, s[24:27], s70 offen lds
  s_add_u32 m0, s101, 0
  s_add_u32 s70, s92, 589824
  buffer_load_dwordx4 v4, s[24:27], s70 offen lds
  s_add_u32 m0, s93, 12384
  s_add_u32 s70, s74, 626688
  buffer_load_dwordx4 v4, s[24:27], s70 offen lds
  s_add_u32 m0, s100, 12384
  s_add_u32 s70, s75, 626688
  buffer_load_dwordx4 v4, s[24:27], s70 offen lds
  s_add_u32 m0, s101, 12384
  s_add_u32 s70, s92, 626688
  buffer_load_dwordx4 v4, s[24:27], s70 offen lds
  s_waitcnt vmcnt(15) lgkmcnt(0)
  s_barrier
  s_add_u32 m0, s58, 32768
  s_add_u32 s70, s48, 1024
  buffer_load_dwordx4 v2, s[20:23], s70 offen lds
  s_add_u32 m0, s59, 32768
  s_add_u32 s70, s49, 1024
  buffer_load_dwordx4 v2, s[20:23], s70 offen lds
  s_add_u32 m0, s60, 32768
  s_add_u32 s70, s50, 1024
  buffer_load_dwordx4 v2, s[20:23], s70 offen lds
  s_add_u32 m0, s61, 32768
  s_add_u32 s70, s51, 1024
  buffer_load_dwordx4 v2, s[20:23], s70 offen lds
  s_add_u32 m0, s66, 9728
  s_add_u32 s70, s63, 1024
  buffer_load_dwordx4 v3, s[20:23], s70 offen lds
  s_waitcnt vmcnt(5)
  s_barrier
  s_waitcnt vmcnt(15)
  s_barrier
  s_waitcnt vmcnt(0)
  s_barrier
  s_endpgm
.fill ((0 - (. - L_base)) & 4095) / 4, 4, 0xbf810000
L_sp_ld:
  v_lshrrev_b32 v13, 1, v0
  v_bfe_u32 v14, v0, 4, 1
  v_lshlrev_b32 v14, 2, v14
  v_xor_b32 v13, v13, v14
  v_mul_u32_u24 v13, 1152, v13
  v_and_b32 v14, 1, v0
  v_lshl_add_u32 v5, v14, 4, v13
  s_mul_i32 s68, s41, 663552
  s_lshl_b32 s46, s36, 5
  s_add_u32 s46, s46, 1024
  s_add_u32 s68, s68, s46
  s_lshl_b32 s69, s41, 10
  s_add_u32 s69, s69, 73920
  s_cmp_eq_u32 s41, 3
  s_cselect_b32 s69, 160512, s69
  s_cselect_b32 s72, 0, 27840
  s_cselect_b32 s47, 0x40000000, 0
  v_add_u32 v5, s47, v5
  s_add_u32 m0, s65, 6144
  s_add_u32 s70, s62, 3456
  buffer_load_dwordx4 v2, s[20:23], s70 offen lds
  s_add_u32 m0, s67, 16512
  s_add_u32 s70, s64, 663680
  buffer_load_dwordx4 v4, s[24:27], s70 offen lds
  s_add_u32 m0, s67, 20640
  s_add_u32 s70, s64, 1327232
  buffer_load_dwordx4 v4, s[24:27], s70 offen lds
  s_add_u32 m0, s67, 12384
  s_add_u32 s70, s64, 128
  buffer_load_dwordx4 v4, s[24:27], s70 offen lds
  s_mul_i32 s71, s72, 0
  s_add_u32 m0, s69, s71
  s_add_u32 s70, s68, 0
  buffer_load_dwordx4 v5, s[24:27], s70 offen lds
  s_add_u32 m0, s67, 31968
  s_add_u32 s70, s64, 700416
  buffer_load_dwordx4 v4, s[24:27], s70 offen lds
  s_add_u32 m0, s67, 44352
  s_add_u32 s70, s64, 700544
  buffer_load_dwordx4 v4, s[24:27], s70 offen lds
  s_add_u32 m0, s67, 36096
  s_add_u32 s70, s64, 1363968
  buffer_load_dwordx4 v4, s[24:27], s70 offen lds
  s_add_u32 m0, s67, 48480
  s_add_u32 s70, s64, 1364096
  buffer_load_dwordx4 v4, s[24:27], s70 offen lds
  s_add_u32 m0, s67, 27840
  s_add_u32 s70, s64, 36864
  buffer_load_dwordx4 v4, s[24:27], s70 offen lds
  s_add_u32 m0, s67, 40224
  s_add_u32 s70, s64, 36992
  buffer_load_dwordx4 v4, s[24:27], s70 offen lds
  s_mul_i32 s71, s72, 1
  s_add_u32 m0, s69, s71
  s_add_u32 s70, s68, 36864
  buffer_load_dwordx4 v5, s[24:27], s70 offen lds
  s_add_u32 m0, s65, 16384
  s_add_u32 s70, s62, 128
  buffer_load_dwordx4 v2, s[20:23], s70 offen lds
  s_add_u32 m0, s65, 18432
  s_add_u32 s70, s62, 1280
  buffer_load_dwordx4 v2, s[20:23], s70 offen lds
  s_lshl_b32 s47, s42, 7
  s_add_u32 s47, s47, s45
  s_cmp_ge_u32 s41, 2
  s_cselect_b32 s47, s46, s47
  v_lshl_add_u32 v6, v0, 1, s47
  v_min_u32 v6, 1150, v6
  v_mov_b32 v20, 0
  v_mov_b32 v21, 0
  v_mov_b32 v22, 0
  v_mov_b32 v23, 0
  s_min_u32 s47, s41, 2
  s_lshl_b32 s47, s47, 9
  s_add_u32 s47, s47, 161536
  v_lshl_add_u32 v7, v0, 2, s47
  s_waitcnt vmcnt(9)
  s_barrier
  s_add_u32 m0, s67, 59808
  s_add_u32 s70, s64, 737280
  buffer_load_dwordx4 v4, s[24:27], s70 offen lds
  s_add_u32 m0, s67, 72192
  s_add_u32 s70, s64, 737408
  buffer_load_dwordx4 v4, s[24:27], s70 offen lds
  s_add_u32 m0, s67, 63936
  s_add_u32 s70, s64, 1400832
  buffer_load_dwordx4 v4, s[24:27], s70 offen lds
  s_add_u32 m0, s67, 76320
  s_add_u32 s70, s64, 1400960
  buffer_load_dwordx4 v4, s[24:27], s70 offen lds
  s_add_u32 m0, s67, 55680
  s_add_u32 s70, s64, 73728
  buffer_load_dwordx4 v4, s[24:27], s70 offen lds
  s_add_u32 m0, s67, 68064
  s_add_u32 s70, s64, 73856
  buffer_load_dwordx4 v4, s[24:27], s70 offen lds
  s_mul_i32 s71, s72, 2
  s_add_u32 m0, s69, s71
  s_add_u32 s70, s68, 73728
  buffer_load_dwordx4 v5, s[24:27], s70 offen lds
  s_add_u32 m0, s65, 20480
  s_add_u32 s70, s62, 2432
  buffer_load_dwordx4 v2, s[20:23], s70 offen lds
  s_add_u32 m0, s65, 22528
  s_add_u32 s70, s62, 3584
  buffer_load_dwordx4 v2, s[20:23], s70 offen lds
  s_waitcnt vmcnt(11)
  s_barrier
  s_add_u32 m0, s67, 87648
  s_add_u32 s70, s64, 774144
  buffer_load_dwordx4 v4, s[24:27], s70 offen lds
  s_add_u32 m0, s67, 100032
  s_add_u32 s70, s64, 774272
  buffer_load_dwordx4 v4, s[24:27], s70 offen lds
  s_add_u32 m0, s67, 91776
  s_add_u32 s70, s64, 1437696
  buffer_load_dwordx4 v4, s[24:27], s70 offen lds
  s_add_u32 m0, s67, 104160
  s_add_u32 s70, s64, 1437824
  buffer_load_dwordx4 v4, s[24:27], s70 offen lds
  s_add_u32 m0, s67, 83520
  s_add_u32 s70, s64, 110592
  buffer_load_dwordx4 v4, s[24:27], s70 offen lds
  s_add_u32 m0, s67, 95904
  s_add_u32 s70, s64, 110720
  buffer_load_dwordx4 v4, s[24:27], s70 offen lds
  s_mul_i32 s71, s72, 3
  s_add_u32 m0, s69, s71
  s_add_u32 s70, s68, 110592
  buffer_load_dwordx4 v5, s[24:27], s70 offen lds
  s_add_u32 m0, s65, 32768
  s_add_u32 s70, s62, 256
  buffer_load_dwordx4 v2, s[20:23], s70 offen lds
  s_add_u32 m0, s65, 34816
  s_add_u32 s70, s62, 1408
  buffer_load_dwordx4 v2, s[20:23], s70 offen lds
  s_waitcnt vmcnt(9)
  s_barrier
  s_add_u32 m0, s67, 4128
  s_add_u32 s70, s64, 811008
  buffer_load_dwordx4 v4, s[24:27], s70 offen lds
  s_add_u32 m0, s67, 16512
  s_add_u32 s70, s64, 811136
  buffer_load_dwordx4 v4, s[24:27], s70 offen lds
  s_add_u32 m0, s67, 8256
  s_add_u32 s70, s64, 1474560
  buffer_load_dwordx4 v4, s[24:27], s70 offen lds
  s_add_u32 m0, s67, 20640
  s_add_u32 s70, s64, 1474688
  buffer_load_dwordx4 v4, s[24:27], s70 offen lds
  s_add_u32 m0, s67, 0
  s_add_u32 s70, s64, 147456
  buffer_load_dwordx4 v4, s[24:27], s70 offen lds
  s_add_u32 m0, s67, 12384
  s_add_u32 s70, s64, 147584
  buffer_load_dwordx4 v4, s[24:27], s70 offen lds
  s_mul_i32 s71, s72, 0
  s_add_u32 m0, s69, s71
  s_add_u32 s70, s68, 147456
  buffer_load_dwordx4 v5, s[24:27], s70 offen lds
  s_add_u32 m0, s65, 36864
  s_add_u32 s70, s62, 2560
  buffer_load_dwordx4 v2, s[20:23], s70 offen lds
  s_add_u32 m0, s65, 38912
  s_add_u32 s70, s62, 3712
  buffer_load_dwordx4 v2, s[20:23], s70 offen lds
  s_waitcnt vmcnt(11)
  s_barrier
  s_add_u32 m0, s67, 31968
  s_add_u32 s70, s64, 847872
  buffer_load_dwordx4 v4, s[24:27], s70 offen lds
  s_add_u32 m0, s67, 44352
  s_add_u32 s70, s64, 848000
  buffer_load_dwordx4 v4, s[24:27], s70 offen lds
  s_add_u32 m0, s67, 36096
  s_add_u32 s70, s64, 1511424
  buffer_load_dwordx4 v4, s[24:27], s70 offen lds
  s_add_u32 m0, s67, 48480
  s_add_u32 s70, s64, 1511552
  buffer_load_dwordx4 v4, s[24:27], s70 offen lds
  s_add_u32 m0, s67, 27840
  s_add_u32 s70, s64, 184320
  buffer_load_dwordx4 v4, s[24:27], s70 offen lds
  s_add_u32 m0, s67, 40224
  s_add_u32 s70, s64, 184448
  buffer_load_dwordx4 v4, s[24:27], s70 offen lds
  s_mul_i32 s71, s72, 1
  s_add_u32 m0, s69, s71
  s_add_u32 s70, s68, 184320
  buffer_load_dwordx4 v5, s[24:27], s70 offen lds
  s_add_u32 m0, s65, 0
  s_add_u32 s70, s62, 384
  buffer_load_dwordx4 v2, s[20:23], s70 offen lds
  s_add_u32 m0, s65, 2048
  s_add_u32 s70, s62, 1536
  buffer_load_dwordx4 v2, s[20:23], s70 offen lds
  global_load_short_d16_hi v20, v6, s[8:9]
  global_load_short_d16_hi v21, v6, s[10:11]
  global_load_short_d16_hi v22, v6, s[12:13]
  global_load_short_d16_hi v23, v6, s[14:15]
  s_waitcnt vmcnt(13)
  s_barrier
  s_add_u32 m0, s67, 59808
  s_add_u32 s70, s64, 884736
  buffer_load_dwordx4 v4, s[24:27], s70 offen lds
  s_add_u32 m0, s67, 72192
  s_add_u32 s70, s64, 884864
  buffer_load_dwordx4 v4, s[24:27], s70 offen lds
  s_add_u32 m0, s67, 63936
  s_add_u32 s70, s64, 1548288
  buffer_load_dwordx4 v4, s[24:27], s70 offen lds
  s_add_u32 m0, s67, 76320
  s_add_u32 s70, s64, 1548416
  buffer_load_dwordx4 v4, s[24:27], s70 offen lds
  s_add_u32 m0, s67, 55680
  s_add_u32 s70, s64, 221184
  buffer_load_dwordx4 v4, s[24:27], s70 offen lds
  s_add_u32 m0, s67, 68064
  s_add_u32 s70, s64, 221312
  buffer_load_dwordx4 v4, s[24:27], s70 offen lds
  s_mul_i32 s71, s72, 2
  s_add_u32 m0, s69, s71
  s_add_u32 s70, s68, 221184
  buffer_load_dwordx4 v5, s[24:27], s70 offen lds
  s_add_u32 m0, s65, 4096
  s_add_u32 s70, s62, 2688
  buffer_load_dwordx4 v2, s[20:23], s70 offen lds
  s_add_u32 m0, s65, 6144
  s_add_u32 s70, s62, 3840
  buffer_load_dwordx4 v2, s[20:23], s70 offen lds
  s_waitcnt vmcnt(15)
  s_barrier
  s_add_u32 m0, s67, 87648
  s_add_u32 s70, s64, 921600
  buffer_load_dwordx4 v4, s[24:27], s70 offen lds
  s_add_u32 m0, s67, 100032
  s_add_u32 s70, s64, 921728
  buffer_load_dwordx4 v4, s[24:27], s70 offen lds
  s_add_u32 m0, s67, 91776
  s_add_u32 s70, s64, 1585152
  buffer_load_dwordx4 v4, s[24:27], s70 offen lds
  s_add_u32 m0, s67, 104160
  s_add_u32 s70, s64, 1585280
  buffer_load_dwordx4 v4, s[24:27], s70 offen lds
  s_add_u32 m0, s67, 83520
  s_add_u32 s70, s64, 258048
  buffer_load_dwordx4 v4, s[24:27], s70 offen lds
  s_add_u32 m0, s67, 95904
  s_add_u32 s70, s64, 258176
  buffer_load_dwordx4 v4, s[24:27], s70 offen lds
  s_mul_i32 s71, s72, 3
  s_add_u32 m0, s69, s71
  s_add_u32 s70, s68, 258048
  buffer_load_dwordx4 v5, s[24:27], s70 offen lds
  s_add_u32 m0, s65, 16384
  s_add_u32 s70, s62, 512
  buffer_load_dwordx4 v2, s[20:23], s70 offen lds
  s_add_u32 m0, s65, 18432
  s_add_u32 s70, s62, 1664
  buffer_load_dwordx4 v2, s[20:23], s70 offen lds
  s_waitcnt vmcnt(9)
  s_barrier
  s_add_u32 m0, s67, 4128
  s_add_u32 s70, s64, 958464
  buffer_load_dwordx4 v4, s[24:27], s70 offen lds
  s_add_u32 m0, s67, 16512
  s_add_u32 s70, s64, 958592
  buffer_load_dwordx4 v4, s[24:27], s70 offen lds
  s_add_u32 m0, s67, 8256
  s_add_u32 s70, s64, 1622016
  buffer_load_dwordx4 v4, s[24:27], s70 offen lds
  s_add_u32 m0, s67, 20640
  s_add_u32 s70, s64, 1622144
  buffer_load_dwordx4 v4, s[24:27], s70 offen lds
  s_add_u32 m0, s67, 0
  s_add_u32 s70, s64, 294912
  buffer_load_dwordx4 v4, s[24:27], s70 offen lds
  s_add_u32 m0, s67, 12384
  s_add_u32 s70, s64, 295040
  buffer_load_dwordx4 v4, s[24:27], s70 offen lds
  s_mul_i32 s71, s72, 0
  s_add_u32 m0, s69, s71
  s_add_u32 s70, s68, 294912
  buffer_load_dwordx4 v5, s[24:27], s70 offen lds
  s_add_u32 m0, s65, 20480
  s_add_u32 s70, s62, 2816
  buffer_load_dwordx4 v2, s[20:23], s70 offen lds
  s_add_u32 m0, s65, 22528
  s_add_u32 s70, s62, 3968
  buffer_load_dwordx4 v2, s[20:23], s70 offen lds
  s_add_u32 m0, s67, 31968
  s_add_u32 s70, s64, 995328
  buffer_load_dwordx4 v4, s[24:27], s70 offen lds
  s_waitcnt vmcnt(12)
  s_barrier
  s_add_u32 m0, s67, 44352
  s_add_u32 s70, s64, 995456
  buffer_load_dwordx4 v4, s[24:27], s70 offen lds
  s_add_u32 m0, s67, 36096
  s_add_u32 s70, s64, 1658880
  buffer_load_dwordx4 v4, s[24:27], s70 offen lds
  s_add_u32 m0, s67, 48480
  s_add_u32 s70, s64, 1659008
  buffer_load_dwordx4 v4, s[24:27], s70 offen lds
  s_add_u32 m0, s67, 27840
  s_add_u32 s70, s64, 331776
  buffer_load_dwordx4 v4, s[24:27], s70 offen lds
  s_add_u32 m0, s67, 40224
  s_add_u32 s70, s64, 331904
  buffer_load_dwordx4 v4, s[24:27], s70 offen lds
  s_mul_i32 s71, s72, 1
  s_add_u32 m0, s69, s71
  s_add_u32 s70, s68, 331776
  buffer_load_dwordx4 v5, s[24:27], s70 offen lds
  s_add_u32 m0, s65, 32768
  s_add_u32 s70, s62, 640
  buffer_load_dwordx4 v2, s[20:23], s70 offen lds
  s_add_u32 m0, s65, 34816
  s_add_u32 s70, s62, 1792
  buffer_load_dwordx4 v2, s[20:23], s70 offen lds
  s_add_u32 m0, s67, 59808
  s_add_u32 s70, s64, 1032192
  buffer_load_dwordx4 v4, s[24:27], s70 offen lds
  s_add_u32 m0, s67, 72192
  s_add_u32 s70, s64, 1032320
  buffer_load_dwordx4 v4, s[24:27], s70 offen lds
  s_waitcnt vmcnt(38)
  v_add_f32 v21, 0x3727c5ac, v21
  v_mul_f32 v22, s56, v22
  v_rsq_f32 v21, v21
  v_mul_f32 v23, s56, v23
  v_mul_f32 v21, v21, v22
  ds_write_b32 v7, v21
  v_fma_f32 v23, -v20, v21, v23
  ds_write_b32 v7, v23 offset:256
  s_waitcnt lgkmcnt(0)
  s_waitcnt vmcnt(11)
  s_barrier
  s_add_u32 m0, s67, 63936
  s_add_u32 s70, s64, 1695744
  buffer_load_dwordx4 v4, s[24:27], s70 offen lds
  s_add_u32 m0, s67, 76320
  s_add_u32 s70, s64, 1695872
  buffer_load_dwordx4 v4, s[24:27], s70 offen lds
  s_add_u32 m0, s67, 55680
  s_add_u32 s70, s64, 368640
  buffer_load_dwordx4 v4, s[24:27], s70 offen lds
  s_add_u32 m0, s67, 68064
  s_add_u32 s70, s64, 368768
  buffer_load_dwordx4 v4, s[24:27], s70 offen lds
  s_mul_i32 s71, s72, 2
  s_add_u32 m0, s69, s71
  s_add_u32 s70, s68, 368640
  buffer_load_dwordx4 v5, s[24:27], s70 offen lds
  s_add_u32 m0, s65, 36864
  s_add_u32 s70, s62, 2944
  buffer_load_dwordx4 v2, s[20:23], s70 offen lds
  s_add_u32 m0, s65, 38912
  s_add_u32 s70, s62, 4096
  buffer_load_dwordx4 v2, s[20:23], s70 offen lds
  s_add_u32 m0, s67, 87648
  s_add_u32 s70, s64, 1069056
  buffer_load_dwordx4 v4, s[24:27], s70 offen lds
  s_add_u32 m0, s67, 100032
  s_add_u32 s70, s64, 1069184
  buffer_load_dwordx4 v4, s[24:27], s70 offen lds
  s_add_u32 m0, s67, 91776
  s_add_u32 s70, s64, 1732608
  buffer_load_dwordx4 v4, s[24:27], s70 offen lds
  s_waitcnt vmcnt(14)
  s_barrier
  s_add_u32 m0, s67, 104160
  s_add_u32 s70, s64, 1732736
  buffer_load_dwordx4 v4, s[24:27], s70 offen lds
  s_add_u32 m0, s67, 83520
  s_add_u32 s70, s64, 405504
  buffer_load_dwordx4 v4, s[24:27], s70 offen lds
  s_add_u32 m0, s67, 95904
  s_add_u32 s70, s64, 405632
  buffer_load_dwordx4 v4, s[24:27], s70 offen lds
  s_mul_i32 s71, s72, 3
  s_add_u32 m0, s69, s71
  s_add_u32 s70, s68, 405504
  buffer_load_dwordx4 v5, s[24:27], s70 offen lds
  s_add_u32 m0, s65, 0
  s_add_u32 s70, s62, 768
  buffer_load_dwordx4 v2, s[20:23], s70 offen lds
  s_add_u32 m0, s65, 2048
  s_add_u32 s70, s62, 1920
  buffer_load_dwordx4 v2, s[20:23], s70 offen lds
  s_add_u32 m0, s67, 4128
  s_add_u32 s70, s64, 1105920
  buffer_load_dwordx4 v4, s[24:27], s70 offen lds
  s_add_u32 m0, s67, 16512
  s_add_u32 s70, s64, 1106048
  buffer_load_dwordx4 v4, s[24:27], s70 offen lds
  s_add_u32 m0, s67, 8256
  s_add_u32 s70, s64, 1769472
  buffer_load_dwordx4 v4, s[24:27], s70 offen lds
  s_add_u32 m0, s67, 20640
  s_add_u32 s70, s64, 1769600
  buffer_load_dwordx4 v4, s[24:27], s70 offen lds
  s_waitcnt vmcnt(13)
  s_barrier
  s_add_u32 m0, s67, 0
  s_add_u32 s70, s64, 442368
  buffer_load_dwordx4 v4, s[24:27], s70 offen lds
  s_add_u32 m0, s67, 12384
  s_add_u32 s70, s64, 442496
  buffer_load_dwordx4 v4, s[24:27], s70 offen lds
  s_mul_i32 s71, s72, 0
  s_add_u32 m0, s69, s71
  s_add_u32 s70, s68, 442368
  buffer_load_dwordx4 v5, s[24:27], s70 offen lds
  s_add_u32 m0, s65, 4096
  s_add_u32 s70, s62, 3072
  buffer_load_dwordx4 v2, s[20:23], s70 offen lds
  s_add_u32 m0, s65, 6144
  s_add_u32 s70, s62, 4224
  buffer_load_dwordx4 v2, s[20:23], s70 offen lds
  s_add_u32 m0, s67, 31968
  s_add_u32 s70, s64, 1142784
  buffer_load_dwordx4 v4, s[24:27], s70 offen lds
  s_add_u32 m0, s67, 44352
  s_add_u32 s70, s64, 1142912
  buffer_load_dwordx4 v4, s[24:27], s70 offen lds
  s_add_u32 m0, s67, 36096
  s_add_u32 s70, s64, 1806336
  buffer_load_dwordx4 v4, s[24:27], s70 offen lds
  s_add_u32 m0, s67, 48480
  s_add_u32 s70, s64, 1806464
  buffer_load_dwordx4 v4, s[24:27], s70 offen lds
  s_add_u32 m0, s67, 27840
  s_add_u32 s70, s64, 479232
  buffer_load_dwordx4 v4, s[24:27], s70 offen lds
  s_waitcnt vmcnt(16)
  s_barrier
  s_add_u32 m0, s67, 40224
  s_add_u32 s70, s64, 479360
  buffer_load_dwordx4 v4, s[24:27], s70 offen lds
  s_mul_i32 s71, s72, 1
  s_add_u32 m0, s69, s71
  s_add_u32 s70, s68, 479232
  buffer_load_dwordx4 v5, s[24:27], s70 offen lds
  s_add_u32 m0, s65, 16384
  s_add_u32 s70, s62, 896
  buffer_load_dwordx4 v2, s[20:23], s70 offen lds
  s_add_u32 m0, s65, 18432
  s_add_u32 s70, s62, 2048
  buffer_load_dwordx4 v2, s[20:23], s70 offen lds
  s_add_u32 m0, s67, 59808
  s_add_u32 s70, s64, 1179648
  buffer_load_dwordx4 v4, s[24:27], s70 offen lds
  s_add_u32 m0, s67, 72192
  s_add_u32 s70, s64, 1179776
  buffer_load_dwordx4 v4, s[24:27], s70 offen lds
  s_add_u32 m0, s67, 63936
  s_add_u32 s70, s64, 1843200
  buffer_load_dwordx4 v4, s[24:27], s70 offen lds
  s_add_u32 m0, s67, 76320
  s_add_u32 s70, s64, 1843328
  buffer_load_dwordx4 v4, s[24:27], s70 offen lds
  s_add_u32 m0, s67, 55680
  s_add_u32 s70, s64, 516096
  buffer_load_dwordx4 v4, s[24:27], s70 offen lds
  s_add_u32 m0, s67, 68064
  s_add_u32 s70, s64, 516224
  buffer_load_dwordx4 v4, s[24:27], s70 offen lds
  s_waitcnt vmcnt(15)
  s_barrier
  s_mul_i32 s71, s72, 2
  s_add_u32 m0, s69, s71
  s_add_u32 s70, s68, 516096
  buffer_load_dwordx4 v5, s[24:27], s70 offen lds
  s_add_u32 m0, s65, 20480
  s_add_u32 s70, s62, 3200
  buffer_load_dwordx4 v2, s[20:23], s70 offen lds
  s_add_u32 m0, s65, 22528
  s_add_u32 s70, s62, 4352
  buffer_load_dwordx4 v2, s[20:23], s70 offen lds
  s_add_u32 m0, s67, 87648
  s_add_u32 s70, s64, 1216512
  buffer_load_dwordx4 v4, s[24:27], s70 offen lds
  s_add_u32 m0, s67, 100032
  s_add_u32 s70, s64, 1216640
  buffer_load_dwordx4 v4, s[24:27], s70 offen lds
  s_add_u32 m0, s67, 91776
  s_add_u32 s70, s64, 1880064
  buffer_load_dwordx4 v4, s[24:27], s70 offen lds
  s_add_u32 m0, s67, 104160
  s_add_u32 s70, s64, 1880192
  buffer_load_dwordx4 v4, s[24:27], s70 offen lds
  s_add_u32 m0, s67, 83520
  s_add_u32 s70, s64, 552960
  buffer_load_dwordx4 v4, s[24:27], s70 offen lds
  s_add_u32 m0, s67, 95904
  s_add_u32 s70, s64, 553088
  buffer_load_dwordx4 v4, s[24:27], s70 offen lds
  s_mul_i32 s71, s72, 3
  s_add_u32 m0, s69, s71
  s_add_u32 s70, s68, 552960
  buffer_load_dwordx4 v5, s[24:27], s70 offen lds
  s_waitcnt vmcnt(18)
  s_barrier
  s_add_u32 m0, s65, 32768
  s_add_u32 s70, s62, 1024
  buffer_load_dwordx4 v2, s[20:23], s70 offen lds
  s_add_u32 m0, s65, 34816
  s_add_u32 s70, s62, 2176
  buffer_load_dwordx4 v2, s[20:23], s70 offen lds
  s_add_u32 m0, s65, 36864
  s_add_u32 s70, s62, 3328
  buffer_load_dwordx4 v2, s[20:23], s70 offen lds
  s_add_u32 m0, s65, 38912
  s_add_u32 s70, s62, 4480
  buffer_load_dwordx4 v2, s[20:23], s70 offen lds
  s_add_u32 m0, s67, 4128
  s_add_u32 s70, s64, 1253376
  buffer_load_dwordx4 v4, s[24:27], s70 offen lds
  s_add_u32 m0, s67, 16512
  s_add_u32 s70, s64, 1253504
  buffer_load_dwordx4 v4, s[24:27], s70 offen lds
  s_add_u32 m0, s67, 8256
  s_add_u32 s70, s64, 1916928
  buffer_load_dwordx4 v4, s[24:27], s70 offen lds
  s_add_u32 m0, s67, 20640
  s_add_u32 s70, s64, 1917056
  buffer_load_dwordx4 v4, s[24:27], s70 offen lds
  s_add_u32 m0, s67, 0
  s_add_u32 s70, s64, 589824
  buffer_load_dwordx4 v4, s[24:27], s70 offen lds
  s_add_u32 m0, s67, 12384
  s_add_u32 s70, s64, 589952
  buffer_load_dwordx4 v4, s[24:27], s70 offen lds
  s_mul_i32 s71, s72, 0
  s_add_u32 m0, s69, s71
  s_add_u32 s70, s68, 589824
  buffer_load_dwordx4 v5, s[24:27], s70 offen lds
  s_waitcnt vmcnt(18)
  s_barrier
  s_add_u32 m0, s67, 31968
  s_add_u32 s70, s64, 1290240
  buffer_load_dwordx4 v4, s[24:27], s70 offen lds
  s_add_u32 m0, s67, 44352
  s_add_u32 s70, s64, 1290368
  buffer_load_dwordx4 v4, s[24:27], s70 offen lds
  s_add_u32 m0, s67, 36096
  s_add_u32 s70, s64, 1953792
  buffer_load_dwordx4 v4, s[24:27], s70 offen lds
  s_add_u32 m0, s67, 48480
  s_add_u32 s70, s64, 1953920
  buffer_load_dwordx4 v4, s[24:27], s70 offen lds
  s_add_u32 m0, s67, 27840
  s_add_u32 s70, s64, 626688
  buffer_load_dwordx4 v4, s[24:27], s70 offen lds
  s_add_u32 m0, s67, 40224
  s_add_u32 s70, s64, 626816
  buffer_load_dwordx4 v4, s[24:27], s70 offen lds
  s_mul_i32 s71, s72, 1
  s_add_u32 m0, s69, s71
  s_add_u32 s70, s68, 626688
  buffer_load_dwordx4 v5, s[24:27], s70 offen lds
  s_waitcnt vmcnt(18)
  s_barrier
  s_waitcnt vmcnt(7)
  s_barrier
  s_waitcnt vmcnt(0)
  s_barrier
  s_endpgm
.fill ((460 - (. - L_base)) & 4095) / 4, 4, 0xbf810000
L_sp_comp:
  s_lshr_b32 s41, s33, 1
  s_and_b32 s42, s33, 1
  v_and_b32 v60, 15, v0
  v_lshrrev_b32 v61, 4, v0
  s_add_u32 s39, s39, s41
  s_lshl_b32 s43, s39, 7
  s_lshl_b32 s44, s42, 6
  s_add_u32 s43, s43, s44
  s_lshl_b32 s44, s42, 7
  s_add_u32 s44, s44, 161536
  s_lshl_b32 s45, s41, 9
  s_add_u32 s44, s44, s45
  v_lshlrev_b32 v11, 4, v61
  v_add_u32 v11, 162560, v11
  v_lshl_add_u32 v10, v61, 5, s44
  v_and_b32 v62, 1, v61
  v_lshrrev_b32 v63, 1, v61
  v_mul_u32_u24 v8, 9216, v60
  v_lshl_add_u32 v8, v63, 4, v8
  v_mul_u32_u24 v64, 1152, v62
  v_add_u32 v9, v8, v64
  v_lshl_add_u32 v8, v62, 5, v8
  s_add_u32 s48, s40, s43
  s_mul_i32 s44, s33, 2304
  s_add_u32 s50, s40, s44
  s_lshl_b32 s44, s36, 5
  s_add_u32 s50, s50, s44
  s_add_u32 s50, s50, 1024
  v_mul_u32_u24 v8, 9216, v60
  v_lshl_add_u32 v8, v61, 4, v8
  s_add_u32 s49, s48, 4608
  v_lshrrev_b32 v64, 1, v60
  v_xor_b32 v64, v64, v61
  v_lshlrev_b32 v64, 4, v64
  v_lshl_add_u32 v2, v60, 7, v64
  v_xor_b32 v1, 64, v2
  v_lshrrev_b32 v64, 2, v60
  v_and_b32 v65, 3, v60
  v_lshl_add_u32 v66, v61, 3, v64
  v_and_b32 v67, 2, v64
  v_lshlrev_b32 v67, 1, v67
  s_lshl_b32 s44, s42, 2
  v_add_u32 v68, s44, v65
  v_xor_b32 v68, v68, v67
  v_mul_u32_u24 v69, 1032, v61
  v_lshl_add_u32 v69, v64, 7, v69
  v_lshl_add_u32 v69, v68, 4, v69
  s_mul_i32 s44, s41, 12384
  s_add_u32 s44, s44, 49152
  v_add_u32 v69, s44, v69
  v_mov_b32 v6, v69
  v_add_u32 v7, 8, v69
  v_lshl_add_u32 v70, v62, 2, v66
  v_lshlrev_b32 v70, 5, v70
  v_lshl_add_u32 v70, v65, 3, v70
  v_add_u32 v3, 73920, v70
  v_xor_b32 v70, 128, v70
  v_add_u32 v4, 73920, v70
  s_mov_b32 s30, 9437184
  s_mov_b32 s31, 0x20000
  s_waitcnt lgkmcnt(0)
  s_cmp_eq_u32 s33, 1
  s_cbranch_scc1 L_sp1_go
  s_cmp_eq_u32 s33, 2
  s_cbranch_scc1 L_sp2_go
  s_cmp_eq_u32 s33, 3
  s_cbranch_scc1 L_sp3_go
L_sp0_go:
  s_cmp_eq_u32 0, 0
  s_branch L_t_sp0_0
L_r_sp0_0:
  s_barrier
  s_mov_b32 s53, 6
  s_mov_b32 s54, 1
  s_mov_b32 s52, 55680
  s_mov_b32 s55, 16384
  s_mov_b32 s51, 16384
  ds_read_b64_tr_b16 v[64:65], v6 offset:4128
  ds_read_b64_tr_b16 v[66:67], v6 offset:4640
  ds_read_b128 v[16:19], v2 offset:0
  ds_read_b64_tr_b16 v[68:69], v6 offset:8256
  ds_read_b64_tr_b16 v[70:71], v6 offset:8768
  ds_read_b128 v[20:23], v2 offset:2048
  ds_read_b64_tr_b16 v[80:81], v7 offset:8256
  ds_read_b64_tr_b16 v[82:83], v7 offset:8768
  ds_read_b64_tr_b16 v[76:77], v7 offset:4128
  ds_read_b64_tr_b16 v[78:79], v7 offset:4640
  ds_read_b64_tr_b16 v[60:61], v6 offset:0
  ds_read_b64_tr_b16 v[62:63], v6 offset:512
  ds_read_b128 v[24:27], v2 offset:4096
  ds_read_b64_tr_b16 v[72:73], v7 offset:0
  ds_read_b64_tr_b16 v[74:75], v7 offset:512
  ds_read_b128 v[28:31], v2 offset:6144
  ds_read_b128 v[32:35], v2 offset:8192
  ds_read_b128 v[36:39], v2 offset:10240
  ds_read_b128 v[40:43], v2 offset:12288
  ds_read_b128 v[44:47], v2 offset:14336
  ds_read_b64_tr_b16 v[48:49], v3 offset:0
  ds_read_b64_tr_b16 v[50:51], v4 offset:0
  ds_read_b64_tr_b16 v[52:53], v3 offset:1024
  ds_read_b64_tr_b16 v[54:55], v4 offset:1024
  ds_read_b64_tr_b16 v[56:57], v3 offset:2048
  ds_read_b64_tr_b16 v[58:59], v4 offset:2048
  s_waitcnt lgkmcnt(15)
  v_mfma_f32_16x16x32_bf16 v[152:155], v[64:67], v[16:19], 0
  v_mfma_f32_16x16x32_bf16 v[152:155], v[68:71], v[20:23], v[152:155]
  v_mfma_f32_16x16x32_bf16 v[156:159], v[80:83], v[20:23], 0
  v_mfma_f32_16x16x32_bf16 v[156:159], v[76:79], v[16:19], v[156:159]
  s_waitcnt lgkmcnt(0)
  s_barrier
  ds_read_b64_tr_b16 v[132:133], v6 offset:31968
  v_mfma_f32_16x16x32_bf16 v[160:163], v[60:63], v[16:19], 0
  ds_read_b64_tr_b16 v[134:135], v6 offset:32480
  v_mfma_f32_16x16x32_bf16 v[160:163], v[64:67], v[20:23], v[160:163]
  ds_read_b128 v[84:87], v1 offset:0
  v_mfma_f32_16x16x32_bf16 v[160:163], v[68:71], v[24:27], v[160:163]
  v_mfma_f32_16x16x32_bf16 v[164:167], v[80:83], v[24:27], 0
  ds_read_b64_tr_b16 v[136:137], v6 offset:36096
  v_mfma_f32_16x16x32_bf16 v[164:167], v[76:79], v[20:23], v[164:167]
  ds_read_b64_tr_b16 v[138:139], v6 offset:36608
  v_mfma_f32_16x16x32_bf16 v[164:167], v[72:75], v[16:19], v[164:167]
  ds_read_b128 v[88:91], v1 offset:2048
  v_mfma_f32_16x16x32_bf16 v[168:171], v[60:63], v[20:23], 0
  v_mfma_f32_16x16x32_bf16 v[168:171], v[64:67], v[24:27], v[168:171]
  ds_read_b64_tr_b16 v[148:149], v7 offset:36096
  v_mfma_f32_16x16x32_bf16 v[168:171], v[68:71], v[28:31], v[168:171]
  ds_read_b64_tr_b16 v[150:151], v7 offset:36608
  v_mfma_f32_16x16x32_bf16 v[172:175], v[80:83], v[28:31], 0
  ds_read_b64_tr_b16 v[144:145], v7 offset:31968
  v_mfma_f32_16x16x32_bf16 v[172:175], v[76:79], v[24:27], v[172:175]
  ds_read_b64_tr_b16 v[146:147], v7 offset:32480
  v_mfma_f32_16x16x32_bf16 v[172:175], v[72:75], v[20:23], v[172:175]
  ds_read_b64_tr_b16 v[128:129], v6 offset:27840
  v_mfma_f32_16x16x32_bf16 v[176:179], v[60:63], v[24:27], 0
  ds_read_b64_tr_b16 v[130:131], v6 offset:28352
  v_mfma_f32_16x16x32_bf16 v[176:179], v[64:67], v[28:31], v[176:179]
  ds_read_b128 v[92:95], v1 offset:4096
  v_mfma_f32_16x16x32_bf16 v[176:179], v[68:71], v[32:35], v[176:179]
  v_mfma_f32_16x16x32_bf16 v[180:183], v[80:83], v[32:35], 0
  ds_read_b64_tr_b16 v[140:141], v7 offset:27840
  v_mfma_f32_16x16x32_bf16 v[180:183], v[76:79], v[28:31], v[180:183]
  ds_read_b64_tr_b16 v[142:143], v7 offset:28352
  v_mfma_f32_16x16x32_bf16 v[180:183], v[72:75], v[24:27], v[180:183]
  v_mfma_f32_16x16x32_bf16 v[184:187], v[60:63], v[28:31], 0
  ds_read_b128 v[96:99], v1 offset:6144
  v_mfma_f32_16x16x32_bf16 v[184:187], v[64:67], v[32:35], v[184:187]
  v_mfma_f32_16x16x32_bf16 v[184:187], v[68:71], v[36:39], v[184:187]
  ds_read_b128 v[100:103], v1 offset:8192
  v_mfma_f32_16x16x32_bf16 v[188:191], v[80:83], v[36:39], 0
  v_mfma_f32_16x16x32_bf16 v[188:191], v[76:79], v[32:35], v[188:191]
  ds_read_b128 v[104:107], v1 offset:10240
  v_mfma_f32_16x16x32_bf16 v[188:191], v[72:75], v[28:31], v[188:191]
  v_mfma_f32_16x16x32_bf16 v[192:195], v[60:63], v[32:35], 0
  ds_read_b128 v[108:111], v1 offset:12288
  v_mfma_f32_16x16x32_bf16 v[192:195], v[64:67], v[36:39], v[192:195]
  v_mfma_f32_16x16x32_bf16 v[192:195], v[68:71], v[40:43], v[192:195]
  ds_read_b128 v[112:115], v1 offset:14336
  v_mfma_f32_16x16x32_bf16 v[196:199], v[80:83], v[40:43], 0
  v_mfma_f32_16x16x32_bf16 v[196:199], v[76:79], v[36:39], v[196:199]
  ds_read_b64_tr_b16 v[116:117], v3 offset:27840
  v_mfma_f32_16x16x32_bf16 v[196:199], v[72:75], v[32:35], v[196:199]
  ds_read_b64_tr_b16 v[118:119], v4 offset:27840
  v_mfma_f32_16x16x32_bf16 v[200:203], v[60:63], v[36:39], 0
  ds_read_b64_tr_b16 v[120:121], v3 offset:28864
  v_mfma_f32_16x16x32_bf16 v[200:203], v[64:67], v[40:43], v[200:203]
  ds_read_b64_tr_b16 v[122:123], v4 offset:28864
  v_mfma_f32_16x16x32_bf16 v[200:203], v[68:71], v[44:47], v[200:203]
  ds_read_b64_tr_b16 v[124:125], v3 offset:29888
  v_mfma_f32_16x16x32_bf16 v[204:207], v[80:83], v[44:47], 0
  ds_read_b64_tr_b16 v[126:127], v4 offset:29888
  v_mfma_f32_16x16x32_bf16 v[204:207], v[76:79], v[40:43], v[204:207]
  v_mfma_f32_16x16x32_bf16 v[204:207], v[72:75], v[36:39], v[204:207]
  v_mfma_f32_16x16x32_bf16 v[208:211], v[60:63], v[40:43], 0
  v_add_u32 v2, s51, v2
  v_add_u32 v1, s51, v1
  v_mfma_f32_16x16x32_bf16 v[208:211], v[64:67], v[44:47], v[208:211]
  v_add_u32 v6, s52, v6
  v_add_u32 v7, s52, v7
  v_mfma_f32_16x16x32_bf16 v[212:215], v[76:79], v[44:47], 0
  v_add_u32 v3, s52, v3
  v_add_u32 v4, s52, v4
  v_mfma_f32_16x16x32_bf16 v[212:215], v[72:75], v[40:43], v[212:215]
  s_cmp_eq_u32 s54, 2
  s_cselect_b32 s51, 4294934528, s55
  v_mfma_f32_16x16x32_bf16 v[216:219], v[52:55], v[16:19], 0
  s_cselect_b32 s54, -1, s54
  s_add_u32 s54, s54, 1
  v_mfma_f32_16x16x32_bf16 v[216:219], v[56:59], v[20:23], v[216:219]
  s_sub_u32 s52, 0, s52
  v_mfma_f32_16x16x32_bf16 v[220:223], v[56:59], v[24:27], 0
  v_mfma_f32_16x16x32_bf16 v[220:223], v[52:55], v[20:23], v[220:223]
  v_mfma_f32_16x16x32_bf16 v[220:223], v[48:51], v[16:19], v[220:223]
L_sp0_loop:
  s_waitcnt lgkmcnt(0)
  v_mfma_f32_16x16x32_bf16 v[152:155], v[132:135], v[84:87], v[152:155]
  s_barrier
  ds_read_b64_tr_b16 v[64:65], v6 offset:4128
  v_mfma_f32_16x16x32_bf16 v[152:155], v[136:139], v[88:91], v[152:155]
  ds_read_b64_tr_b16 v[66:67], v6 offset:4640
  v_mfma_f32_16x16x32_bf16 v[156:159], v[148:151], v[88:91], v[156:159]
  ds_read_b128 v[16:19], v2 offset:0
  v_mfma_f32_16x16x32_bf16 v[156:159], v[144:147], v[84:87], v[156:159]
  v_mfma_f32_16x16x32_bf16 v[160:163], v[128:131], v[84:87], v[160:163]
  ds_read_b64_tr_b16 v[68:69], v6 offset:8256
  v_mfma_f32_16x16x32_bf16 v[160:163], v[132:135], v[88:91], v[160:163]
  ds_read_b64_tr_b16 v[70:71], v6 offset:8768
  v_mfma_f32_16x16x32_bf16 v[160:163], v[136:139], v[92:95], v[160:163]
  ds_read_b128 v[20:23], v2 offset:2048
  v_mfma_f32_16x16x32_bf16 v[164:167], v[148:151], v[92:95], v[164:167]
  v_mfma_f32_16x16x32_bf16 v[164:167], v[144:147], v[88:91], v[164:167]
  ds_read_b64_tr_b16 v[80:81], v7 offset:8256
  v_mfma_f32_16x16x32_bf16 v[164:167], v[140:143], v[84:87], v[164:167]
  ds_read_b64_tr_b16 v[82:83], v7 offset:8768
  v_mfma_f32_16x16x32_bf16 v[168:171], v[128:131], v[88:91], v[168:171]
  ds_read_b64_tr_b16 v[76:77], v7 offset:4128
  v_mfma_f32_16x16x32_bf16 v[168:171], v[132:135], v[92:95], v[168:171]
  ds_read_b64_tr_b16 v[78:79], v7 offset:4640
  v_mfma_f32_16x16x32_bf16 v[168:171], v[136:139], v[96:99], v[168:171]
  ds_read_b64_tr_b16 v[60:61], v6 offset:0
  v_mfma_f32_16x16x32_bf16 v[172:175], v[148:151], v[96:99], v[172:175]
  ds_read_b64_tr_b16 v[62:63], v6 offset:512
  v_mfma_f32_16x16x32_bf16 v[172:175], v[144:147], v[92:95], v[172:175]
  ds_read_b128 v[24:27], v2 offset:4096
  v_mfma_f32_16x16x32_bf16 v[172:175], v[140:143], v[88:91], v[172:175]
  v_mfma_f32_16x16x32_bf16 v[176:179], v[128:131], v[92:95], v[176:179]
  ds_read_b64_tr_b16 v[72:73], v7 offset:0
  v_mfma_f32_16x16x32_bf16 v[176:179], v[132:135], v[96:99], v[176:179]
  ds_read_b64_tr_b16 v[74:75], v7 offset:512
  v_mfma_f32_16x16x32_bf16 v[176:179], v[136:139], v[100:103], v[176:179]
  v_mfma_f32_16x16x32_bf16 v[180:183], v[148:151], v[100:103], v[180:183]
  ds_read_b128 v[28:31], v2 offset:6144
  v_mfma_f32_16x16x32_bf16 v[180:183], v[144:147], v[96:99], v[180:183]
  v_mfma_f32_16x16x32_bf16 v[180:183], v[140:143], v[92:95], v[180:183]
  ds_read_b128 v[32:35], v2 offset:8192
  v_mfma_f32_16x16x32_bf16 v[184:187], v[128:131], v[96:99], v[184:187]
  v_mfma_f32_16x16x32_bf16 v[184:187], v[132:135], v[100:103], v[184:187]
  ds_read_b128 v[36:39], v2 offset:10240
  v_mfma_f32_16x16x32_bf16 v[184:187], v[136:139], v[104:107], v[184:187]
  v_mfma_f32_16x16x32_bf16 v[188:191], v[148:151], v[104:107], v[188:191]
  ds_read_b128 v[40:43], v2 offset:12288
  v_mfma_f32_16x16x32_bf16 v[188:191], v[144:147], v[100:103], v[188:191]
  v_mfma_f32_16x16x32_bf16 v[188:191], v[140:143], v[96:99], v[188:191]
  ds_read_b128 v[44:47], v2 offset:14336
  v_mfma_f32_16x16x32_bf16 v[192:195], v[128:131], v[100:103], v[192:195]
  v_mfma_f32_16x16x32_bf16 v[192:195], v[132:135], v[104:107], v[192:195]
  ds_read_b64_tr_b16 v[48:49], v3 offset:0
  v_mfma_f32_16x16x32_bf16 v[192:195], v[136:139], v[108:111], v[192:195]
  ds_read_b64_tr_b16 v[50:51], v4 offset:0
  v_mfma_f32_16x16x32_bf16 v[196:199], v[148:151], v[108:111], v[196:199]
  ds_read_b64_tr_b16 v[52:53], v3 offset:1024
  v_mfma_f32_16x16x32_bf16 v[196:199], v[144:147], v[104:107], v[196:199]
  ds_read_b64_tr_b16 v[54:55], v4 offset:1024
  v_mfma_f32_16x16x32_bf16 v[196:199], v[140:143], v[100:103], v[196:199]
  ds_read_b64_tr_b16 v[56:57], v3 offset:2048
  v_mfma_f32_16x16x32_bf16 v[200:203], v[128:131], v[104:107], v[200:203]
  ds_read_b64_tr_b16 v[58:59], v4 offset:2048
  v_mfma_f32_16x16x32_bf16 v[200:203], v[132:135], v[108:111], v[200:203]
  v_mfma_f32_16x16x32_bf16 v[200:203], v[136:139], v[112:115], v[200:203]
  v_mfma_f32_16x16x32_bf16 v[204:207], v[148:151], v[112:115], v[204:207]
  v_mfma_f32_16x16x32_bf16 v[204:207], v[144:147], v[108:111], v[204:207]
  v_mfma_f32_16x16x32_bf16 v[204:207], v[140:143], v[104:107], v[204:207]
  v_mfma_f32_16x16x32_bf16 v[208:211], v[128:131], v[108:111], v[208:211]
  v_mfma_f32_16x16x32_bf16 v[208:211], v[132:135], v[112:115], v[208:211]
  v_mfma_f32_16x16x32_bf16 v[212:215], v[144:147], v[112:115], v[212:215]
  v_mfma_f32_16x16x32_bf16 v[212:215], v[140:143], v[108:111], v[212:215]
  v_mfma_f32_16x16x32_bf16 v[216:219], v[120:123], v[84:87], v[216:219]
  v_mfma_f32_16x16x32_bf16 v[216:219], v[124:127], v[88:91], v[216:219]
  v_mfma_f32_16x16x32_bf16 v[220:223], v[124:127], v[92:95], v[220:223]
  v_mfma_f32_16x16x32_bf16 v[220:223], v[120:123], v[88:91], v[220:223]
  v_mfma_f32_16x16x32_bf16 v[220:223], v[116:119], v[84:87], v[220:223]
  s_waitcnt lgkmcnt(0)
  v_mfma_f32_16x16x32_bf16 v[152:155], v[64:67], v[16:19], v[152:155]
  s_barrier
  ds_read_b64_tr_b16 v[132:133], v6 offset:31968
  v_mfma_f32_16x16x32_bf16 v[152:155], v[68:71], v[20:23], v[152:155]
  ds_read_b64_tr_b16 v[134:135], v6 offset:32480
  v_mfma_f32_16x16x32_bf16 v[156:159], v[80:83], v[20:23], v[156:159]
  ds_read_b128 v[84:87], v1 offset:0
  v_mfma_f32_16x16x32_bf16 v[156:159], v[76:79], v[16:19], v[156:159]
  v_mfma_f32_16x16x32_bf16 v[160:163], v[60:63], v[16:19], v[160:163]
  ds_read_b64_tr_b16 v[136:137], v6 offset:36096
  v_mfma_f32_16x16x32_bf16 v[160:163], v[64:67], v[20:23], v[160:163]
  ds_read_b64_tr_b16 v[138:139], v6 offset:36608
  v_mfma_f32_16x16x32_bf16 v[160:163], v[68:71], v[24:27], v[160:163]
  ds_read_b128 v[88:91], v1 offset:2048
  v_mfma_f32_16x16x32_bf16 v[164:167], v[80:83], v[24:27], v[164:167]
  v_mfma_f32_16x16x32_bf16 v[164:167], v[76:79], v[20:23], v[164:167]
  ds_read_b64_tr_b16 v[148:149], v7 offset:36096
  v_mfma_f32_16x16x32_bf16 v[164:167], v[72:75], v[16:19], v[164:167]
  ds_read_b64_tr_b16 v[150:151], v7 offset:36608
  v_mfma_f32_16x16x32_bf16 v[168:171], v[60:63], v[20:23], v[168:171]
  ds_read_b64_tr_b16 v[144:145], v7 offset:31968
  v_mfma_f32_16x16x32_bf16 v[168:171], v[64:67], v[24:27], v[168:171]
  ds_read_b64_tr_b16 v[146:147], v7 offset:32480
  v_mfma_f32_16x16x32_bf16 v[168:171], v[68:71], v[28:31], v[168:171]
  ds_read_b64_tr_b16 v[128:129], v6 offset:27840
  v_mfma_f32_16x16x32_bf16 v[172:175], v[80:83], v[28:31], v[172:175]
  ds_read_b64_tr_b16 v[130:131], v6 offset:28352
  v_mfma_f32_16x16x32_bf16 v[172:175], v[76:79], v[24:27], v[172:175]
  ds_read_b128 v[92:95], v1 offset:4096
  v_mfma_f32_16x16x32_bf16 v[172:175], v[72:75], v[20:23], v[172:175]
  v_mfma_f32_16x16x32_bf16 v[176:179], v[60:63], v[24:27], v[176:179]
  ds_read_b64_tr_b16 v[140:141], v7 offset:27840
  v_mfma_f32_16x16x32_bf16 v[176:179], v[64:67], v[28:31], v[176:179]
  ds_read_b64_tr_b16 v[142:143], v7 offset:28352
  v_mfma_f32_16x16x32_bf16 v[176:179], v[68:71], v[32:35], v[176:179]
  v_mfma_f32_16x16x32_bf16 v[180:183], v[80:83], v[32:35], v[180:183]
  ds_read_b128 v[96:99], v1 offset:6144
  v_mfma_f32_16x16x32_bf16 v[180:183], v[76:79], v[28:31], v[180:183]
  v_mfma_f32_16x16x32_bf16 v[180:183], v[72:75], v[24:27], v[180:183]
  ds_read_b128 v[100:103], v1 offset:8192
  v_mfma_f32_16x16x32_bf16 v[184:187], v[60:63], v[28:31], v[184:187]
  v_mfma_f32_16x16x32_bf16 v[184:187], v[64:67], v[32:35], v[184:187]
  ds_read_b128 v[104:107], v1 offset:10240
  v_mfma_f32_16x16x32_bf16 v[184:187], v[68:71], v[36:39], v[184:187]
  v_mfma_f32_16x16x32_bf16 v[188:191], v[80:83], v[36:39], v[188:191]
  ds_read_b128 v[108:111], v1 offset:12288
  v_mfma_f32_16x16x32_bf16 v[188:191], v[76:79], v[32:35], v[188:191]
  v_mfma_f32_16x16x32_bf16 v[188:191], v[72:75], v[28:31], v[188:191]
  ds_read_b128 v[112:115], v1 offset:14336
  v_mfma_f32_16x16x32_bf16 v[192:195], v[60:63], v[32:35], v[192:195]
  v_mfma_f32_16x16x32_bf16 v[192:195], v[64:67], v[36:39], v[192:195]
  ds_read_b64_tr_b16 v[116:117], v3 offset:27840
  v_mfma_f32_16x16x32_bf16 v[192:195], v[68:71], v[40:43], v[192:195]
  ds_read_b64_tr_b16 v[118:119], v4 offset:27840
  v_mfma_f32_16x16x32_bf16 v[196:199], v[80:83], v[40:43], v[196:199]
  ds_read_b64_tr_b16 v[120:121], v3 offset:28864
  v_mfma_f32_16x16x32_bf16 v[196:199], v[76:79], v[36:39], v[196:199]
  ds_read_b64_tr_b16 v[122:123], v4 offset:28864
  v_mfma_f32_16x16x32_bf16 v[196:199], v[72:75], v[32:35], v[196:199]
  ds_read_b64_tr_b16 v[124:125], v3 offset:29888
  v_mfma_f32_16x16x32_bf16 v[200:203], v[60:63], v[36:39], v[200:203]
  ds_read_b64_tr_b16 v[126:127], v4 offset:29888
  v_mfma_f32_16x16x32_bf16 v[200:203], v[64:67], v[40:43], v[200:203]
  v_mfma_f32_16x16x32_bf16 v[200:203], v[68:71], v[44:47], v[200:203]
  v_mfma_f32_16x16x32_bf16 v[204:207], v[80:83], v[44:47], v[204:207]
  v_add_u32 v2, s51, v2
  v_add_u32 v1, s51, v1
  v_mfma_f32_16x16x32_bf16 v[204:207], v[76:79], v[40:43], v[204:207]
  v_add_u32 v6, s52, v6
  v_add_u32 v7, s52, v7
  v_mfma_f32_16x16x32_bf16 v[204:207], v[72:75], v[36:39], v[204:207]
  v_add_u32 v3, s52, v3
  v_add_u32 v4, s52, v4
  v_mfma_f32_16x16x32_bf16 v[208:211], v[60:63], v[40:43], v[208:211]
  s_cmp_eq_u32 s54, 2
  s_cselect_b32 s51, 4294934528, s55
  v_mfma_f32_16x16x32_bf16 v[208:211], v[64:67], v[44:47], v[208:211]
  s_cselect_b32 s54, -1, s54
  s_add_u32 s54, s54, 1
  v_mfma_f32_16x16x32_bf16 v[212:215], v[76:79], v[44:47], v[212:215]
  s_sub_u32 s52, 0, s52
  s_sub_u32 s53, s53, 1
  v_mfma_f32_16x16x32_bf16 v[212:215], v[72:75], v[40:43], v[212:215]
  s_cmp_lg_u32 s53, 0
  v_mfma_f32_16x16x32_bf16 v[216:219], v[52:55], v[16:19], v[216:219]
  v_mfma_f32_16x16x32_bf16 v[216:219], v[56:59], v[20:23], v[216:219]
  v_mfma_f32_16x16x32_bf16 v[220:223], v[56:59], v[24:27], v[220:223]
  v_mfma_f32_16x16x32_bf16 v[220:223], v[52:55], v[20:23], v[220:223]
  v_mfma_f32_16x16x32_bf16 v[220:223], v[48:51], v[16:19], v[220:223]
  s_cbranch_scc1 L_sp0_loop
  s_waitcnt vmcnt(0) lgkmcnt(0)
  v_mfma_f32_16x16x32_bf16 v[152:155], v[132:135], v[84:87], v[152:155]
  s_barrier
  v_mfma_f32_16x16x32_bf16 v[152:155], v[136:139], v[88:91], v[152:155]
  v_mfma_f32_16x16x32_bf16 v[156:159], v[148:151], v[88:91], v[156:159]
  v_mfma_f32_16x16x32_bf16 v[156:159], v[144:147], v[84:87], v[156:159]
  v_mfma_f32_16x16x32_bf16 v[160:163], v[128:131], v[84:87], v[160:163]
  v_mfma_f32_16x16x32_bf16 v[160:163], v[132:135], v[88:91], v[160:163]
  v_mfma_f32_16x16x32_bf16 v[160:163], v[136:139], v[92:95], v[160:163]
  v_mfma_f32_16x16x32_bf16 v[164:167], v[148:151], v[92:95], v[164:167]
  v_mfma_f32_16x16x32_bf16 v[164:167], v[144:147], v[88:91], v[164:167]
  v_mfma_f32_16x16x32_bf16 v[164:167], v[140:143], v[84:87], v[164:167]
  v_mfma_f32_16x16x32_bf16 v[168:171], v[128:131], v[88:91], v[168:171]
  v_mfma_f32_16x16x32_bf16 v[168:171], v[132:135], v[92:95], v[168:171]
  v_mfma_f32_16x16x32_bf16 v[168:171], v[136:139], v[96:99], v[168:171]
  v_mfma_f32_16x16x32_bf16 v[172:175], v[148:151], v[96:99], v[172:175]
  v_mfma_f32_16x16x32_bf16 v[172:175], v[144:147], v[92:95], v[172:175]
  v_mfma_f32_16x16x32_bf16 v[172:175], v[140:143], v[88:91], v[172:175]
  v_mfma_f32_16x16x32_bf16 v[176:179], v[128:131], v[92:95], v[176:179]
  v_mfma_f32_16x16x32_bf16 v[176:179], v[132:135], v[96:99], v[176:179]
  v_mfma_f32_16x16x32_bf16 v[176:179], v[136:139], v[100:103], v[176:179]
  v_mfma_f32_16x16x32_bf16 v[180:183], v[148:151], v[100:103], v[180:183]
  v_mfma_f32_16x16x32_bf16 v[180:183], v[144:147], v[96:99], v[180:183]
  v_mfma_f32_16x16x32_bf16 v[180:183], v[140:143], v[92:95], v[180:183]
  v_mfma_f32_16x16x32_bf16 v[184:187], v[128:131], v[96:99], v[184:187]
  v_mfma_f32_16x16x32_bf16 v[184:187], v[132:135], v[100:103], v[184:187]
  ds_read_b64_tr_b16 v[16:17], v6 offset:4128
  v_mfma_f32_16x16x32_bf16 v[184:187], v[136:139], v[104:107], v[184:187]
  ds_read_b64_tr_b16 v[18:19], v6 offset:4640
  v_mfma_f32_16x16x32_bf16 v[188:191], v[148:151], v[104:107], v[188:191]
  s_barrier
  ds_read_b128 v[20:23], v2 offset:0
  v_mfma_f32_16x16x32_bf16 v[188:191], v[144:147], v[100:103], v[188:191]
  ds_read_b64_tr_b16 v[24:25], v6 offset:31968
  v_mfma_f32_16x16x32_bf16 v[188:191], v[140:143], v[96:99], v[188:191]
  ds_read_b64_tr_b16 v[26:27], v6 offset:32480
  v_mfma_f32_16x16x32_bf16 v[192:195], v[128:131], v[100:103], v[192:195]
  ds_read_b128 v[28:31], v1 offset:0
  v_mfma_f32_16x16x32_bf16 v[192:195], v[132:135], v[104:107], v[192:195]
  ds_read_b64_tr_b16 v[32:33], v6 offset:8256
  v_mfma_f32_16x16x32_bf16 v[192:195], v[136:139], v[108:111], v[192:195]
  ds_read_b64_tr_b16 v[34:35], v6 offset:8768
  v_mfma_f32_16x16x32_bf16 v[196:199], v[148:151], v[108:111], v[196:199]
  ds_read_b128 v[36:39], v2 offset:2048
  v_mfma_f32_16x16x32_bf16 v[196:199], v[144:147], v[104:107], v[196:199]
  ds_read_b64_tr_b16 v[40:41], v6 offset:36096
  v_mfma_f32_16x16x32_bf16 v[196:199], v[140:143], v[100:103], v[196:199]
  ds_read_b64_tr_b16 v[42:43], v6 offset:36608
  v_mfma_f32_16x16x32_bf16 v[200:203], v[128:131], v[104:107], v[200:203]
  ds_read_b128 v[44:47], v1 offset:2048
  v_mfma_f32_16x16x32_bf16 v[200:203], v[132:135], v[108:111], v[200:203]
  ds_read_b64_tr_b16 v[48:49], v7 offset:4128
  v_mfma_f32_16x16x32_bf16 v[200:203], v[136:139], v[112:115], v[200:203]
  ds_read_b64_tr_b16 v[50:51], v7 offset:4640
  v_mfma_f32_16x16x32_bf16 v[204:207], v[148:151], v[112:115], v[204:207]
  ds_read_b64_tr_b16 v[52:53], v7 offset:31968
  v_mfma_f32_16x16x32_bf16 v[204:207], v[144:147], v[108:111], v[204:207]
  ds_read_b64_tr_b16 v[54:55], v7 offset:32480
  v_mfma_f32_16x16x32_bf16 v[204:207], v[140:143], v[104:107], v[204:207]
  ds_read_b64_tr_b16 v[56:57], v7 offset:8256
  v_mfma_f32_16x16x32_bf16 v[208:211], v[128:131], v[108:111], v[208:211]
  ds_read_b64_tr_b16 v[58:59], v7 offset:8768
  v_mfma_f32_16x16x32_bf16 v[208:211], v[132:135], v[112:115], v[208:211]
  ds_read_b64_tr_b16 v[60:61], v7 offset:36096
  v_mfma_f32_16x16x32_bf16 v[212:215], v[144:147], v[112:115], v[212:215]
  ds_read_b64_tr_b16 v[62:63], v7 offset:36608
  v_mfma_f32_16x16x32_bf16 v[212:215], v[140:143], v[108:111], v[212:215]
  ds_read_b64_tr_b16 v[64:65], v6 offset:0
  v_mfma_f32_16x16x32_bf16 v[216:219], v[120:123], v[84:87], v[216:219]
  ds_read_b64_tr_b16 v[66:67], v6 offset:512
  v_mfma_f32_16x16x32_bf16 v[216:219], v[124:127], v[88:91], v[216:219]
  ds_read_b64_tr_b16 v[68:69], v6 offset:27840
  v_mfma_f32_16x16x32_bf16 v[220:223], v[124:127], v[92:95], v[220:223]
  ds_read_b64_tr_b16 v[70:71], v6 offset:28352
  v_mfma_f32_16x16x32_bf16 v[220:223], v[120:123], v[88:91], v[220:223]
  ds_read_b128 v[72:75], v2 offset:4096
  v_mfma_f32_16x16x32_bf16 v[220:223], v[116:119], v[84:87], v[220:223]
  ds_read_b128 v[76:79], v1 offset:4096
  s_waitcnt lgkmcnt(10)
  v_mfma_f32_16x16x32_bf16 v[152:155], v[16:19], v[20:23], v[152:155]
  ds_read_b64_tr_b16 v[80:81], v7 offset:0
  v_mfma_f32_16x16x32_bf16 v[152:155], v[24:27], v[28:31], v[152:155]
  ds_read_b64_tr_b16 v[82:83], v7 offset:512
  v_mfma_f32_16x16x32_bf16 v[152:155], v[32:35], v[36:39], v[152:155]
  ds_read_b64_tr_b16 v[240:241], v7 offset:27840
  v_mfma_f32_16x16x32_bf16 v[152:155], v[40:43], v[44:47], v[152:155]
  ds_read_b64_tr_b16 v[242:243], v7 offset:28352
  v_mfma_f32_16x16x32_bf16 v[156:159], v[48:51], v[20:23], v[156:159]
  ds_read_b128 v[224:227], v10 offset:0
  v_mfma_f32_16x16x32_bf16 v[156:159], v[52:55], v[28:31], v[156:159]
  ds_read_b128 v[232:235], v10 offset:256
  s_waitcnt lgkmcnt(10)
  v_mfma_f32_16x16x32_bf16 v[156:159], v[56:59], v[36:39], v[156:159]
  ds_read_b128 v[228:231], v10 offset:16
  v_mfma_f32_16x16x32_bf16 v[156:159], v[60:63], v[44:47], v[156:159]
  ds_read_b128 v[236:239], v10 offset:272
  v_mfma_f32_16x16x32_bf16 v[160:163], v[64:67], v[20:23], v[160:163]
  ds_read_b128 v[244:247], v2 offset:6144
  s_waitcnt lgkmcnt(10)
  v_mfma_f32_16x16x32_bf16 v[160:163], v[68:71], v[28:31], v[160:163]
  ds_read_b128 v[96:99], v1 offset:6144
  v_mfma_f32_16x16x32_bf16 v[160:163], v[16:19], v[36:39], v[160:163]
  ds_read_b128 v[100:103], v2 offset:8192
  v_mfma_f32_16x16x32_bf16 v[160:163], v[24:27], v[44:47], v[160:163]
  ds_read_b128 v[136:139], v1 offset:8192
  v_mfma_f32_16x16x32_bf16 v[160:163], v[32:35], v[72:75], v[160:163]
  s_waitcnt lgkmcnt(9)
  v_mfma_f32_16x16x32_bf16 v[160:163], v[40:43], v[76:79], v[160:163]
  v_mfma_f32_16x16x32_bf16 v[164:167], v[80:83], v[20:23], v[164:167]
  s_waitcnt lgkmcnt(7)
  v_mfma_f32_16x16x32_bf16 v[164:167], v[240:243], v[28:31], v[164:167]
  v_mfma_f32_16x16x32_bf16 v[164:167], v[48:51], v[36:39], v[164:167]
  v_mfma_f32_16x16x32_bf16 v[164:167], v[52:55], v[44:47], v[164:167]
  v_mfma_f32_16x16x32_bf16 v[164:167], v[56:59], v[72:75], v[164:167]
  v_mfma_f32_16x16x32_bf16 v[164:167], v[60:63], v[76:79], v[164:167]
  v_mfma_f32_16x16x32_bf16 v[168:171], v[64:67], v[36:39], v[168:171]
  v_mfma_f32_16x16x32_bf16 v[168:171], v[68:71], v[44:47], v[168:171]
  s_barrier
  v_subrev_u32 v6, 55680, v6
  v_mfma_f32_16x16x32_bf16 v[168:171], v[16:19], v[72:75], v[168:171]
  s_barrier
  v_subrev_u32 v7, 55680, v7
  v_mfma_f32_16x16x32_bf16 v[168:171], v[24:27], v[76:79], v[168:171]
  ds_read_b64_tr_b16 v[148:149], v6 offset:4128
  s_waitcnt lgkmcnt(1)
  v_mfma_f32_16x16x32_bf16 v[168:171], v[32:35], v[244:247], v[168:171]
  ds_read_b64_tr_b16 v[150:151], v6 offset:4640
  v_mfma_f32_16x16x32_bf16 v[168:171], v[40:43], v[96:99], v[168:171]
  ds_read_b128 v[104:107], v2 offset:16384
  v_mfma_f32_16x16x32_bf16 v[172:175], v[80:83], v[36:39], v[172:175]
  ds_read_b64_tr_b16 v[128:129], v6 offset:31968
  v_mfma_f32_16x16x32_bf16 v[172:175], v[240:243], v[44:47], v[172:175]
  ds_read_b64_tr_b16 v[130:131], v6 offset:32480
  v_mfma_f32_16x16x32_bf16 v[172:175], v[48:51], v[72:75], v[172:175]
  ds_read_b128 v[132:135], v1 offset:16384
  v_mfma_f32_16x16x32_bf16 v[172:175], v[52:55], v[76:79], v[172:175]
  ds_read_b64_tr_b16 v[144:145], v6 offset:8256
  v_mfma_f32_16x16x32_bf16 v[172:175], v[56:59], v[244:247], v[172:175]
  ds_read_b64_tr_b16 v[146:147], v6 offset:8768
  v_mfma_f32_16x16x32_bf16 v[172:175], v[60:63], v[96:99], v[172:175]
L_t_sp0_0:
  s_cbranch_scc1 L_r_sp0_0
  ds_read_b128 v[112:115], v2 offset:18432
  v_mfma_f32_16x16x32_bf16 v[176:179], v[64:67], v[72:75], v[176:179]
  ds_read_b64_tr_b16 v[140:141], v6 offset:36096
  v_mfma_f32_16x16x32_bf16 v[176:179], v[68:71], v[76:79], v[176:179]
  ds_read_b64_tr_b16 v[142:143], v6 offset:36608
  v_mfma_f32_16x16x32_bf16 v[176:179], v[16:19], v[244:247], v[176:179]
  ds_read_b128 v[108:111], v1 offset:18432
  v_mfma_f32_16x16x32_bf16 v[176:179], v[24:27], v[96:99], v[176:179]
  ds_read_b64_tr_b16 v[124:125], v7 offset:4128
  v_mfma_f32_16x16x32_bf16 v[176:179], v[32:35], v[100:103], v[176:179]
  ds_read_b64_tr_b16 v[126:127], v7 offset:4640
  v_mfma_f32_16x16x32_bf16 v[176:179], v[40:43], v[136:139], v[176:179]
  ds_read_b64_tr_b16 v[92:93], v7 offset:31968
  v_mfma_f32_16x16x32_bf16 v[180:183], v[80:83], v[72:75], v[180:183]
  ds_read_b64_tr_b16 v[94:95], v7 offset:32480
  v_mfma_f32_16x16x32_bf16 v[180:183], v[240:243], v[76:79], v[180:183]
  ds_read_b64_tr_b16 v[120:121], v7 offset:8256
  v_mfma_f32_16x16x32_bf16 v[180:183], v[48:51], v[244:247], v[180:183]
  ds_read_b64_tr_b16 v[122:123], v7 offset:8768
  v_mfma_f32_16x16x32_bf16 v[180:183], v[52:55], v[96:99], v[180:183]
  ds_read_b64_tr_b16 v[88:89], v7 offset:36096
  ds_read_b64_tr_b16 v[90:91], v7 offset:36608
  v_mfma_f32_16x16x32_bf16 v[180:183], v[56:59], v[100:103], v[180:183]
  ds_read_b128 v[116:119], v2 offset:10240
  v_mfma_f32_16x16x32_bf16 v[180:183], v[60:63], v[136:139], v[180:183]
  ds_read_b128 v[84:87], v1 offset:10240
  s_waitcnt lgkmcnt(11)
  v_mfma_f32_16x16x32_bf16 v[152:155], v[148:151], v[104:107], v[152:155]
  ds_read_b64_tr_b16 v[20:21], v6 offset:0
  v_mfma_f32_16x16x32_bf16 v[152:155], v[128:131], v[132:135], v[152:155]
  ds_read_b64_tr_b16 v[22:23], v6 offset:512
  v_mfma_f32_16x16x32_bf16 v[152:155], v[144:147], v[112:115], v[152:155]
  ds_read_b64_tr_b16 v[28:29], v6 offset:27840
  s_waitcnt lgkmcnt(11)
  v_mfma_f32_16x16x32_bf16 v[152:155], v[140:143], v[108:111], v[152:155]
  ds_read_b64_tr_b16 v[30:31], v6 offset:28352
  v_mfma_f32_16x16x32_bf16 v[156:159], v[124:127], v[104:107], v[156:159]
  ds_read_b128 v[36:39], v2 offset:20480
  s_waitcnt lgkmcnt(11)
  v_mfma_f32_16x16x32_bf16 v[156:159], v[92:95], v[132:135], v[156:159]
  ds_read_b128 v[44:47], v1 offset:20480
  s_waitcnt lgkmcnt(10)
  v_mfma_f32_16x16x32_bf16 v[156:159], v[120:123], v[112:115], v[156:159]
  ds_read_b64_tr_b16 v[72:73], v7 offset:0
  s_waitcnt lgkmcnt(9)
  v_mfma_f32_16x16x32_bf16 v[156:159], v[88:91], v[108:111], v[156:159]
  ds_read_b64_tr_b16 v[74:75], v7 offset:512
  v_mfma_f32_16x16x32_bf16 v[184:187], v[64:67], v[244:247], v[184:187]
  ds_read_b64_tr_b16 v[76:77], v7 offset:27840
  v_mfma_f32_16x16x32_bf16 v[184:187], v[68:71], v[96:99], v[184:187]
  ds_read_b64_tr_b16 v[78:79], v7 offset:28352
  v_mfma_f32_16x16x32_bf16 v[184:187], v[16:19], v[100:103], v[184:187]
  v_mfma_f32_16x16x32_bf16 v[184:187], v[24:27], v[136:139], v[184:187]
  s_waitcnt lgkmcnt(8)
  v_mfma_f32_16x16x32_bf16 v[184:187], v[32:35], v[116:119], v[184:187]
  v_fma_f32 v152, v152, v224, v232
  v_fma_f32 v153, v153, v225, v233
  v_mfma_f32_16x16x32_bf16 v[184:187], v[40:43], v[84:87], v[184:187]
  v_fma_f32 v154, v154, v226, v234
  v_fma_f32 v155, v155, v227, v235
  v_mfma_f32_16x16x32_bf16 v[188:191], v[80:83], v[244:247], v[188:191]
  ds_read_b128 v[244:247], v2 offset:12288
  v_exp_f32 v248, v152
  v_mfma_f32_16x16x32_bf16 v[188:191], v[240:243], v[96:99], v[188:191]
  ds_read_b128 v[96:99], v1 offset:12288
  v_exp_f32 v249, v153
  v_mfma_f32_16x16x32_bf16 v[188:191], v[48:51], v[100:103], v[188:191]
  v_exp_f32 v250, v154
  v_mfma_f32_16x16x32_bf16 v[188:191], v[52:55], v[136:139], v[188:191]
  v_exp_f32 v251, v155
  v_mfma_f32_16x16x32_bf16 v[188:191], v[56:59], v[116:119], v[188:191]
  v_fma_f32 v156, v156, v228, v236
  v_fma_f32 v157, v157, v229, v237
  v_mfma_f32_16x16x32_bf16 v[188:191], v[60:63], v[84:87], v[188:191]
  v_fma_f32 v158, v158, v230, v238
  v_fma_f32 v159, v159, v231, v239
  v_mfma_f32_16x16x32_bf16 v[160:163], v[20:23], v[104:107], v[160:163]
  v_exp_f32 v252, v156
  s_waitcnt lgkmcnt(2)
  v_mfma_f32_16x16x32_bf16 v[160:163], v[28:31], v[132:135], v[160:163]
  v_exp_f32 v253, v157
  v_mfma_f32_16x16x32_bf16 v[160:163], v[148:151], v[112:115], v[160:163]
  v_exp_f32 v254, v158
  v_mfma_f32_16x16x32_bf16 v[160:163], v[128:131], v[108:111], v[160:163]
  v_exp_f32 v255, v159
  v_mfma_f32_16x16x32_bf16 v[160:163], v[144:147], v[36:39], v[160:163]
  v_fma_f32 v248, v248, s56, s56
  v_fma_f32 v249, v249, s56, s56
  v_mfma_f32_16x16x32_bf16 v[160:163], v[140:143], v[44:47], v[160:163]
  v_fma_f32 v250, v250, s56, s56
  v_fma_f32 v251, v251, s56, s56
  v_mfma_f32_16x16x32_bf16 v[164:167], v[72:75], v[104:107], v[164:167]
  ds_read_b128 v[104:107], v2 offset:22528
  v_rcp_f32 v248, v248
  v_mfma_f32_16x16x32_bf16 v[164:167], v[76:79], v[132:135], v[164:167]
  ds_read_b128 v[132:135], v1 offset:22528
  v_rcp_f32 v249, v249
  v_mfma_f32_16x16x32_bf16 v[164:167], v[124:127], v[112:115], v[164:167]
  v_rcp_f32 v250, v250
  v_mfma_f32_16x16x32_bf16 v[164:167], v[92:95], v[108:111], v[164:167]
  v_rcp_f32 v251, v251
  v_mfma_f32_16x16x32_bf16 v[164:167], v[120:123], v[36:39], v[164:167]
  v_fma_f32 v252, v252, s56, s56
  v_fma_f32 v253, v253, s56, s56
  v_mfma_f32_16x16x32_bf16 v[164:167], v[88:91], v[44:47], v[164:167]
  v_fma_f32 v254, v254, s56, s56
  v_fma_f32 v255, v255, s56, s56
  v_mfma_f32_16x16x32_bf16 v[192:195], v[64:67], v[100:103], v[192:195]
  v_rcp_f32 v252, v252
  v_mfma_f32_16x16x32_bf16 v[192:195], v[68:71], v[136:139], v[192:195]
  v_rcp_f32 v253, v253
  v_mfma_f32_16x16x32_bf16 v[192:195], v[16:19], v[116:119], v[192:195]
  v_rcp_f32 v254, v254
  v_mfma_f32_16x16x32_bf16 v[192:195], v[24:27], v[84:87], v[192:195]
  v_rcp_f32 v255, v255
  s_waitcnt lgkmcnt(2)
  v_mfma_f32_16x16x32_bf16 v[192:195], v[32:35], v[244:247], v[192:195]
  v_mul_f32 v152, v152, v248
  v_mul_f32 v153, v153, v249
  v_mfma_f32_16x16x32_bf16 v[192:195], v[40:43], v[96:99], v[192:195]
  v_mul_f32 v154, v154, v250
  v_mul_f32 v155, v155, v251
  v_mfma_f32_16x16x32_bf16 v[196:199], v[80:83], v[100:103], v[196:199]
  ds_read_b128 v[100:103], v2 offset:14336
  v_cvt_pk_bf16_f32 v12, v152, v153
  v_mfma_f32_16x16x32_bf16 v[196:199], v[240:243], v[136:139], v[196:199]
  ds_read_b128 v[136:139], v1 offset:14336
  v_cvt_pk_bf16_f32 v13, v154, v155
  v_mfma_f32_16x16x32_bf16 v[196:199], v[48:51], v[116:119], v[196:199]
  v_mul_f32 v156, v156, v252
  v_mul_f32 v157, v157, v253
  v_mfma_f32_16x16x32_bf16 v[196:199], v[52:55], v[84:87], v[196:199]
  v_mul_f32 v158, v158, v254
  v_mul_f32 v159, v159, v255
  v_mfma_f32_16x16x32_bf16 v[196:199], v[56:59], v[244:247], v[196:199]
  v_cvt_pk_bf16_f32 v14, v156, v157
  v_cvt_pk_bf16_f32 v15, v158, v159
  v_mfma_f32_16x16x32_bf16 v[196:199], v[60:63], v[96:99], v[196:199]
  buffer_store_dwordx4 v[12:15], v8, s[28:31], s48 offen offset:0 sc1
  v_fma_f32 v160, v160, v224, v232
  v_mfma_f32_16x16x32_bf16 v[168:171], v[20:23], v[112:115], v[168:171]
  v_fma_f32 v161, v161, v225, v233
  v_fma_f32 v162, v162, v226, v234
  v_mfma_f32_16x16x32_bf16 v[168:171], v[28:31], v[108:111], v[168:171]
  v_fma_f32 v163, v163, v227, v235
  v_exp_f32 v248, v160
  v_mfma_f32_16x16x32_bf16 v[168:171], v[148:151], v[36:39], v[168:171]
  ds_read_b128 v[156:159], v2 offset:24576
  v_exp_f32 v249, v161
  v_mfma_f32_16x16x32_bf16 v[168:171], v[128:131], v[44:47], v[168:171]
  v_exp_f32 v250, v162
  s_waitcnt lgkmcnt(3)
  v_mfma_f32_16x16x32_bf16 v[168:171], v[144:147], v[104:107], v[168:171]
  v_exp_f32 v251, v163
  v_mfma_f32_16x16x32_bf16 v[168:171], v[140:143], v[132:135], v[168:171]
  v_fma_f32 v164, v164, v228, v236
  v_fma_f32 v165, v165, v229, v237
  v_mfma_f32_16x16x32_bf16 v[172:175], v[72:75], v[112:115], v[172:175]
  ds_read_b128 v[112:115], v1 offset:24576
  v_fma_f32 v166, v166, v230, v238
  v_mfma_f32_16x16x32_bf16 v[172:175], v[76:79], v[108:111], v[172:175]
  v_fma_f32 v167, v167, v231, v239
  v_exp_f32 v252, v164
  v_mfma_f32_16x16x32_bf16 v[172:175], v[124:127], v[36:39], v[172:175]
  v_exp_f32 v253, v165
  v_mfma_f32_16x16x32_bf16 v[172:175], v[92:95], v[44:47], v[172:175]
  v_exp_f32 v254, v166
  v_mfma_f32_16x16x32_bf16 v[172:175], v[120:123], v[104:107], v[172:175]
  v_exp_f32 v255, v167
  v_mfma_f32_16x16x32_bf16 v[172:175], v[88:91], v[132:135], v[172:175]
  v_fma_f32 v248, v248, s56, s56
  v_fma_f32 v249, v249, s56, s56
  v_mfma_f32_16x16x32_bf16 v[200:203], v[64:67], v[116:119], v[200:203]
  v_fma_f32 v250, v250, s56, s56
  v_fma_f32 v251, v251, s56, s56
  v_mfma_f32_16x16x32_bf16 v[200:203], v[68:71], v[84:87], v[200:203]
  v_rcp_f32 v248, v248
  v_mfma_f32_16x16x32_bf16 v[200:203], v[16:19], v[244:247], v[200:203]
  v_rcp_f32 v249, v249
  v_mfma_f32_16x16x32_bf16 v[200:203], v[24:27], v[96:99], v[200:203]
  v_rcp_f32 v250, v250
  s_waitcnt lgkmcnt(1)
  v_mfma_f32_16x16x32_bf16 v[200:203], v[32:35], v[100:103], v[200:203]
  v_rcp_f32 v251, v251
  v_mfma_f32_16x16x32_bf16 v[200:203], v[40:43], v[136:139], v[200:203]
  v_fma_f32 v252, v252, s56, s56
  v_fma_f32 v253, v253, s56, s56
  v_mfma_f32_16x16x32_bf16 v[204:207], v[80:83], v[116:119], v[204:207]
  v_fma_f32 v254, v254, s56, s56
  v_fma_f32 v255, v255, s56, s56
  v_mfma_f32_16x16x32_bf16 v[204:207], v[240:243], v[84:87], v[204:207]
  v_rcp_f32 v252, v252
  v_mfma_f32_16x16x32_bf16 v[204:207], v[48:51], v[244:247], v[204:207]
  v_rcp_f32 v253, v253
  v_mfma_f32_16x16x32_bf16 v[204:207], v[52:55], v[96:99], v[204:207]
  v_rcp_f32 v254, v254
  v_mfma_f32_16x16x32_bf16 v[204:207], v[56:59], v[100:103], v[204:207]
  ds_read_b128 v[108:111], v2 offset:26624
  v_rcp_f32 v255, v255
  v_mfma_f32_16x16x32_bf16 v[204:207], v[60:63], v[136:139], v[204:207]
  ds_read_b128 v[32:35], v1 offset:26624
  v_mul_f32 v160, v160, v248
  v_mfma_f32_16x16x32_bf16 v[176:179], v[20:23], v[36:39], v[176:179]
  v_mul_f32 v161, v161, v249
  v_mul_f32 v162, v162, v250
  v_mfma_f32_16x16x32_bf16 v[176:179], v[28:31], v[44:47], v[176:179]
  v_mul_f32 v163, v163, v251
  v_cvt_pk_bf16_f32 v152, v160, v161
  v_mfma_f32_16x16x32_bf16 v[176:179], v[148:151], v[104:107], v[176:179]
  v_cvt_pk_bf16_f32 v153, v162, v163
  v_mul_f32 v164, v164, v252
  v_mfma_f32_16x16x32_bf16 v[176:179], v[128:131], v[132:135], v[176:179]
  v_mul_f32 v165, v165, v253
  v_mul_f32 v166, v166, v254
  v_mfma_f32_16x16x32_bf16 v[176:179], v[144:147], v[156:159], v[176:179]
  v_mul_f32 v167, v167, v255
  v_cvt_pk_bf16_f32 v154, v164, v165
  s_waitcnt lgkmcnt(2)
  v_mfma_f32_16x16x32_bf16 v[176:179], v[140:143], v[112:115], v[176:179]
  v_cvt_pk_bf16_f32 v155, v166, v167
  buffer_store_dwordx4 v[152:155], v8, s[28:31], s48 offen offset:1152 sc1
  v_mfma_f32_16x16x32_bf16 v[180:183], v[72:75], v[36:39], v[180:183]
  ds_read_b64_tr_b16 v[40:41], v3 offset:1024
  v_fma_f32 v168, v168, v224, v232
  v_mfma_f32_16x16x32_bf16 v[180:183], v[76:79], v[44:47], v[180:183]
  ds_read_b64_tr_b16 v[42:43], v4 offset:1024
  v_fma_f32 v169, v169, v225, v233
  v_mfma_f32_16x16x32_bf16 v[180:183], v[124:127], v[104:107], v[180:183]
  ds_read_b128 v[116:119], v2 offset:0
  v_fma_f32 v170, v170, v226, v234
  v_mfma_f32_16x16x32_bf16 v[180:183], v[92:95], v[132:135], v[180:183]
  ds_read_b64_tr_b16 v[84:85], v3 offset:28864
  v_fma_f32 v171, v171, v227, v235
  v_mfma_f32_16x16x32_bf16 v[180:183], v[120:123], v[156:159], v[180:183]
  ds_read_b64_tr_b16 v[86:87], v4 offset:28864
  v_exp_f32 v248, v168
  v_mfma_f32_16x16x32_bf16 v[180:183], v[88:91], v[112:115], v[180:183]
  ds_read_b128 v[56:59], v1 offset:0
  v_exp_f32 v249, v169
  v_mfma_f32_16x16x32_bf16 v[208:211], v[64:67], v[244:247], v[208:211]
  ds_read_b64_tr_b16 v[60:61], v3 offset:2048
  v_exp_f32 v250, v170
  v_mfma_f32_16x16x32_bf16 v[208:211], v[68:71], v[96:99], v[208:211]
  ds_read_b64_tr_b16 v[62:63], v4 offset:2048
  v_exp_f32 v251, v171
  v_mfma_f32_16x16x32_bf16 v[208:211], v[16:19], v[100:103], v[208:211]
  ds_read_b128 v[164:167], v2 offset:2048
  v_fma_f32 v172, v172, v228, v236
  v_mfma_f32_16x16x32_bf16 v[208:211], v[24:27], v[136:139], v[208:211]
  ds_read_b64_tr_b16 v[36:37], v3 offset:29888
  v_fma_f32 v173, v173, v229, v237
  v_mfma_f32_16x16x32_bf16 v[212:215], v[80:83], v[244:247], v[212:215]
  ds_read_b64_tr_b16 v[38:39], v4 offset:29888
  v_fma_f32 v174, v174, v230, v238
  v_mfma_f32_16x16x32_bf16 v[212:215], v[240:243], v[96:99], v[212:215]
  ds_read_b128 v[44:47], v1 offset:2048
  v_fma_f32 v175, v175, v231, v239
  v_mfma_f32_16x16x32_bf16 v[212:215], v[48:51], v[100:103], v[212:215]
  ds_read_b64_tr_b16 v[152:153], v3 offset:0
  v_exp_f32 v252, v172
  v_mfma_f32_16x16x32_bf16 v[212:215], v[52:55], v[136:139], v[212:215]
  ds_read_b64_tr_b16 v[154:155], v4 offset:0
  v_exp_f32 v253, v173
  v_mfma_f32_16x16x32_bf16 v[184:187], v[20:23], v[104:107], v[184:187]
  ds_read_b64_tr_b16 v[64:65], v3 offset:27840
  v_exp_f32 v254, v174
  v_mfma_f32_16x16x32_bf16 v[184:187], v[28:31], v[132:135], v[184:187]
  ds_read_b64_tr_b16 v[66:67], v4 offset:27840
  v_exp_f32 v255, v175
  v_mfma_f32_16x16x32_bf16 v[184:187], v[148:151], v[156:159], v[184:187]
  ds_read_b128 v[68:71], v2 offset:4096
  v_fma_f32 v248, v248, s56, s56
  v_mfma_f32_16x16x32_bf16 v[184:187], v[128:131], v[112:115], v[184:187]
  ds_read_b128 v[16:19], v1 offset:4096
  v_fma_f32 v249, v249, s56, s56
  s_waitcnt lgkmcnt(10)
  v_mfma_f32_16x16x32_bf16 v[184:187], v[144:147], v[108:111], v[184:187]
  ds_read_b128 v[24:27], v2 offset:28672
  v_fma_f32 v250, v250, s56, s56
  v_mfma_f32_16x16x32_bf16 v[184:187], v[140:143], v[32:35], v[184:187]
  ds_read_b128 v[80:83], v1 offset:28672
  v_fma_f32 v251, v251, s56, s56
  v_mfma_f32_16x16x32_bf16 v[188:191], v[72:75], v[104:107], v[188:191]
  v_rcp_f32 v248, v248
  v_mfma_f32_16x16x32_bf16 v[188:191], v[76:79], v[132:135], v[188:191]
  v_rcp_f32 v249, v249
  v_mfma_f32_16x16x32_bf16 v[188:191], v[124:127], v[156:159], v[188:191]
  v_rcp_f32 v250, v250
  v_mfma_f32_16x16x32_bf16 v[188:191], v[92:95], v[112:115], v[188:191]
  v_rcp_f32 v251, v251
  v_mfma_f32_16x16x32_bf16 v[188:191], v[120:123], v[108:111], v[188:191]
  v_fma_f32 v252, v252, s56, s56
  v_fma_f32 v253, v253, s56, s56
  v_mfma_f32_16x16x32_bf16 v[188:191], v[88:91], v[32:35], v[188:191]
  v_fma_f32 v254, v254, s56, s56
  v_fma_f32 v255, v255, s56, s56
  v_mfma_f32_16x16x32_bf16 v[216:219], v[40:43], v[116:119], v[216:219]
  ds_read_b128 v[244:247], v2 offset:30720
  v_rcp_f32 v252, v252
  v_mfma_f32_16x16x32_bf16 v[216:219], v[84:87], v[56:59], v[216:219]
  ds_read_b128 v[240:243], v1 offset:30720
  v_rcp_f32 v253, v253
  s_waitcnt lgkmcnt(4)
  v_mfma_f32_16x16x32_bf16 v[216:219], v[60:63], v[164:167], v[216:219]
  v_rcp_f32 v254, v254
  v_mfma_f32_16x16x32_bf16 v[216:219], v[36:39], v[44:47], v[216:219]
  v_rcp_f32 v255, v255
  v_mfma_f32_16x16x32_bf16 v[220:223], v[152:155], v[116:119], v[220:223]
  v_mul_f32 v168, v168, v248
  v_mul_f32 v169, v169, v249
  v_mfma_f32_16x16x32_bf16 v[220:223], v[64:67], v[56:59], v[220:223]
  v_mul_f32 v170, v170, v250
  v_mul_f32 v171, v171, v251
  v_mfma_f32_16x16x32_bf16 v[220:223], v[40:43], v[164:167], v[220:223]
  v_cvt_pk_bf16_f32 v160, v168, v169
  v_cvt_pk_bf16_f32 v161, v170, v171
  v_mfma_f32_16x16x32_bf16 v[220:223], v[84:87], v[44:47], v[220:223]
  v_mul_f32 v172, v172, v252
  v_mul_f32 v173, v173, v253
  v_mfma_f32_16x16x32_bf16 v[220:223], v[60:63], v[68:71], v[220:223]
  v_mul_f32 v174, v174, v254
  v_mul_f32 v175, v175, v255
  v_mfma_f32_16x16x32_bf16 v[220:223], v[36:39], v[16:19], v[220:223]
  v_cvt_pk_bf16_f32 v162, v172, v173
  v_cvt_pk_bf16_f32 v163, v174, v175
  v_mfma_f32_16x16x32_bf16 v[192:195], v[20:23], v[156:159], v[192:195]
  buffer_store_dwordx4 v[160:163], v8, s[28:31], s48 offen offset:2304 sc1
  v_fma_f32 v176, v176, v224, v232
  v_mfma_f32_16x16x32_bf16 v[192:195], v[28:31], v[112:115], v[192:195]
  v_fma_f32 v177, v177, v225, v233
  v_fma_f32 v178, v178, v226, v234
  v_mfma_f32_16x16x32_bf16 v[192:195], v[148:151], v[108:111], v[192:195]
  v_fma_f32 v179, v179, v227, v235
  v_exp_f32 v248, v176
  v_mfma_f32_16x16x32_bf16 v[192:195], v[128:131], v[32:35], v[192:195]
  v_exp_f32 v249, v177
  s_waitcnt lgkmcnt(0)
  v_mfma_f32_16x16x32_bf16 v[192:195], v[144:147], v[24:27], v[192:195]
  v_exp_f32 v250, v178
  v_mfma_f32_16x16x32_bf16 v[192:195], v[140:143], v[80:83], v[192:195]
  v_exp_f32 v251, v179
  v_mfma_f32_16x16x32_bf16 v[196:199], v[72:75], v[156:159], v[196:199]
  v_subrev_u32 v3, 55680, v3
  v_fma_f32 v180, v180, v228, v236
  v_mfma_f32_16x16x32_bf16 v[196:199], v[76:79], v[112:115], v[196:199]
  v_subrev_u32 v4, 55680, v4
  v_fma_f32 v181, v181, v229, v237
  v_mfma_f32_16x16x32_bf16 v[196:199], v[124:127], v[108:111], v[196:199]
  ds_read_b64_tr_b16 v[96:97], v3 offset:1024
  v_fma_f32 v182, v182, v230, v238
  v_mfma_f32_16x16x32_bf16 v[196:199], v[92:95], v[32:35], v[196:199]
  ds_read_b64_tr_b16 v[98:99], v4 offset:1024
  v_fma_f32 v183, v183, v231, v239
  v_mfma_f32_16x16x32_bf16 v[196:199], v[120:123], v[24:27], v[196:199]
  ds_read_b128 v[48:51], v2 offset:16384
  v_exp_f32 v252, v180
  v_mfma_f32_16x16x32_bf16 v[196:199], v[88:91], v[80:83], v[196:199]
  ds_read_b64_tr_b16 v[100:101], v3 offset:28864
  v_exp_f32 v253, v181
  v_mfma_f32_16x16x32_bf16 v[200:203], v[20:23], v[108:111], v[200:203]
  ds_read_b64_tr_b16 v[102:103], v4 offset:28864
  v_exp_f32 v254, v182
  v_mfma_f32_16x16x32_bf16 v[200:203], v[28:31], v[32:35], v[200:203]
  ds_read_b128 v[52:55], v1 offset:16384
  v_exp_f32 v255, v183
  v_mfma_f32_16x16x32_bf16 v[200:203], v[148:151], v[24:27], v[200:203]
  ds_read_b64_tr_b16 v[136:137], v3 offset:2048
  v_fma_f32 v248, v248, s56, s56
  v_mfma_f32_16x16x32_bf16 v[200:203], v[128:131], v[80:83], v[200:203]
  ds_read_b64_tr_b16 v[138:139], v4 offset:2048
  v_fma_f32 v249, v249, s56, s56
  v_mfma_f32_16x16x32_bf16 v[200:203], v[144:147], v[244:247], v[200:203]
  ds_read_b128 v[104:107], v2 offset:18432
  v_fma_f32 v250, v250, s56, s56
  v_mfma_f32_16x16x32_bf16 v[200:203], v[140:143], v[240:243], v[200:203]
  ds_read_b64_tr_b16 v[132:133], v3 offset:29888
  v_fma_f32 v251, v251, s56, s56
  v_mfma_f32_16x16x32_bf16 v[204:207], v[72:75], v[108:111], v[204:207]
  ds_read_b64_tr_b16 v[134:135], v4 offset:29888
  v_rcp_f32 v248, v248
  v_mfma_f32_16x16x32_bf16 v[204:207], v[76:79], v[32:35], v[204:207]
  ds_read_b128 v[152:155], v1 offset:18432
  v_rcp_f32 v249, v249
  v_mfma_f32_16x16x32_bf16 v[204:207], v[124:127], v[24:27], v[204:207]
  ds_read_b64_tr_b16 v[116:117], v3 offset:0
  v_rcp_f32 v250, v250
  v_mfma_f32_16x16x32_bf16 v[204:207], v[92:95], v[80:83], v[204:207]
  ds_read_b64_tr_b16 v[118:119], v4 offset:0
  v_rcp_f32 v251, v251
  v_mfma_f32_16x16x32_bf16 v[204:207], v[120:123], v[244:247], v[204:207]
  ds_read_b64_tr_b16 v[64:65], v3 offset:27840
  v_fma_f32 v252, v252, s56, s56
  v_mfma_f32_16x16x32_bf16 v[204:207], v[88:91], v[240:243], v[204:207]
  ds_read_b64_tr_b16 v[66:67], v4 offset:27840
  v_fma_f32 v253, v253, s56, s56
  v_mfma_f32_16x16x32_bf16 v[208:211], v[20:23], v[24:27], v[208:211]
  ds_read_b128 v[56:59], v11 offset:0
  v_fma_f32 v254, v254, s56, s56
  v_mfma_f32_16x16x32_bf16 v[208:211], v[28:31], v[80:83], v[208:211]
  ds_read_b128 v[40:43], v11 offset:256
  v_fma_f32 v255, v255, s56, s56
  v_mfma_f32_16x16x32_bf16 v[208:211], v[148:151], v[244:247], v[208:211]
  ds_read_b128 v[164:167], v2 offset:20480
  v_rcp_f32 v252, v252
  v_mfma_f32_16x16x32_bf16 v[208:211], v[128:131], v[240:243], v[208:211]
  ds_read_b128 v[84:87], v1 offset:20480
  v_rcp_f32 v253, v253
  v_mfma_f32_16x16x32_bf16 v[212:215], v[72:75], v[24:27], v[212:215]
  v_rcp_f32 v254, v254
  v_mfma_f32_16x16x32_bf16 v[212:215], v[76:79], v[80:83], v[212:215]
  v_rcp_f32 v255, v255
  v_mfma_f32_16x16x32_bf16 v[212:215], v[124:127], v[244:247], v[212:215]
  v_mul_f32 v176, v176, v248
  v_mul_f32 v177, v177, v249
  v_mfma_f32_16x16x32_bf16 v[212:215], v[92:95], v[240:243], v[212:215]
  v_mul_f32 v178, v178, v250
  v_mul_f32 v179, v179, v251
  s_waitcnt lgkmcnt(6)
  v_mfma_f32_16x16x32_bf16 v[216:219], v[96:99], v[48:51], v[216:219]
  v_cvt_pk_bf16_f32 v168, v176, v177
  v_cvt_pk_bf16_f32 v169, v178, v179
  v_mfma_f32_16x16x32_bf16 v[216:219], v[100:103], v[52:55], v[216:219]
  v_mul_f32 v180, v180, v252
  v_mul_f32 v181, v181, v253
  v_mfma_f32_16x16x32_bf16 v[216:219], v[136:139], v[104:107], v[216:219]
  v_mul_f32 v182, v182, v254
  v_mul_f32 v183, v183, v255
  v_mfma_f32_16x16x32_bf16 v[216:219], v[132:135], v[152:155], v[216:219]
  v_cvt_pk_bf16_f32 v170, v180, v181
  v_cvt_pk_bf16_f32 v171, v182, v183
  v_mfma_f32_16x16x32_bf16 v[220:223], v[116:119], v[48:51], v[220:223]
  buffer_store_dwordx4 v[168:171], v8, s[28:31], s48 offen offset:3456 sc1
  v_fma_f32 v184, v184, v224, v232
  s_waitcnt lgkmcnt(1)
  v_mfma_f32_16x16x32_bf16 v[220:223], v[64:67], v[52:55], v[220:223]
  v_fma_f32 v185, v185, v225, v233
  v_fma_f32 v186, v186, v226, v234
  v_mfma_f32_16x16x32_bf16 v[220:223], v[96:99], v[104:107], v[220:223]
  v_fma_f32 v187, v187, v227, v235
  v_exp_f32 v248, v184
  v_mfma_f32_16x16x32_bf16 v[220:223], v[100:103], v[152:155], v[220:223]
  v_exp_f32 v249, v185
  v_mfma_f32_16x16x32_bf16 v[220:223], v[136:139], v[164:167], v[220:223]
  v_exp_f32 v250, v186
  s_waitcnt lgkmcnt(0)
  v_mfma_f32_16x16x32_bf16 v[220:223], v[132:135], v[84:87], v[220:223]
  v_exp_f32 v251, v187
  v_pk_fma_f32 v[188:189], v[188:189], v[228:229], v[236:237]
  v_pk_fma_f32 v[190:191], v[190:191], v[230:231], v[238:239]
  v_exp_f32 v252, v188
  v_exp_f32 v253, v189
  v_exp_f32 v254, v190
  v_exp_f32 v255, v191
  v_pk_fma_f32 v[248:249], v[248:249], s[56:57], s[56:57]
  v_pk_fma_f32 v[250:251], v[250:251], s[56:57], s[56:57]
  v_rcp_f32 v248, v248
  v_rcp_f32 v249, v249
  v_rcp_f32 v250, v250
  v_rcp_f32 v251, v251
  v_pk_fma_f32 v[252:253], v[252:253], s[56:57], s[56:57]
  v_pk_fma_f32 v[254:255], v[254:255], s[56:57], s[56:57]
  v_rcp_f32 v252, v252
  v_rcp_f32 v253, v253
  v_rcp_f32 v254, v254
  v_rcp_f32 v255, v255
  v_pk_mul_f32 v[184:185], v[184:185], v[248:249]
  v_pk_mul_f32 v[186:187], v[186:187], v[250:251]
  v_cvt_pk_bf16_f32 v176, v184, v185
  v_cvt_pk_bf16_f32 v177, v186, v187
  v_pk_mul_f32 v[188:189], v[188:189], v[252:253]
  v_pk_mul_f32 v[190:191], v[190:191], v[254:255]
  v_cvt_pk_bf16_f32 v178, v188, v189
  v_cvt_pk_bf16_f32 v179, v190, v191
  buffer_store_dwordx4 v[176:179], v8, s[28:31], s49 offen offset:0 sc1
  v_pk_fma_f32 v[192:193], v[192:193], v[224:225], v[232:233]
  v_pk_fma_f32 v[194:195], v[194:195], v[226:227], v[234:235]
  v_exp_f32 v248, v192
  v_exp_f32 v249, v193
  v_exp_f32 v250, v194
  v_exp_f32 v251, v195
  v_pk_fma_f32 v[196:197], v[196:197], v[228:229], v[236:237]
  v_pk_fma_f32 v[198:199], v[198:199], v[230:231], v[238:239]
  v_exp_f32 v252, v196
  v_exp_f32 v253, v197
  v_exp_f32 v254, v198
  v_exp_f32 v255, v199
  v_pk_fma_f32 v[248:249], v[248:249], s[56:57], s[56:57]
  v_pk_fma_f32 v[250:251], v[250:251], s[56:57], s[56:57]
  v_rcp_f32 v248, v248
  v_rcp_f32 v249, v249
  v_rcp_f32 v250, v250
  v_rcp_f32 v251, v251
  v_pk_fma_f32 v[252:253], v[252:253], s[56:57], s[56:57]
  v_pk_fma_f32 v[254:255], v[254:255], s[56:57], s[56:57]
  v_rcp_f32 v252, v252
  v_rcp_f32 v253, v253
  v_rcp_f32 v254, v254
  v_rcp_f32 v255, v255
  v_pk_mul_f32 v[192:193], v[192:193], v[248:249]
  v_pk_mul_f32 v[194:195], v[194:195], v[250:251]
  v_cvt_pk_bf16_f32 v184, v192, v193
  v_cvt_pk_bf16_f32 v185, v194, v195
  v_pk_mul_f32 v[196:197], v[196:197], v[252:253]
  v_pk_mul_f32 v[198:199], v[198:199], v[254:255]
  v_cvt_pk_bf16_f32 v186, v196, v197
  v_cvt_pk_bf16_f32 v187, v198, v199
  buffer_store_dwordx4 v[184:187], v8, s[28:31], s49 offen offset:1152 sc1
  v_pk_fma_f32 v[200:201], v[200:201], v[224:225], v[232:233]
  v_pk_fma_f32 v[202:203], v[202:203], v[226:227], v[234:235]
  v_exp_f32 v248, v200
  v_exp_f32 v249, v201
  v_exp_f32 v250, v202
  v_exp_f32 v251, v203
  v_pk_fma_f32 v[204:205], v[204:205], v[228:229], v[236:237]
  v_pk_fma_f32 v[206:207], v[206:207], v[230:231], v[238:239]
  v_exp_f32 v252, v204
  v_exp_f32 v253, v205
  v_exp_f32 v254, v206
  v_exp_f32 v255, v207
  v_pk_fma_f32 v[248:249], v[248:249], s[56:57], s[56:57]
  v_pk_fma_f32 v[250:251], v[250:251], s[56:57], s[56:57]
  v_rcp_f32 v248, v248
  v_rcp_f32 v249, v249
  v_rcp_f32 v250, v250
  v_rcp_f32 v251, v251
  v_pk_fma_f32 v[252:253], v[252:253], s[56:57], s[56:57]
  v_pk_fma_f32 v[254:255], v[254:255], s[56:57], s[56:57]
  v_rcp_f32 v252, v252
  v_rcp_f32 v253, v253
  v_rcp_f32 v254, v254
  v_rcp_f32 v255, v255
  v_pk_mul_f32 v[200:201], v[200:201], v[248:249]
  v_pk_mul_f32 v[202:203], v[202:203], v[250:251]
  v_cvt_pk_bf16_f32 v192, v200, v201
  v_cvt_pk_bf16_f32 v193, v202, v203
  v_pk_mul_f32 v[204:205], v[204:205], v[252:253]
  v_pk_mul_f32 v[206:207], v[206:207], v[254:255]
  v_cvt_pk_bf16_f32 v194, v204, v205
  v_cvt_pk_bf16_f32 v195, v206, v207
  buffer_store_dwordx4 v[192:195], v8, s[28:31], s49 offen offset:2304 sc1
  v_pk_fma_f32 v[208:209], v[208:209], v[224:225], v[232:233]
  v_pk_fma_f32 v[210:211], v[210:211], v[226:227], v[234:235]
  v_exp_f32 v248, v208
  v_exp_f32 v249, v209
  v_exp_f32 v250, v210
  v_exp_f32 v251, v211
  v_pk_fma_f32 v[212:213], v[212:213], v[228:229], v[236:237]
  v_pk_fma_f32 v[214:215], v[214:215], v[230:231], v[238:239]
  v_exp_f32 v252, v212
  v_exp_f32 v253, v213
  v_exp_f32 v254, v214
  v_exp_f32 v255, v215
  v_pk_fma_f32 v[248:249], v[248:249], s[56:57], s[56:57]
  v_pk_fma_f32 v[250:251], v[250:251], s[56:57], s[56:57]
  v_rcp_f32 v248, v248
  v_rcp_f32 v249, v249
  v_rcp_f32 v250, v250
  v_rcp_f32 v251, v251
  v_pk_fma_f32 v[252:253], v[252:253], s[56:57], s[56:57]
  v_pk_fma_f32 v[254:255], v[254:255], s[56:57], s[56:57]
  v_rcp_f32 v252, v252
  v_rcp_f32 v253, v253
  v_rcp_f32 v254, v254
  v_rcp_f32 v255, v255
  v_pk_mul_f32 v[208:209], v[208:209], v[248:249]
  v_pk_mul_f32 v[210:211], v[210:211], v[250:251]
  v_cvt_pk_bf16_f32 v200, v208, v209
  v_cvt_pk_bf16_f32 v201, v210, v211
  v_pk_mul_f32 v[212:213], v[212:213], v[252:253]
  v_pk_mul_f32 v[214:215], v[214:215], v[254:255]
  v_cvt_pk_bf16_f32 v202, v212, v213
  v_cvt_pk_bf16_f32 v203, v214, v215
  buffer_store_dwordx4 v[200:203], v8, s[28:31], s49 offen offset:3456 sc1
  v_pk_fma_f32 v[216:217], v[216:217], v[56:57], v[40:41]
  v_pk_fma_f32 v[218:219], v[218:219], v[58:59], v[42:43]
  v_exp_f32 v248, v216
  v_exp_f32 v249, v217
  v_exp_f32 v250, v218
  v_exp_f32 v251, v219
  v_pk_fma_f32 v[220:221], v[220:221], v[56:57], v[40:41]
  v_pk_fma_f32 v[222:223], v[222:223], v[58:59], v[42:43]
  v_exp_f32 v252, v220
  v_exp_f32 v253, v221
  v_exp_f32 v254, v222
  v_exp_f32 v255, v223
  v_pk_fma_f32 v[248:249], v[248:249], s[56:57], s[56:57]
  v_pk_fma_f32 v[250:251], v[250:251], s[56:57], s[56:57]
  v_rcp_f32 v248, v248
  v_rcp_f32 v249, v249
  v_rcp_f32 v250, v250
  v_rcp_f32 v251, v251
  v_pk_fma_f32 v[252:253], v[252:253], s[56:57], s[56:57]
  v_pk_fma_f32 v[254:255], v[254:255], s[56:57], s[56:57]
  v_rcp_f32 v252, v252
  v_rcp_f32 v253, v253
  v_rcp_f32 v254, v254
  v_rcp_f32 v255, v255
  v_pk_mul_f32 v[216:217], v[216:217], v[248:249]
  v_pk_mul_f32 v[218:219], v[218:219], v[250:251]
  v_cvt_pk_bf16_f32 v208, v216, v217
  v_cvt_pk_bf16_f32 v209, v218, v219
  v_pk_mul_f32 v[220:221], v[220:221], v[252:253]
  v_pk_mul_f32 v[222:223], v[222:223], v[254:255]
  v_cvt_pk_bf16_f32 v210, v220, v221
  v_cvt_pk_bf16_f32 v211, v222, v223
  s_nop 1
  v_permlane16_swap_b32 v208, v210
  v_permlane16_swap_b32 v209, v211
  buffer_store_dwordx4 v[208:211], v9, s[28:31], s50 offen
  s_endpgm
.fill ((712 - (. - L_base)) & 4095) / 4, 4, 0xbf810000
L_sp1_go:
  s_cmp_eq_u32 0, 0
  s_branch L_t_sp1_0
L_r_sp1_0:
  s_barrier
  s_mov_b32 s53, 6
  s_mov_b32 s54, 1
  s_mov_b32 s52, 55680
  s_mov_b32 s55, 16384
  s_mov_b32 s51, 16384
  ds_read_b64_tr_b16 v[64:65], v6 offset:4128
  ds_read_b64_tr_b16 v[66:67], v6 offset:4640
  ds_read_b128 v[16:19], v2 offset:0
  ds_read_b64_tr_b16 v[68:69], v6 offset:8256
  ds_read_b64_tr_b16 v[70:71], v6 offset:8768
  ds_read_b128 v[20:23], v2 offset:2048
  ds_read_b64_tr_b16 v[80:81], v7 offset:8256
  ds_read_b64_tr_b16 v[82:83], v7 offset:8768
  ds_read_b64_tr_b16 v[76:77], v7 offset:4128
  ds_read_b64_tr_b16 v[78:79], v7 offset:4640
  ds_read_b64_tr_b16 v[60:61], v6 offset:0
  ds_read_b64_tr_b16 v[62:63], v6 offset:512
  ds_read_b128 v[24:27], v2 offset:4096
  ds_read_b64_tr_b16 v[72:73], v7 offset:0
  ds_read_b64_tr_b16 v[74:75], v7 offset:512
  ds_read_b128 v[28:31], v2 offset:6144
  ds_read_b128 v[32:35], v2 offset:8192
  ds_read_b128 v[36:39], v2 offset:10240
  ds_read_b128 v[40:43], v2 offset:12288
  ds_read_b128 v[44:47], v2 offset:14336
  ds_read_b64_tr_b16 v[48:49], v3 offset:0
  ds_read_b64_tr_b16 v[50:51], v4 offset:0
  ds_read_b64_tr_b16 v[52:53], v3 offset:1024
  ds_read_b64_tr_b16 v[54:55], v4 offset:1024
  ds_read_b64_tr_b16 v[56:57], v3 offset:2048
  ds_read_b64_tr_b16 v[58:59], v4 offset:2048
  s_waitcnt lgkmcnt(15)
  v_mfma_f32_16x16x32_bf16 v[152:155], v[64:67], v[16:19], 0
  v_mfma_f32_16x16x32_bf16 v[152:155], v[68:71], v[20:23], v[152:155]
  v_mfma_f32_16x16x32_bf16 v[156:159], v[80:83], v[20:23], 0
  v_mfma_f32_16x16x32_bf16 v[156:159], v[76:79], v[16:19], v[156:159]
  s_waitcnt lgkmcnt(0)
  s_barrier
  ds_read_b64_tr_b16 v[132:133], v6 offset:31968
  v_mfma_f32_16x16x32_bf16 v[160:163], v[60:63], v[16:19], 0
  ds_read_b64_tr_b16 v[134:135], v6 offset:32480
  v_mfma_f32_16x16x32_bf16 v[160:163], v[64:67], v[20:23], v[160:163]
  ds_read_b128 v[84:87], v1 offset:0
  v_mfma_f32_16x16x32_bf16 v[160:163], v[68:71], v[24:27], v[160:163]
  v_mfma_f32_16x16x32_bf16 v[164:167], v[80:83], v[24:27], 0
  ds_read_b64_tr_b16 v[136:137], v6 offset:36096
  v_mfma_f32_16x16x32_bf16 v[164:167], v[76:79], v[20:23], v[164:167]
  ds_read_b64_tr_b16 v[138:139], v6 offset:36608
  v_mfma_f32_16x16x32_bf16 v[164:167], v[72:75], v[16:19], v[164:167]
  ds_read_b128 v[88:91], v1 offset:2048
  v_mfma_f32_16x16x32_bf16 v[168:171], v[60:63], v[20:23], 0
  v_mfma_f32_16x16x32_bf16 v[168:171], v[64:67], v[24:27], v[168:171]
  ds_read_b64_tr_b16 v[148:149], v7 offset:36096
  v_mfma_f32_16x16x32_bf16 v[168:171], v[68:71], v[28:31], v[168:171]
  ds_read_b64_tr_b16 v[150:151], v7 offset:36608
  v_mfma_f32_16x16x32_bf16 v[172:175], v[80:83], v[28:31], 0
  ds_read_b64_tr_b16 v[144:145], v7 offset:31968
  v_mfma_f32_16x16x32_bf16 v[172:175], v[76:79], v[24:27], v[172:175]
  ds_read_b64_tr_b16 v[146:147], v7 offset:32480
  v_mfma_f32_16x16x32_bf16 v[172:175], v[72:75], v[20:23], v[172:175]
  ds_read_b64_tr_b16 v[128:129], v6 offset:27840
  v_mfma_f32_16x16x32_bf16 v[176:179], v[60:63], v[24:27], 0
  ds_read_b64_tr_b16 v[130:131], v6 offset:28352
  v_mfma_f32_16x16x32_bf16 v[176:179], v[64:67], v[28:31], v[176:179]
  ds_read_b128 v[92:95], v1 offset:4096
  v_mfma_f32_16x16x32_bf16 v[176:179], v[68:71], v[32:35], v[176:179]
  v_mfma_f32_16x16x32_bf16 v[180:183], v[80:83], v[32:35], 0
  ds_read_b64_tr_b16 v[140:141], v7 offset:27840
  v_mfma_f32_16x16x32_bf16 v[180:183], v[76:79], v[28:31], v[180:183]
  ds_read_b64_tr_b16 v[142:143], v7 offset:28352
  v_mfma_f32_16x16x32_bf16 v[180:183], v[72:75], v[24:27], v[180:183]
  v_mfma_f32_16x16x32_bf16 v[184:187], v[60:63], v[28:31], 0
  ds_read_b128 v[96:99], v1 offset:6144
  v_mfma_f32_16x16x32_bf16 v[184:187], v[64:67], v[32:35], v[184:187]
  v_mfma_f32_16x16x32_bf16 v[184:187], v[68:71], v[36:39], v[184:187]
  ds_read_b128 v[100:103], v1 offset:8192
  v_mfma_f32_16x16x32_bf16 v[188:191], v[80:83], v[36:39], 0
  v_mfma_f32_16x16x32_bf16 v[188:191], v[76:79], v[32:35], v[188:191]
  ds_read_b128 v[104:107], v1 offset:10240
  v_mfma_f32_16x16x32_bf16 v[188:191], v[72:75], v[28:31], v[188:191]
  v_mfma_f32_16x16x32_bf16 v[192:195], v[60:63], v[32:35], 0
  ds_read_b128 v[108:111], v1 offset:12288
  v_mfma_f32_16x16x32_bf16 v[192:195], v[64:67], v[36:39], v[192:195]
  v_mfma_f32_16x16x32_bf16 v[192:195], v[68:71], v[40:43], v[192:195]
  ds_read_b128 v[112:115], v1 offset:14336
  v_mfma_f32_16x16x32_bf16 v[196:199], v[80:83], v[40:43], 0
  v_mfma_f32_16x16x32_bf16 v[196:199], v[76:79], v[36:39], v[196:199]
  ds_read_b64_tr_b16 v[116:117], v3 offset:27840
  v_mfma_f32_16x16x32_bf16 v[196:199], v[72:75], v[32:35], v[196:199]
  ds_read_b64_tr_b16 v[118:119], v4 offset:27840
  v_mfma_f32_16x16x32_bf16 v[200:203], v[60:63], v[36:39], 0
  ds_read_b64_tr_b16 v[120:121], v3 offset:28864
  v_mfma_f32_16x16x32_bf16 v[200:203], v[64:67], v[40:43], v[200:203]
  ds_read_b64_tr_b16 v[122:123], v4 offset:28864
  v_mfma_f32_16x16x32_bf16 v[200:203], v[68:71], v[44:47], v[200:203]
  ds_read_b64_tr_b16 v[124:125], v3 offset:29888
  v_mfma_f32_16x16x32_bf16 v[204:207], v[80:83], v[44:47], 0
  ds_read_b64_tr_b16 v[126:127], v4 offset:29888
  v_mfma_f32_16x16x32_bf16 v[204:207], v[76:79], v[40:43], v[204:207]
  v_mfma_f32_16x16x32_bf16 v[204:207], v[72:75], v[36:39], v[204:207]
  v_mfma_f32_16x16x32_bf16 v[208:211], v[60:63], v[40:43], 0
  v_add_u32 v2, s51, v2
  v_add_u32 v1, s51, v1
  v_mfma_f32_16x16x32_bf16 v[208:211], v[64:67], v[44:47], v[208:211]
  v_add_u32 v6, s52, v6
  v_add_u32 v7, s52, v7
  v_mfma_f32_16x16x32_bf16 v[212:215], v[76:79], v[44:47], 0
  v_add_u32 v3, s52, v3
  v_add_u32 v4, s52, v4
  v_mfma_f32_16x16x32_bf16 v[212:215], v[72:75], v[40:43], v[212:215]
  s_cmp_eq_u32 s54, 2
  s_cselect_b32 s51, 4294934528, s55
  v_mfma_f32_16x16x32_bf16 v[216:219], v[48:51], v[20:23], 0
  s_cselect_b32 s54, -1, s54
  s_add_u32 s54, s54, 1
  v_mfma_f32_16x16x32_bf16 v[216:219], v[52:55], v[24:27], v[216:219]
  s_sub_u32 s52, 0, s52
  v_mfma_f32_16x16x32_bf16 v[216:219], v[56:59], v[28:31], v[216:219]
  v_mfma_f32_16x16x32_bf16 v[220:223], v[56:59], v[32:35], 0
  v_mfma_f32_16x16x32_bf16 v[220:223], v[52:55], v[28:31], v[220:223]
  v_mfma_f32_16x16x32_bf16 v[220:223], v[48:51], v[24:27], v[220:223]
L_sp1_loop:
  s_waitcnt lgkmcnt(0)
  v_mfma_f32_16x16x32_bf16 v[152:155], v[132:135], v[84:87], v[152:155]
  s_barrier
  ds_read_b64_tr_b16 v[64:65], v6 offset:4128
  v_mfma_f32_16x16x32_bf16 v[152:155], v[136:139], v[88:91], v[152:155]
  ds_read_b64_tr_b16 v[66:67], v6 offset:4640
  v_mfma_f32_16x16x32_bf16 v[156:159], v[148:151], v[88:91], v[156:159]
  ds_read_b128 v[16:19], v2 offset:0
  v_mfma_f32_16x16x32_bf16 v[156:159], v[144:147], v[84:87], v[156:159]
  v_mfma_f32_16x16x32_bf16 v[160:163], v[128:131], v[84:87], v[160:163]
  ds_read_b64_tr_b16 v[68:69], v6 offset:8256
  v_mfma_f32_16x16x32_bf16 v[160:163], v[132:135], v[88:91], v[160:163]
  ds_read_b64_tr_b16 v[70:71], v6 offset:8768
  v_mfma_f32_16x16x32_bf16 v[160:163], v[136:139], v[92:95], v[160:163]
  ds_read_b128 v[20:23], v2 offset:2048
  v_mfma_f32_16x16x32_bf16 v[164:167], v[148:151], v[92:95], v[164:167]
  v_mfma_f32_16x16x32_bf16 v[164:167], v[144:147], v[88:91], v[164:167]
  ds_read_b64_tr_b16 v[80:81], v7 offset:8256
  v_mfma_f32_16x16x32_bf16 v[164:167], v[140:143], v[84:87], v[164:167]
  ds_read_b64_tr_b16 v[82:83], v7 offset:8768
  v_mfma_f32_16x16x32_bf16 v[168:171], v[128:131], v[88:91], v[168:171]
  ds_read_b64_tr_b16 v[76:77], v7 offset:4128
  v_mfma_f32_16x16x32_bf16 v[168:171], v[132:135], v[92:95], v[168:171]
  ds_read_b64_tr_b16 v[78:79], v7 offset:4640
  v_mfma_f32_16x16x32_bf16 v[168:171], v[136:139], v[96:99], v[168:171]
  ds_read_b64_tr_b16 v[60:61], v6 offset:0
  v_mfma_f32_16x16x32_bf16 v[172:175], v[148:151], v[96:99], v[172:175]
  ds_read_b64_tr_b16 v[62:63], v6 offset:512
  v_mfma_f32_16x16x32_bf16 v[172:175], v[144:147], v[92:95], v[172:175]
  ds_read_b128 v[24:27], v2 offset:4096
  v_mfma_f32_16x16x32_bf16 v[172:175], v[140:143], v[88:91], v[172:175]
  v_mfma_f32_16x16x32_bf16 v[176:179], v[128:131], v[92:95], v[176:179]
  ds_read_b64_tr_b16 v[72:73], v7 offset:0
  v_mfma_f32_16x16x32_bf16 v[176:179], v[132:135], v[96:99], v[176:179]
  ds_read_b64_tr_b16 v[74:75], v7 offset:512
  v_mfma_f32_16x16x32_bf16 v[176:179], v[136:139], v[100:103], v[176:179]
  v_mfma_f32_16x16x32_bf16 v[180:183], v[148:151], v[100:103], v[180:183]
  ds_read_b128 v[28:31], v2 offset:6144
  v_mfma_f32_16x16x32_bf16 v[180:183], v[144:147], v[96:99], v[180:183]
  v_mfma_f32_16x16x32_bf16 v[180:183], v[140:143], v[92:95], v[180:183]
  ds_read_b128 v[32:35], v2 offset:8192
  v_mfma_f32_16x16x32_bf16 v[184:187], v[128:131], v[96:99], v[184:187]
  v_mfma_f32_16x16x32_bf16 v[184:187], v[132:135], v[100:103], v[184:187]
  ds_read_b128 v[36:39], v2 offset:10240
  v_mfma_f32_16x16x32_bf16 v[184:187], v[136:139], v[104:107], v[184:187]
  v_mfma_f32_16x16x32_bf16 v[188:191], v[148:151], v[104:107], v[188:191]
  ds_read_b128 v[40:43], v2 offset:12288
  v_mfma_f32_16x16x32_bf16 v[188:191], v[144:147], v[100:103], v[188:191]
  v_mfma_f32_16x16x32_bf16 v[188:191], v[140:143], v[96:99], v[188:191]
  ds_read_b128 v[44:47], v2 offset:14336
  v_mfma_f32_16x16x32_bf16 v[192:195], v[128:131], v[100:103], v[192:195]
  v_mfma_f32_16x16x32_bf16 v[192:195], v[132:135], v[104:107], v[192:195]
  ds_read_b64_tr_b16 v[48:49], v3 offset:0
  v_mfma_f32_16x16x32_bf16 v[192:195], v[136:139], v[108:111], v[192:195]
  ds_read_b64_tr_b16 v[50:51], v4 offset:0
  v_mfma_f32_16x16x32_bf16 v[196:199], v[148:151], v[108:111], v[196:199]
  ds_read_b64_tr_b16 v[52:53], v3 offset:1024
  v_mfma_f32_16x16x32_bf16 v[196:199], v[144:147], v[104:107], v[196:199]
  ds_read_b64_tr_b16 v[54:55], v4 offset:1024
  v_mfma_f32_16x16x32_bf16 v[196:199], v[140:143], v[100:103], v[196:199]
  ds_read_b64_tr_b16 v[56:57], v3 offset:2048
  v_mfma_f32_16x16x32_bf16 v[200:203], v[128:131], v[104:107], v[200:203]
  ds_read_b64_tr_b16 v[58:59], v4 offset:2048
  v_mfma_f32_16x16x32_bf16 v[200:203], v[132:135], v[108:111], v[200:203]
  v_mfma_f32_16x16x32_bf16 v[200:203], v[136:139], v[112:115], v[200:203]
  v_mfma_f32_16x16x32_bf16 v[204:207], v[148:151], v[112:115], v[204:207]
  v_mfma_f32_16x16x32_bf16 v[204:207], v[144:147], v[108:111], v[204:207]
  v_mfma_f32_16x16x32_bf16 v[204:207], v[140:143], v[104:107], v[204:207]
  v_mfma_f32_16x16x32_bf16 v[208:211], v[128:131], v[108:111], v[208:211]
  v_mfma_f32_16x16x32_bf16 v[208:211], v[132:135], v[112:115], v[208:211]
  v_mfma_f32_16x16x32_bf16 v[212:215], v[144:147], v[112:115], v[212:215]
  v_mfma_f32_16x16x32_bf16 v[212:215], v[140:143], v[108:111], v[212:215]
  v_mfma_f32_16x16x32_bf16 v[216:219], v[116:119], v[88:91], v[216:219]
  v_mfma_f32_16x16x32_bf16 v[216:219], v[120:123], v[92:95], v[216:219]
  v_mfma_f32_16x16x32_bf16 v[216:219], v[124:127], v[96:99], v[216:219]
  v_mfma_f32_16x16x32_bf16 v[220:223], v[124:127], v[100:103], v[220:223]
  v_mfma_f32_16x16x32_bf16 v[220:223], v[120:123], v[96:99], v[220:223]
  v_mfma_f32_16x16x32_bf16 v[220:223], v[116:119], v[92:95], v[220:223]
  s_waitcnt lgkmcnt(0)
  v_mfma_f32_16x16x32_bf16 v[152:155], v[64:67], v[16:19], v[152:155]
  s_barrier
  ds_read_b64_tr_b16 v[132:133], v6 offset:31968
  v_mfma_f32_16x16x32_bf16 v[152:155], v[68:71], v[20:23], v[152:155]
  ds_read_b64_tr_b16 v[134:135], v6 offset:32480
  v_mfma_f32_16x16x32_bf16 v[156:159], v[80:83], v[20:23], v[156:159]
  ds_read_b128 v[84:87], v1 offset:0
  v_mfma_f32_16x16x32_bf16 v[156:159], v[76:79], v[16:19], v[156:159]
  v_mfma_f32_16x16x32_bf16 v[160:163], v[60:63], v[16:19], v[160:163]
  ds_read_b64_tr_b16 v[136:137], v6 offset:36096
  v_mfma_f32_16x16x32_bf16 v[160:163], v[64:67], v[20:23], v[160:163]
  ds_read_b64_tr_b16 v[138:139], v6 offset:36608
  v_mfma_f32_16x16x32_bf16 v[160:163], v[68:71], v[24:27], v[160:163]
  ds_read_b128 v[88:91], v1 offset:2048
  v_mfma_f32_16x16x32_bf16 v[164:167], v[80:83], v[24:27], v[164:167]
  v_mfma_f32_16x16x32_bf16 v[164:167], v[76:79], v[20:23], v[164:167]
  ds_read_b64_tr_b16 v[148:149], v7 offset:36096
  v_mfma_f32_16x16x32_bf16 v[164:167], v[72:75], v[16:19], v[164:167]
  ds_read_b64_tr_b16 v[150:151], v7 offset:36608
  v_mfma_f32_16x16x32_bf16 v[168:171], v[60:63], v[20:23], v[168:171]
  ds_read_b64_tr_b16 v[144:145], v7 offset:31968
  v_mfma_f32_16x16x32_bf16 v[168:171], v[64:67], v[24:27], v[168:171]
  ds_read_b64_tr_b16 v[146:147], v7 offset:32480
  v_mfma_f32_16x16x32_bf16 v[168:171], v[68:71], v[28:31], v[168:171]
  ds_read_b64_tr_b16 v[128:129], v6 offset:27840
  v_mfma_f32_16x16x32_bf16 v[172:175], v[80:83], v[28:31], v[172:175]
  ds_read_b64_tr_b16 v[130:131], v6 offset:28352
  v_mfma_f32_16x16x32_bf16 v[172:175], v[76:79], v[24:27], v[172:175]
  ds_read_b128 v[92:95], v1 offset:4096
  v_mfma_f32_16x16x32_bf16 v[172:175], v[72:75], v[20:23], v[172:175]
  v_mfma_f32_16x16x32_bf16 v[176:179], v[60:63], v[24:27], v[176:179]
  ds_read_b64_tr_b16 v[140:141], v7 offset:27840
  v_mfma_f32_16x16x32_bf16 v[176:179], v[64:67], v[28:31], v[176:179]
  ds_read_b64_tr_b16 v[142:143], v7 offset:28352
  v_mfma_f32_16x16x32_bf16 v[176:179], v[68:71], v[32:35], v[176:179]
  v_mfma_f32_16x16x32_bf16 v[180:183], v[80:83], v[32:35], v[180:183]
  ds_read_b128 v[96:99], v1 offset:6144
  v_mfma_f32_16x16x32_bf16 v[180:183], v[76:79], v[28:31], v[180:183]
  v_mfma_f32_16x16x32_bf16 v[180:183], v[72:75], v[24:27], v[180:183]
  ds_read_b128 v[100:103], v1 offset:8192
  v_mfma_f32_16x16x32_bf16 v[184:187], v[60:63], v[28:31], v[184:187]
  v_mfma_f32_16x16x32_bf16 v[184:187], v[64:67], v[32:35], v[184:187]
  ds_read_b128 v[104:107], v1 offset:10240
  v_mfma_f32_16x16x32_bf16 v[184:187], v[68:71], v[36:39], v[184:187]
  v_mfma_f32_16x16x32_bf16 v[188:191], v[80:83], v[36:39], v[188:191]
  ds_read_b128 v[108:111], v1 offset:12288
  v_mfma_f32_16x16x32_bf16 v[188:191], v[76:79], v[32:35], v[188:191]
  v_mfma_f32_16x16x32_bf16 v[188:191], v[72:75], v[28:31], v[188:191]
  ds_read_b128 v[112:115], v1 offset:14336
  v_mfma_f32_16x16x32_bf16 v[192:195], v[60:63], v[32:35], v[192:195]
  v_mfma_f32_16x16x32_bf16 v[192:195], v[64:67], v[36:39], v[192:195]
  ds_read_b64_tr_b16 v[116:117], v3 offset:27840
  v_mfma_f32_16x16x32_bf16 v[192:195], v[68:71], v[40:43], v[192:195]
  ds_read_b64_tr_b16 v[118:119], v4 offset:27840
  v_mfma_f32_16x16x32_bf16 v[196:199], v[80:83], v[40:43], v[196:199]
  ds_read_b64_tr_b16 v[120:121], v3 offset:28864
  v_mfma_f32_16x16x32_bf16 v[196:199], v[76:79], v[36:39], v[196:199]
  ds_read_b64_tr_b16 v[122:123], v4 offset:28864
  v_mfma_f32_16x16x32_bf16 v[196:199], v[72:75], v[32:35], v[196:199]
  ds_read_b64_tr_b16 v[124:125], v3 offset:29888
  v_mfma_f32_16x16x32_bf16 v[200:203], v[60:63], v[36:39], v[200:203]
  ds_read_b64_tr_b16 v[126:127], v4 offset:29888
  v_mfma_f32_16x16x32_bf16 v[200:203], v[64:67], v[40:43], v[200:203]
  v_mfma_f32_16x16x32_bf16 v[200:203], v[68:71], v[44:47], v[200:203]
  v_mfma_f32_16x16x32_bf16 v[204:207], v[80:83], v[44:47], v[204:207]
  v_add_u32 v2, s51, v2
  v_add_u32 v1, s51, v1
  v_mfma_f32_16x16x32_bf16 v[204:207], v[76:79], v[40:43], v[204:207]
  v_add_u32 v6, s52, v6
  v_add_u32 v7, s52, v7
  v_mfma_f32_16x16x32_bf16 v[204:207], v[72:75], v[36:39], v[204:207]
  v_add_u32 v3, s52, v3
  v_add_u32 v4, s52, v4
  v_mfma_f32_16x16x32_bf16 v[208:211], v[60:63], v[40:43], v[208:211]
  s_cmp_eq_u32 s54, 2
  s_cselect_b32 s51, 4294934528, s55
  v_mfma_f32_16x16x32_bf16 v[208:211], v[64:67], v[44:47], v[208:211]
  s_cselect_b32 s54, -1, s54
  s_add_u32 s54, s54, 1
  v_mfma_f32_16x16x32_bf16 v[212:215], v[76:79], v[44:47], v[212:215]
  s_sub_u32 s52, 0, s52
  s_sub_u32 s53, s53, 1
  v_mfma_f32_16x16x32_bf16 v[212:215], v[72:75], v[40:43], v[212:215]
  s_cmp_lg_u32 s53, 0
  v_mfma_f32_16x16x32_bf16 v[216:219], v[48:51], v[20:23], v[216:219]
  v_mfma_f32_16x16x32_bf16 v[216:219], v[52:55], v[24:27], v[216:219]
  v_mfma_f32_16x16x32_bf16 v[216:219], v[56:59], v[28:31], v[216:219]
  v_mfma_f32_16x16x32_bf16 v[220:223], v[56:59], v[32:35], v[220:223]
  v_mfma_f32_16x16x32_bf16 v[220:223], v[52:55], v[28:31], v[220:223]
  v_mfma_f32_16x16x32_bf16 v[220:223], v[48:51], v[24:27], v[220:223]
  s_cbranch_scc1 L_sp1_loop
  s_waitcnt vmcnt(0) lgkmcnt(0)
  v_mfma_f32_16x16x32_bf16 v[152:155], v[132:135], v[84:87], v[152:155]
  s_barrier
  v_mfma_f32_16x16x32_bf16 v[152:155], v[136:139], v[88:91], v[152:155]
  v_mfma_f32_16x16x32_bf16 v[156:159], v[148:151], v[88:91], v[156:159]
  v_mfma_f32_16x16x32_bf16 v[156:159], v[144:147], v[84:87], v[156:159]
  v_mfma_f32_16x16x32_bf16 v[160:163], v[128:131], v[84:87], v[160:163]
  v_mfma_f32_16x16x32_bf16 v[160:163], v[132:135], v[88:91], v[160:163]
  v_mfma_f32_16x16x32_bf16 v[160:163], v[136:139], v[92:95], v[160:163]
  v_mfma_f32_16x16x32_bf16 v[164:167], v[148:151], v[92:95], v[164:167]
  v_mfma_f32_16x16x32_bf16 v[164:167], v[144:147], v[88:91], v[164:167]
  v_mfma_f32_16x16x32_bf16 v[164:167], v[140:143], v[84:87], v[164:167]
  v_mfma_f32_16x16x32_bf16 v[168:171], v[128:131], v[88:91], v[168:171]
  v_mfma_f32_16x16x32_bf16 v[168:171], v[132:135], v[92:95], v[168:171]
  v_mfma_f32_16x16x32_bf16 v[168:171], v[136:139], v[96:99], v[168:171]
  v_mfma_f32_16x16x32_bf16 v[172:175], v[148:151], v[96:99], v[172:175]
  v_mfma_f32_16x16x32_bf16 v[172:175], v[144:147], v[92:95], v[172:175]
  v_mfma_f32_16x16x32_bf16 v[172:175], v[140:143], v[88:91], v[172:175]
  v_mfma_f32_16x16x32_bf16 v[176:179], v[128:131], v[92:95], v[176:179]
  v_mfma_f32_16x16x32_bf16 v[176:179], v[132:135], v[96:99], v[176:179]
  v_mfma_f32_16x16x32_bf16 v[176:179], v[136:139], v[100:103], v[176:179]
  v_mfma_f32_16x16x32_bf16 v[180:183], v[148:151], v[100:103], v[180:183]
  v_mfma_f32_16x16x32_bf16 v[180:183], v[144:147], v[96:99], v[180:183]
  v_mfma_f32_16x16x32_bf16 v[180:183], v[140:143], v[92:95], v[180:183]
  v_mfma_f32_16x16x32_bf16 v[184:187], v[128:131], v[96:99], v[184:187]
  v_mfma_f32_16x16x32_bf16 v[184:187], v[132:135], v[100:103], v[184:187]
  v_mfma_f32_16x16x32_bf16 v[184:187], v[136:139], v[104:107], v[184:187]
  ds_read_b64_tr_b16 v[16:17], v6 offset:4128
  v_mfma_f32_16x16x32_bf16 v[188:191], v[148:151], v[104:107], v[188:191]
  s_barrier
  ds_read_b64_tr_b16 v[18:19], v6 offset:4640
  v_mfma_f32_16x16x32_bf16 v[188:191], v[144:147], v[100:103], v[188:191]
  ds_read_b128 v[20:23], v2 offset:0
  v_mfma_f32_16x16x32_bf16 v[188:191], v[140:143], v[96:99], v[188:191]
  ds_read_b64_tr_b16 v[24:25], v6 offset:31968
  v_mfma_f32_16x16x32_bf16 v[192:195], v[128:131], v[100:103], v[192:195]
  ds_read_b64_tr_b16 v[26:27], v6 offset:32480
  v_mfma_f32_16x16x32_bf16 v[192:195], v[132:135], v[104:107], v[192:195]
  ds_read_b128 v[28:31], v1 offset:0
  v_mfma_f32_16x16x32_bf16 v[192:195], v[136:139], v[108:111], v[192:195]
  ds_read_b64_tr_b16 v[32:33], v6 offset:8256
  v_mfma_f32_16x16x32_bf16 v[196:199], v[148:151], v[108:111], v[196:199]
  ds_read_b64_tr_b16 v[34:35], v6 offset:8768
  v_mfma_f32_16x16x32_bf16 v[196:199], v[144:147], v[104:107], v[196:199]
  ds_read_b128 v[36:39], v2 offset:2048
  v_mfma_f32_16x16x32_bf16 v[196:199], v[140:143], v[100:103], v[196:199]
  ds_read_b64_tr_b16 v[40:41], v6 offset:36096
  v_mfma_f32_16x16x32_bf16 v[200:203], v[128:131], v[104:107], v[200:203]
  ds_read_b64_tr_b16 v[42:43], v6 offset:36608
  v_mfma_f32_16x16x32_bf16 v[200:203], v[132:135], v[108:111], v[200:203]
  ds_read_b128 v[44:47], v1 offset:2048
  v_mfma_f32_16x16x32_bf16 v[200:203], v[136:139], v[112:115], v[200:203]
  ds_read_b64_tr_b16 v[48:49], v7 offset:4128
  v_mfma_f32_16x16x32_bf16 v[204:207], v[148:151], v[112:115], v[204:207]
  ds_read_b64_tr_b16 v[50:51], v7 offset:4640
  v_mfma_f32_16x16x32_bf16 v[204:207], v[144:147], v[108:111], v[204:207]
  ds_read_b64_tr_b16 v[52:53], v7 offset:31968
  v_mfma_f32_16x16x32_bf16 v[204:207], v[140:143], v[104:107], v[204:207]
  ds_read_b64_tr_b16 v[54:55], v7 offset:32480
  v_mfma_f32_16x16x32_bf16 v[208:211], v[128:131], v[108:111], v[208:211]
  ds_read_b64_tr_b16 v[56:57], v7 offset:8256
  v_mfma_f32_16x16x32_bf16 v[208:211], v[132:135], v[112:115], v[208:211]
  ds_read_b64_tr_b16 v[58:59], v7 offset:8768
  v_mfma_f32_16x16x32_bf16 v[212:215], v[144:147], v[112:115], v[212:215]
  ds_read_b64_tr_b16 v[60:61], v7 offset:36096
  v_mfma_f32_16x16x32_bf16 v[212:215], v[140:143], v[108:111], v[212:215]
  ds_read_b64_tr_b16 v[62:63], v7 offset:36608
  v_mfma_f32_16x16x32_bf16 v[216:219], v[116:119], v[88:91], v[216:219]
  ds_read_b64_tr_b16 v[64:65], v6 offset:0
  v_mfma_f32_16x16x32_bf16 v[216:219], v[120:123], v[92:95], v[216:219]
  ds_read_b64_tr_b16 v[66:67], v6 offset:512
  v_mfma_f32_16x16x32_bf16 v[216:219], v[124:127], v[96:99], v[216:219]
  ds_read_b64_tr_b16 v[68:69], v6 offset:27840
  v_mfma_f32_16x16x32_bf16 v[220:223], v[124:127], v[100:103], v[220:223]
  ds_read_b64_tr_b16 v[70:71], v6 offset:28352
  v_mfma_f32_16x16x32_bf16 v[220:223], v[120:123], v[96:99], v[220:223]
  ds_read_b128 v[72:75], v2 offset:4096
  v_mfma_f32_16x16x32_bf16 v[220:223], v[116:119], v[92:95], v[220:223]
  ds_read_b128 v[76:79], v1 offset:4096
  s_waitcnt lgkmcnt(10)
  v_mfma_f32_16x16x32_bf16 v[152:155], v[16:19], v[20:23], v[152:155]
  ds_read_b64_tr_b16 v[80:81], v7 offset:0
  v_mfma_f32_16x16x32_bf16 v[152:155], v[24:27], v[28:31], v[152:155]
  ds_read_b64_tr_b16 v[82:83], v7 offset:512
  v_mfma_f32_16x16x32_bf16 v[152:155], v[32:35], v[36:39], v[152:155]
  ds_read_b64_tr_b16 v[240:241], v7 offset:27840
  v_mfma_f32_16x16x32_bf16 v[152:155], v[40:43], v[44:47], v[152:155]
  ds_read_b64_tr_b16 v[242:243], v7 offset:28352
  v_mfma_f32_16x16x32_bf16 v[156:159], v[48:51], v[20:23], v[156:159]
  ds_read_b128 v[224:227], v10 offset:0
  v_mfma_f32_16x16x32_bf16 v[156:159], v[52:55], v[28:31], v[156:159]
  ds_read_b128 v[232:235], v10 offset:256
  s_waitcnt lgkmcnt(10)
  v_mfma_f32_16x16x32_bf16 v[156:159], v[56:59], v[36:39], v[156:159]
  ds_read_b128 v[228:231], v10 offset:16
  v_mfma_f32_16x16x32_bf16 v[156:159], v[60:63], v[44:47], v[156:159]
  ds_read_b128 v[236:239], v10 offset:272
  v_mfma_f32_16x16x32_bf16 v[160:163], v[64:67], v[20:23], v[160:163]
  ds_read_b128 v[244:247], v2 offset:6144
  s_waitcnt lgkmcnt(10)
  v_mfma_f32_16x16x32_bf16 v[160:163], v[68:71], v[28:31], v[160:163]
  ds_read_b128 v[84:87], v1 offset:6144
  v_mfma_f32_16x16x32_bf16 v[160:163], v[16:19], v[36:39], v[160:163]
  ds_read_b128 v[136:139], v2 offset:8192
  v_mfma_f32_16x16x32_bf16 v[160:163], v[24:27], v[44:47], v[160:163]
  ds_read_b128 v[148:151], v1 offset:8192
  v_mfma_f32_16x16x32_bf16 v[160:163], v[32:35], v[72:75], v[160:163]
  s_waitcnt lgkmcnt(9)
  v_mfma_f32_16x16x32_bf16 v[160:163], v[40:43], v[76:79], v[160:163]
  v_mfma_f32_16x16x32_bf16 v[164:167], v[80:83], v[20:23], v[164:167]
  s_waitcnt lgkmcnt(7)
  v_mfma_f32_16x16x32_bf16 v[164:167], v[240:243], v[28:31], v[164:167]
  v_mfma_f32_16x16x32_bf16 v[164:167], v[48:51], v[36:39], v[164:167]
  v_mfma_f32_16x16x32_bf16 v[164:167], v[52:55], v[44:47], v[164:167]
  v_mfma_f32_16x16x32_bf16 v[164:167], v[56:59], v[72:75], v[164:167]
  v_mfma_f32_16x16x32_bf16 v[164:167], v[60:63], v[76:79], v[164:167]
  v_mfma_f32_16x16x32_bf16 v[168:171], v[64:67], v[36:39], v[168:171]
  v_mfma_f32_16x16x32_bf16 v[168:171], v[68:71], v[44:47], v[168:171]
  s_barrier
  v_subrev_u32 v6, 55680, v6
  v_mfma_f32_16x16x32_bf16 v[168:171], v[16:19], v[72:75], v[168:171]
  s_barrier
  v_subrev_u32 v7, 55680, v7
  v_mfma_f32_16x16x32_bf16 v[168:171], v[24:27], v[76:79], v[168:171]
  ds_read_b64_tr_b16 v[104:105], v6 offset:4128
  s_waitcnt lgkmcnt(1)
  v_mfma_f32_16x16x32_bf16 v[168:171], v[32:35], v[244:247], v[168:171]
  ds_read_b64_tr_b16 v[106:107], v6 offset:4640
  v_mfma_f32_16x16x32_bf16 v[168:171], v[40:43], v[84:87], v[168:171]
  ds_read_b128 v[128:131], v2 offset:16384
  v_mfma_f32_16x16x32_bf16 v[172:175], v[80:83], v[36:39], v[172:175]
  ds_read_b64_tr_b16 v[132:133], v6 offset:31968
  v_mfma_f32_16x16x32_bf16 v[172:175], v[240:243], v[44:47], v[172:175]
  ds_read_b64_tr_b16 v[134:135], v6 offset:32480
  v_mfma_f32_16x16x32_bf16 v[172:175], v[48:51], v[72:75], v[172:175]
  ds_read_b128 v[144:147], v1 offset:16384
  v_mfma_f32_16x16x32_bf16 v[172:175], v[52:55], v[76:79], v[172:175]
  ds_read_b64_tr_b16 v[112:113], v6 offset:8256
  v_mfma_f32_16x16x32_bf16 v[172:175], v[56:59], v[244:247], v[172:175]
  ds_read_b64_tr_b16 v[114:115], v6 offset:8768
  v_mfma_f32_16x16x32_bf16 v[172:175], v[60:63], v[84:87], v[172:175]
  ds_read_b128 v[140:143], v2 offset:18432
  v_mfma_f32_16x16x32_bf16 v[176:179], v[64:67], v[72:75], v[176:179]
  ds_read_b64_tr_b16 v[108:109], v6 offset:36096
  v_mfma_f32_16x16x32_bf16 v[176:179], v[68:71], v[76:79], v[176:179]
  ds_read_b64_tr_b16 v[110:111], v6 offset:36608
  v_mfma_f32_16x16x32_bf16 v[176:179], v[16:19], v[244:247], v[176:179]
  ds_read_b128 v[88:91], v1 offset:18432
  v_mfma_f32_16x16x32_bf16 v[176:179], v[24:27], v[84:87], v[176:179]
  ds_read_b64_tr_b16 v[124:125], v7 offset:4128
  v_mfma_f32_16x16x32_bf16 v[176:179], v[32:35], v[136:139], v[176:179]
  ds_read_b64_tr_b16 v[126:127], v7 offset:4640
L_t_sp1_0:
  s_cbranch_scc1 L_r_sp1_0
  v_mfma_f32_16x16x32_bf16 v[176:179], v[40:43], v[148:151], v[176:179]
  ds_read_b64_tr_b16 v[100:101], v7 offset:31968
  v_mfma_f32_16x16x32_bf16 v[180:183], v[80:83], v[72:75], v[180:183]
  ds_read_b64_tr_b16 v[102:103], v7 offset:32480
  v_mfma_f32_16x16x32_bf16 v[180:183], v[240:243], v[76:79], v[180:183]
  ds_read_b64_tr_b16 v[120:121], v7 offset:8256
  v_mfma_f32_16x16x32_bf16 v[180:183], v[48:51], v[244:247], v[180:183]
  ds_read_b64_tr_b16 v[122:123], v7 offset:8768
  v_mfma_f32_16x16x32_bf16 v[180:183], v[52:55], v[84:87], v[180:183]
  ds_read_b64_tr_b16 v[96:97], v7 offset:36096
  ds_read_b64_tr_b16 v[98:99], v7 offset:36608
  v_mfma_f32_16x16x32_bf16 v[180:183], v[56:59], v[136:139], v[180:183]
  ds_read_b128 v[116:119], v2 offset:10240
  v_mfma_f32_16x16x32_bf16 v[180:183], v[60:63], v[148:151], v[180:183]
  ds_read_b128 v[92:95], v1 offset:10240
  s_waitcnt lgkmcnt(11)
  v_mfma_f32_16x16x32_bf16 v[152:155], v[104:107], v[128:131], v[152:155]
  ds_read_b64_tr_b16 v[20:21], v6 offset:0
  v_mfma_f32_16x16x32_bf16 v[152:155], v[132:135], v[144:147], v[152:155]
  ds_read_b64_tr_b16 v[22:23], v6 offset:512
  v_mfma_f32_16x16x32_bf16 v[152:155], v[112:115], v[140:143], v[152:155]
  ds_read_b64_tr_b16 v[28:29], v6 offset:27840
  s_waitcnt lgkmcnt(11)
  v_mfma_f32_16x16x32_bf16 v[152:155], v[108:111], v[88:91], v[152:155]
  ds_read_b64_tr_b16 v[30:31], v6 offset:28352
  v_mfma_f32_16x16x32_bf16 v[156:159], v[124:127], v[128:131], v[156:159]
  ds_read_b128 v[36:39], v2 offset:20480
  s_waitcnt lgkmcnt(11)
  v_mfma_f32_16x16x32_bf16 v[156:159], v[100:103], v[144:147], v[156:159]
  ds_read_b128 v[44:47], v1 offset:20480
  s_waitcnt lgkmcnt(10)
  v_mfma_f32_16x16x32_bf16 v[156:159], v[120:123], v[140:143], v[156:159]
  ds_read_b64_tr_b16 v[72:73], v7 offset:0
  s_waitcnt lgkmcnt(9)
  v_mfma_f32_16x16x32_bf16 v[156:159], v[96:99], v[88:91], v[156:159]
  ds_read_b64_tr_b16 v[74:75], v7 offset:512
  v_mfma_f32_16x16x32_bf16 v[184:187], v[64:67], v[244:247], v[184:187]
  ds_read_b64_tr_b16 v[76:77], v7 offset:27840
  v_mfma_f32_16x16x32_bf16 v[184:187], v[68:71], v[84:87], v[184:187]
  ds_read_b64_tr_b16 v[78:79], v7 offset:28352
  v_mfma_f32_16x16x32_bf16 v[184:187], v[16:19], v[136:139], v[184:187]
  v_mfma_f32_16x16x32_bf16 v[184:187], v[24:27], v[148:151], v[184:187]
  s_waitcnt lgkmcnt(8)
  v_mfma_f32_16x16x32_bf16 v[184:187], v[32:35], v[116:119], v[184:187]
  v_fma_f32 v152, v152, v224, v232
  v_fma_f32 v153, v153, v225, v233
  v_mfma_f32_16x16x32_bf16 v[184:187], v[40:43], v[92:95], v[184:187]
  v_fma_f32 v154, v154, v226, v234
  v_fma_f32 v155, v155, v227, v235
  v_mfma_f32_16x16x32_bf16 v[188:191], v[80:83], v[244:247], v[188:191]
  ds_read_b128 v[244:247], v2 offset:12288
  v_exp_f32 v248, v152
  v_mfma_f32_16x16x32_bf16 v[188:191], v[240:243], v[84:87], v[188:191]
  ds_read_b128 v[84:87], v1 offset:12288
  v_exp_f32 v249, v153
  v_mfma_f32_16x16x32_bf16 v[188:191], v[48:51], v[136:139], v[188:191]
  v_exp_f32 v250, v154
  v_mfma_f32_16x16x32_bf16 v[188:191], v[52:55], v[148:151], v[188:191]
  v_exp_f32 v251, v155
  v_mfma_f32_16x16x32_bf16 v[188:191], v[56:59], v[116:119], v[188:191]
  v_fma_f32 v156, v156, v228, v236
  v_fma_f32 v157, v157, v229, v237
  v_mfma_f32_16x16x32_bf16 v[188:191], v[60:63], v[92:95], v[188:191]
  v_fma_f32 v158, v158, v230, v238
  v_fma_f32 v159, v159, v231, v239
  v_mfma_f32_16x16x32_bf16 v[160:163], v[20:23], v[128:131], v[160:163]
  v_exp_f32 v252, v156
  s_waitcnt lgkmcnt(2)
  v_mfma_f32_16x16x32_bf16 v[160:163], v[28:31], v[144:147], v[160:163]
  v_exp_f32 v253, v157
  v_mfma_f32_16x16x32_bf16 v[160:163], v[104:107], v[140:143], v[160:163]
  v_exp_f32 v254, v158
  v_mfma_f32_16x16x32_bf16 v[160:163], v[132:135], v[88:91], v[160:163]
  v_exp_f32 v255, v159
  v_mfma_f32_16x16x32_bf16 v[160:163], v[112:115], v[36:39], v[160:163]
  v_fma_f32 v248, v248, s56, s56
  v_fma_f32 v249, v249, s56, s56
  v_mfma_f32_16x16x32_bf16 v[160:163], v[108:111], v[44:47], v[160:163]
  v_fma_f32 v250, v250, s56, s56
  v_fma_f32 v251, v251, s56, s56
  v_mfma_f32_16x16x32_bf16 v[164:167], v[72:75], v[128:131], v[164:167]
  ds_read_b128 v[128:131], v2 offset:22528
  v_rcp_f32 v248, v248
  v_mfma_f32_16x16x32_bf16 v[164:167], v[76:79], v[144:147], v[164:167]
  ds_read_b128 v[144:147], v1 offset:22528
  v_rcp_f32 v249, v249
  v_mfma_f32_16x16x32_bf16 v[164:167], v[124:127], v[140:143], v[164:167]
  v_rcp_f32 v250, v250
  v_mfma_f32_16x16x32_bf16 v[164:167], v[100:103], v[88:91], v[164:167]
  v_rcp_f32 v251, v251
  v_mfma_f32_16x16x32_bf16 v[164:167], v[120:123], v[36:39], v[164:167]
  v_fma_f32 v252, v252, s56, s56
  v_fma_f32 v253, v253, s56, s56
  v_mfma_f32_16x16x32_bf16 v[164:167], v[96:99], v[44:47], v[164:167]
  v_fma_f32 v254, v254, s56, s56
  v_fma_f32 v255, v255, s56, s56
  v_mfma_f32_16x16x32_bf16 v[192:195], v[64:67], v[136:139], v[192:195]
  v_rcp_f32 v252, v252
  v_mfma_f32_16x16x32_bf16 v[192:195], v[68:71], v[148:151], v[192:195]
  v_rcp_f32 v253, v253
  v_mfma_f32_16x16x32_bf16 v[192:195], v[16:19], v[116:119], v[192:195]
  v_rcp_f32 v254, v254
  v_mfma_f32_16x16x32_bf16 v[192:195], v[24:27], v[92:95], v[192:195]
  v_rcp_f32 v255, v255
  s_waitcnt lgkmcnt(2)
  v_mfma_f32_16x16x32_bf16 v[192:195], v[32:35], v[244:247], v[192:195]
  v_mul_f32 v152, v152, v248
  v_mul_f32 v153, v153, v249
  v_mfma_f32_16x16x32_bf16 v[192:195], v[40:43], v[84:87], v[192:195]
  v_mul_f32 v154, v154, v250
  v_mul_f32 v155, v155, v251
  v_mfma_f32_16x16x32_bf16 v[196:199], v[80:83], v[136:139], v[196:199]
  ds_read_b128 v[136:139], v2 offset:14336
  v_cvt_pk_bf16_f32 v12, v152, v153
  v_mfma_f32_16x16x32_bf16 v[196:199], v[240:243], v[148:151], v[196:199]
  ds_read_b128 v[148:151], v1 offset:14336
  v_cvt_pk_bf16_f32 v13, v154, v155
  v_mfma_f32_16x16x32_bf16 v[196:199], v[48:51], v[116:119], v[196:199]
  v_mul_f32 v156, v156, v252
  v_mul_f32 v157, v157, v253
  v_mfma_f32_16x16x32_bf16 v[196:199], v[52:55], v[92:95], v[196:199]
  v_mul_f32 v158, v158, v254
  v_mul_f32 v159, v159, v255
  v_mfma_f32_16x16x32_bf16 v[196:199], v[56:59], v[244:247], v[196:199]
  v_cvt_pk_bf16_f32 v14, v156, v157
  v_cvt_pk_bf16_f32 v15, v158, v159
  v_mfma_f32_16x16x32_bf16 v[196:199], v[60:63], v[84:87], v[196:199]
  buffer_store_dwordx4 v[12:15], v8, s[28:31], s48 offen offset:0 sc1
  v_fma_f32 v160, v160, v224, v232
  v_mfma_f32_16x16x32_bf16 v[168:171], v[20:23], v[140:143], v[168:171]
  v_fma_f32 v161, v161, v225, v233
  v_fma_f32 v162, v162, v226, v234
  v_mfma_f32_16x16x32_bf16 v[168:171], v[28:31], v[88:91], v[168:171]
  v_fma_f32 v163, v163, v227, v235
  v_exp_f32 v248, v160
  v_mfma_f32_16x16x32_bf16 v[168:171], v[104:107], v[36:39], v[168:171]
  ds_read_b128 v[156:159], v2 offset:24576
  v_exp_f32 v249, v161
  v_mfma_f32_16x16x32_bf16 v[168:171], v[132:135], v[44:47], v[168:171]
  v_exp_f32 v250, v162
  s_waitcnt lgkmcnt(3)
  v_mfma_f32_16x16x32_bf16 v[168:171], v[112:115], v[128:131], v[168:171]
  v_exp_f32 v251, v163
  v_mfma_f32_16x16x32_bf16 v[168:171], v[108:111], v[144:147], v[168:171]
  v_fma_f32 v164, v164, v228, v236
  v_fma_f32 v165, v165, v229, v237
  v_mfma_f32_16x16x32_bf16 v[172:175], v[72:75], v[140:143], v[172:175]
  ds_read_b128 v[140:143], v1 offset:24576
  v_fma_f32 v166, v166, v230, v238
  v_mfma_f32_16x16x32_bf16 v[172:175], v[76:79], v[88:91], v[172:175]
  v_fma_f32 v167, v167, v231, v239
  v_exp_f32 v252, v164
  v_mfma_f32_16x16x32_bf16 v[172:175], v[124:127], v[36:39], v[172:175]
  v_exp_f32 v253, v165
  v_mfma_f32_16x16x32_bf16 v[172:175], v[100:103], v[44:47], v[172:175]
  v_exp_f32 v254, v166
  v_mfma_f32_16x16x32_bf16 v[172:175], v[120:123], v[128:131], v[172:175]
  v_exp_f32 v255, v167
  v_mfma_f32_16x16x32_bf16 v[172:175], v[96:99], v[144:147], v[172:175]
  v_fma_f32 v248, v248, s56, s56
  v_fma_f32 v249, v249, s56, s56
  v_mfma_f32_16x16x32_bf16 v[200:203], v[64:67], v[116:119], v[200:203]
  v_fma_f32 v250, v250, s56, s56
  v_fma_f32 v251, v251, s56, s56
  v_mfma_f32_16x16x32_bf16 v[200:203], v[68:71], v[92:95], v[200:203]
  v_rcp_f32 v248, v248
  v_mfma_f32_16x16x32_bf16 v[200:203], v[16:19], v[244:247], v[200:203]
  v_rcp_f32 v249, v249
  v_mfma_f32_16x16x32_bf16 v[200:203], v[24:27], v[84:87], v[200:203]
  v_rcp_f32 v250, v250
  s_waitcnt lgkmcnt(1)
  v_mfma_f32_16x16x32_bf16 v[200:203], v[32:35], v[136:139], v[200:203]
  v_rcp_f32 v251, v251
  v_mfma_f32_16x16x32_bf16 v[200:203], v[40:43], v[148:151], v[200:203]
  v_fma_f32 v252, v252, s56, s56
  v_fma_f32 v253, v253, s56, s56
  v_mfma_f32_16x16x32_bf16 v[204:207], v[80:83], v[116:119], v[204:207]
  v_fma_f32 v254, v254, s56, s56
  v_fma_f32 v255, v255, s56, s56
  v_mfma_f32_16x16x32_bf16 v[204:207], v[240:243], v[92:95], v[204:207]
  v_rcp_f32 v252, v252
  v_mfma_f32_16x16x32_bf16 v[204:207], v[48:51], v[244:247], v[204:207]
  v_rcp_f32 v253, v253
  v_mfma_f32_16x16x32_bf16 v[204:207], v[52:55], v[84:87], v[204:207]
  v_rcp_f32 v254, v254
  v_mfma_f32_16x16x32_bf16 v[204:207], v[56:59], v[136:139], v[204:207]
  ds_read_b128 v[88:91], v2 offset:26624
  v_rcp_f32 v255, v255
  v_mfma_f32_16x16x32_bf16 v[204:207], v[60:63], v[148:151], v[204:207]
  ds_read_b128 v[32:35], v1 offset:26624
  v_mul_f32 v160, v160, v248
  v_mfma_f32_16x16x32_bf16 v[176:179], v[20:23], v[36:39], v[176:179]
  v_mul_f32 v161, v161, v249
  v_mul_f32 v162, v162, v250
  v_mfma_f32_16x16x32_bf16 v[176:179], v[28:31], v[44:47], v[176:179]
  v_mul_f32 v163, v163, v251
  v_cvt_pk_bf16_f32 v152, v160, v161
  v_mfma_f32_16x16x32_bf16 v[176:179], v[104:107], v[128:131], v[176:179]
  v_cvt_pk_bf16_f32 v153, v162, v163
  v_mul_f32 v164, v164, v252
  v_mfma_f32_16x16x32_bf16 v[176:179], v[132:135], v[144:147], v[176:179]
  v_mul_f32 v165, v165, v253
  v_mul_f32 v166, v166, v254
  v_mfma_f32_16x16x32_bf16 v[176:179], v[112:115], v[156:159], v[176:179]
  v_mul_f32 v167, v167, v255
  v_cvt_pk_bf16_f32 v154, v164, v165
  s_waitcnt lgkmcnt(2)
  v_mfma_f32_16x16x32_bf16 v[176:179], v[108:111], v[140:143], v[176:179]
  v_cvt_pk_bf16_f32 v155, v166, v167
  buffer_store_dwordx4 v[152:155], v8, s[28:31], s48 offen offset:1152 sc1
  v_mfma_f32_16x16x32_bf16 v[180:183], v[72:75], v[36:39], v[180:183]
  ds_read_b64_tr_b16 v[40:41], v3 offset:0
  v_fma_f32 v168, v168, v224, v232
  v_mfma_f32_16x16x32_bf16 v[180:183], v[76:79], v[44:47], v[180:183]
  ds_read_b64_tr_b16 v[42:43], v4 offset:0
  v_fma_f32 v169, v169, v225, v233
  v_mfma_f32_16x16x32_bf16 v[180:183], v[124:127], v[128:131], v[180:183]
  ds_read_b128 v[116:119], v2 offset:2048
  v_fma_f32 v170, v170, v226, v234
  v_mfma_f32_16x16x32_bf16 v[180:183], v[100:103], v[144:147], v[180:183]
  ds_read_b64_tr_b16 v[92:93], v3 offset:27840
  v_fma_f32 v171, v171, v227, v235
  v_mfma_f32_16x16x32_bf16 v[180:183], v[120:123], v[156:159], v[180:183]
  ds_read_b64_tr_b16 v[94:95], v4 offset:27840
  v_exp_f32 v248, v168
  v_mfma_f32_16x16x32_bf16 v[180:183], v[96:99], v[140:143], v[180:183]
  ds_read_b128 v[56:59], v1 offset:2048
  v_exp_f32 v249, v169
  v_mfma_f32_16x16x32_bf16 v[208:211], v[64:67], v[244:247], v[208:211]
  ds_read_b64_tr_b16 v[60:61], v3 offset:1024
  v_exp_f32 v250, v170
  v_mfma_f32_16x16x32_bf16 v[208:211], v[68:71], v[84:87], v[208:211]
  ds_read_b64_tr_b16 v[62:63], v4 offset:1024
  v_exp_f32 v251, v171
  v_mfma_f32_16x16x32_bf16 v[208:211], v[16:19], v[136:139], v[208:211]
  ds_read_b128 v[164:167], v2 offset:4096
  v_fma_f32 v172, v172, v228, v236
  v_mfma_f32_16x16x32_bf16 v[208:211], v[24:27], v[148:151], v[208:211]
  ds_read_b64_tr_b16 v[36:37], v3 offset:28864
  v_fma_f32 v173, v173, v229, v237
  v_mfma_f32_16x16x32_bf16 v[212:215], v[80:83], v[244:247], v[212:215]
  ds_read_b64_tr_b16 v[38:39], v4 offset:28864
  v_fma_f32 v174, v174, v230, v238
  v_mfma_f32_16x16x32_bf16 v[212:215], v[240:243], v[84:87], v[212:215]
  ds_read_b128 v[44:47], v1 offset:4096
  v_fma_f32 v175, v175, v231, v239
  v_mfma_f32_16x16x32_bf16 v[212:215], v[48:51], v[136:139], v[212:215]
  ds_read_b64_tr_b16 v[152:153], v3 offset:2048
  v_exp_f32 v252, v172
  v_mfma_f32_16x16x32_bf16 v[212:215], v[52:55], v[148:151], v[212:215]
  ds_read_b64_tr_b16 v[154:155], v4 offset:2048
  v_exp_f32 v253, v173
  v_mfma_f32_16x16x32_bf16 v[184:187], v[20:23], v[128:131], v[184:187]
  ds_read_b128 v[64:67], v2 offset:6144
  v_exp_f32 v254, v174
  v_mfma_f32_16x16x32_bf16 v[184:187], v[28:31], v[144:147], v[184:187]
  ds_read_b64_tr_b16 v[68:69], v3 offset:29888
  v_exp_f32 v255, v175
  v_mfma_f32_16x16x32_bf16 v[184:187], v[104:107], v[156:159], v[184:187]
  ds_read_b64_tr_b16 v[70:71], v4 offset:29888
  v_fma_f32 v248, v248, s56, s56
  v_mfma_f32_16x16x32_bf16 v[184:187], v[132:135], v[140:143], v[184:187]
  ds_read_b128 v[16:19], v1 offset:6144
  v_fma_f32 v249, v249, s56, s56
  s_waitcnt lgkmcnt(10)
  v_mfma_f32_16x16x32_bf16 v[184:187], v[112:115], v[88:91], v[184:187]
  ds_read_b128 v[24:27], v2 offset:8192
  v_fma_f32 v250, v250, s56, s56
  v_mfma_f32_16x16x32_bf16 v[184:187], v[108:111], v[32:35], v[184:187]
  ds_read_b128 v[80:83], v1 offset:8192
  v_fma_f32 v251, v251, s56, s56
  v_mfma_f32_16x16x32_bf16 v[188:191], v[72:75], v[128:131], v[188:191]
  ds_read_b128 v[244:247], v2 offset:28672
  v_rcp_f32 v248, v248
  v_mfma_f32_16x16x32_bf16 v[188:191], v[76:79], v[144:147], v[188:191]
  ds_read_b128 v[240:243], v1 offset:28672
  v_rcp_f32 v249, v249
  v_mfma_f32_16x16x32_bf16 v[188:191], v[124:127], v[156:159], v[188:191]
  v_rcp_f32 v250, v250
  v_mfma_f32_16x16x32_bf16 v[188:191], v[100:103], v[140:143], v[188:191]
  v_rcp_f32 v251, v251
  v_mfma_f32_16x16x32_bf16 v[188:191], v[120:123], v[88:91], v[188:191]
  v_fma_f32 v252, v252, s56, s56
  v_fma_f32 v253, v253, s56, s56
  v_mfma_f32_16x16x32_bf16 v[188:191], v[96:99], v[32:35], v[188:191]
  v_fma_f32 v254, v254, s56, s56
  v_fma_f32 v255, v255, s56, s56
  v_mfma_f32_16x16x32_bf16 v[216:219], v[40:43], v[116:119], v[216:219]
  v_rcp_f32 v252, v252
  v_mfma_f32_16x16x32_bf16 v[216:219], v[92:95], v[56:59], v[216:219]
  v_rcp_f32 v253, v253
  s_waitcnt lgkmcnt(4)
  v_mfma_f32_16x16x32_bf16 v[216:219], v[60:63], v[164:167], v[216:219]
  ds_read_b128 v[84:87], v2 offset:30720
  v_rcp_f32 v254, v254
  v_mfma_f32_16x16x32_bf16 v[216:219], v[36:39], v[44:47], v[216:219]
  ds_read_b128 v[48:51], v1 offset:30720
  v_rcp_f32 v255, v255
  v_mfma_f32_16x16x32_bf16 v[216:219], v[152:155], v[64:67], v[216:219]
  v_mul_f32 v168, v168, v248
  v_mul_f32 v169, v169, v249
  v_mfma_f32_16x16x32_bf16 v[216:219], v[68:71], v[16:19], v[216:219]
  v_mul_f32 v170, v170, v250
  v_mul_f32 v171, v171, v251
  v_mfma_f32_16x16x32_bf16 v[220:223], v[40:43], v[164:167], v[220:223]
  v_cvt_pk_bf16_f32 v160, v168, v169
  v_cvt_pk_bf16_f32 v161, v170, v171
  v_mfma_f32_16x16x32_bf16 v[220:223], v[92:95], v[44:47], v[220:223]
  v_mul_f32 v172, v172, v252
  v_mul_f32 v173, v173, v253
  v_mfma_f32_16x16x32_bf16 v[220:223], v[60:63], v[64:67], v[220:223]
  v_mul_f32 v174, v174, v254
  v_mul_f32 v175, v175, v255
  v_mfma_f32_16x16x32_bf16 v[220:223], v[36:39], v[16:19], v[220:223]
  v_cvt_pk_bf16_f32 v162, v172, v173
  v_cvt_pk_bf16_f32 v163, v174, v175
  s_waitcnt lgkmcnt(2)
  v_mfma_f32_16x16x32_bf16 v[220:223], v[152:155], v[24:27], v[220:223]
  buffer_store_dwordx4 v[160:163], v8, s[28:31], s48 offen offset:2304 sc1
  v_fma_f32 v176, v176, v224, v232
  v_mfma_f32_16x16x32_bf16 v[220:223], v[68:71], v[80:83], v[220:223]
  v_fma_f32 v177, v177, v225, v233
  v_fma_f32 v178, v178, v226, v234
  v_mfma_f32_16x16x32_bf16 v[192:195], v[20:23], v[156:159], v[192:195]
  v_fma_f32 v179, v179, v227, v235
  v_exp_f32 v248, v176
  v_mfma_f32_16x16x32_bf16 v[192:195], v[28:31], v[140:143], v[192:195]
  v_exp_f32 v249, v177
  v_mfma_f32_16x16x32_bf16 v[192:195], v[104:107], v[88:91], v[192:195]
  v_exp_f32 v250, v178
  v_mfma_f32_16x16x32_bf16 v[192:195], v[132:135], v[32:35], v[192:195]
  v_exp_f32 v251, v179
  v_mfma_f32_16x16x32_bf16 v[192:195], v[112:115], v[244:247], v[192:195]
  v_fma_f32 v180, v180, v228, v236
  v_fma_f32 v181, v181, v229, v237
  v_mfma_f32_16x16x32_bf16 v[192:195], v[108:111], v[240:243], v[192:195]
  v_fma_f32 v182, v182, v230, v238
  v_fma_f32 v183, v183, v231, v239
  v_mfma_f32_16x16x32_bf16 v[196:199], v[72:75], v[156:159], v[196:199]
  v_subrev_u32 v3, 55680, v3
  v_exp_f32 v252, v180
  v_mfma_f32_16x16x32_bf16 v[196:199], v[76:79], v[140:143], v[196:199]
  v_subrev_u32 v4, 55680, v4
  v_exp_f32 v253, v181
  v_mfma_f32_16x16x32_bf16 v[196:199], v[124:127], v[88:91], v[196:199]
  ds_read_b64_tr_b16 v[136:137], v3 offset:0
  v_exp_f32 v254, v182
  v_mfma_f32_16x16x32_bf16 v[196:199], v[100:103], v[32:35], v[196:199]
  ds_read_b64_tr_b16 v[138:139], v4 offset:0
  v_exp_f32 v255, v183
  v_mfma_f32_16x16x32_bf16 v[196:199], v[120:123], v[244:247], v[196:199]
  ds_read_b128 v[52:55], v2 offset:18432
  v_fma_f32 v248, v248, s56, s56
  v_mfma_f32_16x16x32_bf16 v[196:199], v[96:99], v[240:243], v[196:199]
  ds_read_b64_tr_b16 v[148:149], v3 offset:27840
  v_fma_f32 v249, v249, s56, s56
  v_mfma_f32_16x16x32_bf16 v[200:203], v[20:23], v[88:91], v[200:203]
  ds_read_b64_tr_b16 v[150:151], v4 offset:27840
  v_fma_f32 v250, v250, s56, s56
  v_mfma_f32_16x16x32_bf16 v[200:203], v[28:31], v[32:35], v[200:203]
  ds_read_b128 v[128:131], v1 offset:18432
  v_fma_f32 v251, v251, s56, s56
  v_mfma_f32_16x16x32_bf16 v[200:203], v[104:107], v[244:247], v[200:203]
  ds_read_b64_tr_b16 v[144:145], v3 offset:1024
  v_rcp_f32 v248, v248
  v_mfma_f32_16x16x32_bf16 v[200:203], v[132:135], v[240:243], v[200:203]
  ds_read_b64_tr_b16 v[146:147], v4 offset:1024
  v_rcp_f32 v249, v249
  s_waitcnt lgkmcnt(8)
  v_mfma_f32_16x16x32_bf16 v[200:203], v[112:115], v[84:87], v[200:203]
  ds_read_b128 v[116:119], v2 offset:20480
  v_rcp_f32 v250, v250
  v_mfma_f32_16x16x32_bf16 v[200:203], v[108:111], v[48:51], v[200:203]
  ds_read_b64_tr_b16 v[56:57], v3 offset:28864
  v_rcp_f32 v251, v251
  v_mfma_f32_16x16x32_bf16 v[204:207], v[72:75], v[88:91], v[204:207]
  ds_read_b64_tr_b16 v[58:59], v4 offset:28864
  v_fma_f32 v252, v252, s56, s56
  v_mfma_f32_16x16x32_bf16 v[204:207], v[76:79], v[32:35], v[204:207]
  ds_read_b128 v[40:43], v1 offset:20480
  v_fma_f32 v253, v253, s56, s56
  v_mfma_f32_16x16x32_bf16 v[204:207], v[124:127], v[244:247], v[204:207]
  ds_read_b64_tr_b16 v[164:165], v3 offset:2048
  v_fma_f32 v254, v254, s56, s56
  v_mfma_f32_16x16x32_bf16 v[204:207], v[100:103], v[240:243], v[204:207]
  ds_read_b64_tr_b16 v[166:167], v4 offset:2048
  v_fma_f32 v255, v255, s56, s56
  v_mfma_f32_16x16x32_bf16 v[204:207], v[120:123], v[84:87], v[204:207]
  ds_read_b128 v[92:95], v2 offset:22528
  v_rcp_f32 v252, v252
  v_mfma_f32_16x16x32_bf16 v[204:207], v[96:99], v[48:51], v[204:207]
  ds_read_b64_tr_b16 v[44:45], v3 offset:29888
  v_rcp_f32 v253, v253
  v_mfma_f32_16x16x32_bf16 v[208:211], v[20:23], v[244:247], v[208:211]
  ds_read_b64_tr_b16 v[46:47], v4 offset:29888
  v_rcp_f32 v254, v254
  v_mfma_f32_16x16x32_bf16 v[208:211], v[28:31], v[240:243], v[208:211]
  ds_read_b128 v[60:63], v11 offset:0
  v_rcp_f32 v255, v255
  v_mfma_f32_16x16x32_bf16 v[208:211], v[104:107], v[84:87], v[208:211]
  ds_read_b128 v[64:67], v11 offset:256
  v_mul_f32 v176, v176, v248
  v_mfma_f32_16x16x32_bf16 v[208:211], v[132:135], v[48:51], v[208:211]
  ds_read_b128 v[36:39], v1 offset:22528
  v_mul_f32 v177, v177, v249
  v_mfma_f32_16x16x32_bf16 v[212:215], v[72:75], v[244:247], v[212:215]
  ds_read_b128 v[16:19], v2 offset:24576
  v_mul_f32 v178, v178, v250
  v_mfma_f32_16x16x32_bf16 v[212:215], v[76:79], v[240:243], v[212:215]
  ds_read_b128 v[172:175], v1 offset:24576
  v_mul_f32 v179, v179, v251
  v_mfma_f32_16x16x32_bf16 v[212:215], v[124:127], v[84:87], v[212:215]
  v_cvt_pk_bf16_f32 v168, v176, v177
  v_cvt_pk_bf16_f32 v169, v178, v179
  v_mfma_f32_16x16x32_bf16 v[212:215], v[100:103], v[48:51], v[212:215]
  v_mul_f32 v180, v180, v252
  v_mul_f32 v181, v181, v253
  s_waitcnt lgkmcnt(8)
  v_mfma_f32_16x16x32_bf16 v[216:219], v[136:139], v[52:55], v[216:219]
  v_mul_f32 v182, v182, v254
  v_mul_f32 v183, v183, v255
  v_mfma_f32_16x16x32_bf16 v[216:219], v[148:151], v[128:131], v[216:219]
  v_cvt_pk_bf16_f32 v170, v180, v181
  v_cvt_pk_bf16_f32 v171, v182, v183
  v_mfma_f32_16x16x32_bf16 v[216:219], v[144:147], v[116:119], v[216:219]
  buffer_store_dwordx4 v[168:171], v8, s[28:31], s48 offen offset:3456 sc1
  v_fma_f32 v184, v184, v224, v232
  v_mfma_f32_16x16x32_bf16 v[216:219], v[56:59], v[40:43], v[216:219]
  v_fma_f32 v185, v185, v225, v233
  v_fma_f32 v186, v186, v226, v234
  s_waitcnt lgkmcnt(4)
  v_mfma_f32_16x16x32_bf16 v[216:219], v[164:167], v[92:95], v[216:219]
  v_fma_f32 v187, v187, v227, v235
  v_exp_f32 v248, v184
  s_waitcnt lgkmcnt(2)
  v_mfma_f32_16x16x32_bf16 v[216:219], v[44:47], v[36:39], v[216:219]
  v_exp_f32 v249, v185
  v_mfma_f32_16x16x32_bf16 v[220:223], v[136:139], v[116:119], v[220:223]
  v_exp_f32 v250, v186
  v_mfma_f32_16x16x32_bf16 v[220:223], v[148:151], v[40:43], v[220:223]
  v_exp_f32 v251, v187
  v_mfma_f32_16x16x32_bf16 v[220:223], v[144:147], v[92:95], v[220:223]
  v_fma_f32 v188, v188, v228, v236
  v_fma_f32 v189, v189, v229, v237
  v_mfma_f32_16x16x32_bf16 v[220:223], v[56:59], v[36:39], v[220:223]
  v_fma_f32 v190, v190, v230, v238
  v_fma_f32 v191, v191, v231, v239
  s_waitcnt lgkmcnt(0)
  v_mfma_f32_16x16x32_bf16 v[220:223], v[164:167], v[16:19], v[220:223]
  v_exp_f32 v252, v188
  v_mfma_f32_16x16x32_bf16 v[220:223], v[44:47], v[172:175], v[220:223]
  v_exp_f32 v253, v189
  v_exp_f32 v254, v190
  v_exp_f32 v255, v191
  v_pk_fma_f32 v[248:249], v[248:249], s[56:57], s[56:57]
  v_pk_fma_f32 v[250:251], v[250:251], s[56:57], s[56:57]
  v_rcp_f32 v248, v248
  v_rcp_f32 v249, v249
  v_rcp_f32 v250, v250
  v_rcp_f32 v251, v251
  v_pk_fma_f32 v[252:253], v[252:253], s[56:57], s[56:57]
  v_pk_fma_f32 v[254:255], v[254:255], s[56:57], s[56:57]
  v_rcp_f32 v252, v252
  v_rcp_f32 v253, v253
  v_rcp_f32 v254, v254
  v_rcp_f32 v255, v255
  v_pk_mul_f32 v[184:185], v[184:185], v[248:249]
  v_pk_mul_f32 v[186:187], v[186:187], v[250:251]
  v_cvt_pk_bf16_f32 v176, v184, v185
  v_cvt_pk_bf16_f32 v177, v186, v187
  v_pk_mul_f32 v[188:189], v[188:189], v[252:253]
  v_pk_mul_f32 v[190:191], v[190:191], v[254:255]
  v_cvt_pk_bf16_f32 v178, v188, v189
  v_cvt_pk_bf16_f32 v179, v190, v191
  buffer_store_dwordx4 v[176:179], v8, s[28:31], s49 offen offset:0 sc1
  v_pk_fma_f32 v[192:193], v[192:193], v[224:225], v[232:233]
  v_pk_fma_f32 v[194:195], v[194:195], v[226:227], v[234:235]
  v_exp_f32 v248, v192
  v_exp_f32 v249, v193
  v_exp_f32 v250, v194
  v_exp_f32 v251, v195
  v_pk_fma_f32 v[196:197], v[196:197], v[228:229], v[236:237]
  v_pk_fma_f32 v[198:199], v[198:199], v[230:231], v[238:239]
  v_exp_f32 v252, v196
  v_exp_f32 v253, v197
  v_exp_f32 v254, v198
  v_exp_f32 v255, v199
  v_pk_fma_f32 v[248:249], v[248:249], s[56:57], s[56:57]
  v_pk_fma_f32 v[250:251], v[250:251], s[56:57], s[56:57]
  v_rcp_f32 v248, v248
  v_rcp_f32 v249, v249
  v_rcp_f32 v250, v250
  v_rcp_f32 v251, v251
  v_pk_fma_f32 v[252:253], v[252:253], s[56:57], s[56:57]
  v_pk_fma_f32 v[254:255], v[254:255], s[56:57], s[56:57]
  v_rcp_f32 v252, v252
  v_rcp_f32 v253, v253
  v_rcp_f32 v254, v254
  v_rcp_f32 v255, v255
  v_pk_mul_f32 v[192:193], v[192:193], v[248:249]
  v_pk_mul_f32 v[194:195], v[194:195], v[250:251]
  v_cvt_pk_bf16_f32 v184, v192, v193
  v_cvt_pk_bf16_f32 v185, v194, v195
  v_pk_mul_f32 v[196:197], v[196:197], v[252:253]
  v_pk_mul_f32 v[198:199], v[198:199], v[254:255]
  v_cvt_pk_bf16_f32 v186, v196, v197
  v_cvt_pk_bf16_f32 v187, v198, v199
  buffer_store_dwordx4 v[184:187], v8, s[28:31], s49 offen offset:1152 sc1
  v_pk_fma_f32 v[200:201], v[200:201], v[224:225], v[232:233]
  v_pk_fma_f32 v[202:203], v[202:203], v[226:227], v[234:235]
  v_exp_f32 v248, v200
  v_exp_f32 v249, v201
  v_exp_f32 v250, v202
  v_exp_f32 v251, v203
  v_pk_fma_f32 v[204:205], v[204:205], v[228:229], v[236:237]
  v_pk_fma_f32 v[206:207], v[206:207], v[230:231], v[238:239]
  v_exp_f32 v252, v204
  v_exp_f32 v253, v205
  v_exp_f32 v254, v206
  v_exp_f32 v255, v207
  v_pk_fma_f32 v[248:249], v[248:249], s[56:57], s[56:57]
  v_pk_fma_f32 v[250:251], v[250:251], s[56:57], s[56:57]
  v_rcp_f32 v248, v248
  v_rcp_f32 v249, v249
  v_rcp_f32 v250, v250
  v_rcp_f32 v251, v251
  v_pk_fma_f32 v[252:253], v[252:253], s[56:57], s[56:57]
  v_pk_fma_f32 v[254:255], v[254:255], s[56:57], s[56:57]
  v_rcp_f32 v252, v252
  v_rcp_f32 v253, v253
  v_rcp_f32 v254, v254
  v_rcp_f32 v255, v255
  v_pk_mul_f32 v[200:201], v[200:201], v[248:249]
  v_pk_mul_f32 v[202:203], v[202:203], v[250:251]
  v_cvt_pk_bf16_f32 v192, v200, v201
  v_cvt_pk_bf16_f32 v193, v202, v203
  v_pk_mul_f32 v[204:205], v[204:205], v[252:253]
  v_pk_mul_f32 v[206:207], v[206:207], v[254:255]
  v_cvt_pk_bf16_f32 v194, v204, v205
  v_cvt_pk_bf16_f32 v195, v206, v207
  buffer_store_dwordx4 v[192:195], v8, s[28:31], s49 offen offset:2304 sc1
  v_pk_fma_f32 v[208:209], v[208:209], v[224:225], v[232:233]
  v_pk_fma_f32 v[210:211], v[210:211], v[226:227], v[234:235]
  v_exp_f32 v248, v208
  v_exp_f32 v249, v209
  v_exp_f32 v250, v210
  v_exp_f32 v251, v211
  v_pk_fma_f32 v[212:213], v[212:213], v[228:229], v[236:237]
  v_pk_fma_f32 v[214:215], v[214:215], v[230:231], v[238:239]
  v_exp_f32 v252, v212
  v_exp_f32 v253, v213
  v_exp_f32 v254, v214
  v_exp_f32 v255, v215
  v_pk_fma_f32 v[248:249], v[248:249], s[56:57], s[56:57]
  v_pk_fma_f32 v[250:251], v[250:251], s[56:57], s[56:57]
  v_rcp_f32 v248, v248
  v_rcp_f32 v249, v249
  v_rcp_f32 v250, v250
  v_rcp_f32 v251, v251
  v_pk_fma_f32 v[252:253], v[252:253], s[56:57], s[56:57]
  v_pk_fma_f32 v[254:255], v[254:255], s[56:57], s[56:57]
  v_rcp_f32 v252, v252
  v_rcp_f32 v253, v253
  v_rcp_f32 v254, v254
  v_rcp_f32 v255, v255
  v_pk_mul_f32 v[208:209], v[208:209], v[248:249]
  v_pk_mul_f32 v[210:211], v[210:211], v[250:251]
  v_cvt_pk_bf16_f32 v200, v208, v209
  v_cvt_pk_bf16_f32 v201, v210, v211
  v_pk_mul_f32 v[212:213], v[212:213], v[252:253]
  v_pk_mul_f32 v[214:215], v[214:215], v[254:255]
  v_cvt_pk_bf16_f32 v202, v212, v213
  v_cvt_pk_bf16_f32 v203, v214, v215
  buffer_store_dwordx4 v[200:203], v8, s[28:31], s49 offen offset:3456 sc1
  v_pk_fma_f32 v[216:217], v[216:217], v[60:61], v[64:65]
  v_pk_fma_f32 v[218:219], v[218:219], v[62:63], v[66:67]
  v_exp_f32 v248, v216
  v_exp_f32 v249, v217
  v_exp_f32 v250, v218
  v_exp_f32 v251, v219
  v_pk_fma_f32 v[220:221], v[220:221], v[60:61], v[64:65]
  v_pk_fma_f32 v[222:223], v[222:223], v[62:63], v[66:67]
  v_exp_f32 v252, v220
  v_exp_f32 v253, v221
  v_exp_f32 v254, v222
  v_exp_f32 v255, v223
  v_pk_fma_f32 v[248:249], v[248:249], s[56:57], s[56:57]
  v_pk_fma_f32 v[250:251], v[250:251], s[56:57], s[56:57]
  v_rcp_f32 v248, v248
  v_rcp_f32 v249, v249
  v_rcp_f32 v250, v250
  v_rcp_f32 v251, v251
  v_pk_fma_f32 v[252:253], v[252:253], s[56:57], s[56:57]
  v_pk_fma_f32 v[254:255], v[254:255], s[56:57], s[56:57]
  v_rcp_f32 v252, v252
  v_rcp_f32 v253, v253
  v_rcp_f32 v254, v254
  v_rcp_f32 v255, v255
  v_pk_mul_f32 v[216:217], v[216:217], v[248:249]
  v_pk_mul_f32 v[218:219], v[218:219], v[250:251]
  v_cvt_pk_bf16_f32 v208, v216, v217
  v_cvt_pk_bf16_f32 v209, v218, v219
  v_pk_mul_f32 v[220:221], v[220:221], v[252:253]
  v_pk_mul_f32 v[222:223], v[222:223], v[254:255]
  v_cvt_pk_bf16_f32 v210, v220, v221
  v_cvt_pk_bf16_f32 v211, v222, v223
  s_nop 1
  v_permlane16_swap_b32 v208, v210
  v_permlane16_swap_b32 v209, v211
  buffer_store_dwordx4 v[208:211], v9, s[28:31], s50 offen
  s_endpgm
.fill ((712 - (. - L_base)) & 4095) / 4, 4, 0xbf810000
L_sp2_go:
  s_cmp_eq_u32 0, 0
  s_branch L_t_sp2_0
L_r_sp2_0:
  s_barrier
  s_mov_b32 s53, 6
  s_mov_b32 s54, 1
  s_mov_b32 s52, 55680
  s_mov_b32 s55, 16384
  s_mov_b32 s51, 16384
  ds_read_b64_tr_b16 v[64:65], v6 offset:4128
  ds_read_b64_tr_b16 v[66:67], v6 offset:4640
  ds_read_b128 v[16:19], v2 offset:0
  ds_read_b64_tr_b16 v[68:69], v6 offset:8256
  ds_read_b64_tr_b16 v[70:71], v6 offset:8768
  ds_read_b128 v[20:23], v2 offset:2048
  ds_read_b64_tr_b16 v[80:81], v7 offset:8256
  ds_read_b64_tr_b16 v[82:83], v7 offset:8768
  ds_read_b64_tr_b16 v[76:77], v7 offset:4128
  ds_read_b64_tr_b16 v[78:79], v7 offset:4640
  ds_read_b64_tr_b16 v[60:61], v6 offset:0
  ds_read_b64_tr_b16 v[62:63], v6 offset:512
  ds_read_b128 v[24:27], v2 offset:4096
  ds_read_b64_tr_b16 v[72:73], v7 offset:0
  ds_read_b64_tr_b16 v[74:75], v7 offset:512
  ds_read_b128 v[28:31], v2 offset:6144
  ds_read_b128 v[32:35], v2 offset:8192
  ds_read_b128 v[36:39], v2 offset:10240
  ds_read_b128 v[40:43], v2 offset:12288
  ds_read_b128 v[44:47], v2 offset:14336
  ds_read_b64_tr_b16 v[48:49], v3 offset:0
  ds_read_b64_tr_b16 v[50:51], v4 offset:0
  ds_read_b64_tr_b16 v[52:53], v3 offset:1024
  ds_read_b64_tr_b16 v[54:55], v4 offset:1024
  ds_read_b64_tr_b16 v[56:57], v3 offset:2048
  ds_read_b64_tr_b16 v[58:59], v4 offset:2048
  s_waitcnt lgkmcnt(15)
  v_mfma_f32_16x16x32_bf16 v[152:155], v[64:67], v[16:19], 0
  v_mfma_f32_16x16x32_bf16 v[152:155], v[68:71], v[20:23], v[152:155]
  v_mfma_f32_16x16x32_bf16 v[156:159], v[80:83], v[20:23], 0
  v_mfma_f32_16x16x32_bf16 v[156:159], v[76:79], v[16:19], v[156:159]
  s_waitcnt lgkmcnt(0)
  s_barrier
  ds_read_b64_tr_b16 v[132:133], v6 offset:31968
  v_mfma_f32_16x16x32_bf16 v[160:163], v[60:63], v[16:19], 0
  ds_read_b64_tr_b16 v[134:135], v6 offset:32480
  v_mfma_f32_16x16x32_bf16 v[160:163], v[64:67], v[20:23], v[160:163]
  ds_read_b128 v[84:87], v1 offset:0
  v_mfma_f32_16x16x32_bf16 v[160:163], v[68:71], v[24:27], v[160:163]
  v_mfma_f32_16x16x32_bf16 v[164:167], v[80:83], v[24:27], 0
  ds_read_b64_tr_b16 v[136:137], v6 offset:36096
  v_mfma_f32_16x16x32_bf16 v[164:167], v[76:79], v[20:23], v[164:167]
  ds_read_b64_tr_b16 v[138:139], v6 offset:36608
  v_mfma_f32_16x16x32_bf16 v[164:167], v[72:75], v[16:19], v[164:167]
  ds_read_b128 v[88:91], v1 offset:2048
  v_mfma_f32_16x16x32_bf16 v[168:171], v[60:63], v[20:23], 0
  v_mfma_f32_16x16x32_bf16 v[168:171], v[64:67], v[24:27], v[168:171]
  ds_read_b64_tr_b16 v[148:149], v7 offset:36096
  v_mfma_f32_16x16x32_bf16 v[168:171], v[68:71], v[28:31], v[168:171]
  ds_read_b64_tr_b16 v[150:151], v7 offset:36608
  v_mfma_f32_16x16x32_bf16 v[172:175], v[80:83], v[28:31], 0
  ds_read_b64_tr_b16 v[144:145], v7 offset:31968
  v_mfma_f32_16x16x32_bf16 v[172:175], v[76:79], v[24:27], v[172:175]
  ds_read_b64_tr_b16 v[146:147], v7 offset:32480
  v_mfma_f32_16x16x32_bf16 v[172:175], v[72:75], v[20:23], v[172:175]
  ds_read_b64_tr_b16 v[128:129], v6 offset:27840
  v_mfma_f32_16x16x32_bf16 v[176:179], v[60:63], v[24:27], 0
  ds_read_b64_tr_b16 v[130:131], v6 offset:28352
  v_mfma_f32_16x16x32_bf16 v[176:179], v[64:67], v[28:31], v[176:179]
  ds_read_b128 v[92:95], v1 offset:4096
  v_mfma_f32_16x16x32_bf16 v[176:179], v[68:71], v[32:35], v[176:179]
  v_mfma_f32_16x16x32_bf16 v[180:183], v[80:83], v[32:35], 0
  ds_read_b64_tr_b16 v[140:141], v7 offset:27840
  v_mfma_f32_16x16x32_bf16 v[180:183], v[76:79], v[28:31], v[180:183]
  ds_read_b64_tr_b16 v[142:143], v7 offset:28352
  v_mfma_f32_16x16x32_bf16 v[180:183], v[72:75], v[24:27], v[180:183]
  v_mfma_f32_16x16x32_bf16 v[184:187], v[60:63], v[28:31], 0
  ds_read_b128 v[96:99], v1 offset:6144
  v_mfma_f32_16x16x32_bf16 v[184:187], v[64:67], v[32:35], v[184:187]
  v_mfma_f32_16x16x32_bf16 v[184:187], v[68:71], v[36:39], v[184:187]
  ds_read_b128 v[100:103], v1 offset:8192
  v_mfma_f32_16x16x32_bf16 v[188:191], v[80:83], v[36:39], 0
  v_mfma_f32_16x16x32_bf16 v[188:191], v[76:79], v[32:35], v[188:191]
  ds_read_b128 v[104:107], v1 offset:10240
  v_mfma_f32_16x16x32_bf16 v[188:191], v[72:75], v[28:31], v[188:191]
  v_mfma_f32_16x16x32_bf16 v[192:195], v[60:63], v[32:35], 0
  ds_read_b128 v[108:111], v1 offset:12288
  v_mfma_f32_16x16x32_bf16 v[192:195], v[64:67], v[36:39], v[192:195]
  v_mfma_f32_16x16x32_bf16 v[192:195], v[68:71], v[40:43], v[192:195]
  ds_read_b128 v[112:115], v1 offset:14336
  v_mfma_f32_16x16x32_bf16 v[196:199], v[80:83], v[40:43], 0
  v_mfma_f32_16x16x32_bf16 v[196:199], v[76:79], v[36:39], v[196:199]
  ds_read_b64_tr_b16 v[116:117], v3 offset:27840
  v_mfma_f32_16x16x32_bf16 v[196:199], v[72:75], v[32:35], v[196:199]
  ds_read_b64_tr_b16 v[118:119], v4 offset:27840
  v_mfma_f32_16x16x32_bf16 v[200:203], v[60:63], v[36:39], 0
  ds_read_b64_tr_b16 v[120:121], v3 offset:28864
  v_mfma_f32_16x16x32_bf16 v[200:203], v[64:67], v[40:43], v[200:203]
  ds_read_b64_tr_b16 v[122:123], v4 offset:28864
  v_mfma_f32_16x16x32_bf16 v[200:203], v[68:71], v[44:47], v[200:203]
  ds_read_b64_tr_b16 v[124:125], v3 offset:29888
  v_mfma_f32_16x16x32_bf16 v[204:207], v[80:83], v[44:47], 0
  ds_read_b64_tr_b16 v[126:127], v4 offset:29888
  v_mfma_f32_16x16x32_bf16 v[204:207], v[76:79], v[40:43], v[204:207]
  v_mfma_f32_16x16x32_bf16 v[204:207], v[72:75], v[36:39], v[204:207]
  v_mfma_f32_16x16x32_bf16 v[208:211], v[60:63], v[40:43], 0
  v_add_u32 v2, s51, v2
  v_add_u32 v1, s51, v1
  v_mfma_f32_16x16x32_bf16 v[208:211], v[64:67], v[44:47], v[208:211]
  v_add_u32 v6, s52, v6
  v_add_u32 v7, s52, v7
  v_mfma_f32_16x16x32_bf16 v[212:215], v[76:79], v[44:47], 0
  v_add_u32 v3, s52, v3
  v_add_u32 v4, s52, v4
  v_mfma_f32_16x16x32_bf16 v[212:215], v[72:75], v[40:43], v[212:215]
  s_cmp_eq_u32 s54, 2
  s_cselect_b32 s51, 4294934528, s55
  v_mfma_f32_16x16x32_bf16 v[216:219], v[48:51], v[28:31], 0
  s_cselect_b32 s54, -1, s54
  s_add_u32 s54, s54, 1
  v_mfma_f32_16x16x32_bf16 v[216:219], v[52:55], v[32:35], v[216:219]
  s_sub_u32 s52, 0, s52
  v_mfma_f32_16x16x32_bf16 v[216:219], v[56:59], v[36:39], v[216:219]
  v_mfma_f32_16x16x32_bf16 v[220:223], v[56:59], v[40:43], 0
  v_mfma_f32_16x16x32_bf16 v[220:223], v[52:55], v[36:39], v[220:223]
  v_mfma_f32_16x16x32_bf16 v[220:223], v[48:51], v[32:35], v[220:223]
L_sp2_loop:
  s_waitcnt lgkmcnt(0)
  v_mfma_f32_16x16x32_bf16 v[152:155], v[132:135], v[84:87], v[152:155]
  s_barrier
  ds_read_b64_tr_b16 v[64:65], v6 offset:4128
  v_mfma_f32_16x16x32_bf16 v[152:155], v[136:139], v[88:91], v[152:155]
  ds_read_b64_tr_b16 v[66:67], v6 offset:4640
  v_mfma_f32_16x16x32_bf16 v[156:159], v[148:151], v[88:91], v[156:159]
  ds_read_b128 v[16:19], v2 offset:0
  v_mfma_f32_16x16x32_bf16 v[156:159], v[144:147], v[84:87], v[156:159]
  v_mfma_f32_16x16x32_bf16 v[160:163], v[128:131], v[84:87], v[160:163]
  ds_read_b64_tr_b16 v[68:69], v6 offset:8256
  v_mfma_f32_16x16x32_bf16 v[160:163], v[132:135], v[88:91], v[160:163]
  ds_read_b64_tr_b16 v[70:71], v6 offset:8768
  v_mfma_f32_16x16x32_bf16 v[160:163], v[136:139], v[92:95], v[160:163]
  ds_read_b128 v[20:23], v2 offset:2048
  v_mfma_f32_16x16x32_bf16 v[164:167], v[148:151], v[92:95], v[164:167]
  v_mfma_f32_16x16x32_bf16 v[164:167], v[144:147], v[88:91], v[164:167]
  ds_read_b64_tr_b16 v[80:81], v7 offset:8256
  v_mfma_f32_16x16x32_bf16 v[164:167], v[140:143], v[84:87], v[164:167]
  ds_read_b64_tr_b16 v[82:83], v7 offset:8768
  v_mfma_f32_16x16x32_bf16 v[168:171], v[128:131], v[88:91], v[168:171]
  ds_read_b64_tr_b16 v[76:77], v7 offset:4128
  v_mfma_f32_16x16x32_bf16 v[168:171], v[132:135], v[92:95], v[168:171]
  ds_read_b64_tr_b16 v[78:79], v7 offset:4640
  v_mfma_f32_16x16x32_bf16 v[168:171], v[136:139], v[96:99], v[168:171]
  ds_read_b64_tr_b16 v[60:61], v6 offset:0
  v_mfma_f32_16x16x32_bf16 v[172:175], v[148:151], v[96:99], v[172:175]
  ds_read_b64_tr_b16 v[62:63], v6 offset:512
  v_mfma_f32_16x16x32_bf16 v[172:175], v[144:147], v[92:95], v[172:175]
  ds_read_b128 v[24:27], v2 offset:4096
  v_mfma_f32_16x16x32_bf16 v[172:175], v[140:143], v[88:91], v[172:175]
  v_mfma_f32_16x16x32_bf16 v[176:179], v[128:131], v[92:95], v[176:179]
  ds_read_b64_tr_b16 v[72:73], v7 offset:0
  v_mfma_f32_16x16x32_bf16 v[176:179], v[132:135], v[96:99], v[176:179]
  ds_read_b64_tr_b16 v[74:75], v7 offset:512
  v_mfma_f32_16x16x32_bf16 v[176:179], v[136:139], v[100:103], v[176:179]
  v_mfma_f32_16x16x32_bf16 v[180:183], v[148:151], v[100:103], v[180:183]
  ds_read_b128 v[28:31], v2 offset:6144
  v_mfma_f32_16x16x32_bf16 v[180:183], v[144:147], v[96:99], v[180:183]
  v_mfma_f32_16x16x32_bf16 v[180:183], v[140:143], v[92:95], v[180:183]
  ds_read_b128 v[32:35], v2 offset:8192
  v_mfma_f32_16x16x32_bf16 v[184:187], v[128:131], v[96:99], v[184:187]
  v_mfma_f32_16x16x32_bf16 v[184:187], v[132:135], v[100:103], v[184:187]
  ds_read_b128 v[36:39], v2 offset:10240
  v_mfma_f32_16x16x32_bf16 v[184:187], v[136:139], v[104:107], v[184:187]
  v_mfma_f32_16x16x32_bf16 v[188:191], v[148:151], v[104:107], v[188:191]
  ds_read_b128 v[40:43], v2 offset:12288
  v_mfma_f32_16x16x32_bf16 v[188:191], v[144:147], v[100:103], v[188:191]
  v_mfma_f32_16x16x32_bf16 v[188:191], v[140:143], v[96:99], v[188:191]
  ds_read_b128 v[44:47], v2 offset:14336
  v_mfma_f32_16x16x32_bf16 v[192:195], v[128:131], v[100:103], v[192:195]
  v_mfma_f32_16x16x32_bf16 v[192:195], v[132:135], v[104:107], v[192:195]
  ds_read_b64_tr_b16 v[48:49], v3 offset:0
  v_mfma_f32_16x16x32_bf16 v[192:195], v[136:139], v[108:111], v[192:195]
  ds_read_b64_tr_b16 v[50:51], v4 offset:0
  v_mfma_f32_16x16x32_bf16 v[196:199], v[148:151], v[108:111], v[196:199]
  ds_read_b64_tr_b16 v[52:53], v3 offset:1024
  v_mfma_f32_16x16x32_bf16 v[196:199], v[144:147], v[104:107], v[196:199]
  ds_read_b64_tr_b16 v[54:55], v4 offset:1024
  v_mfma_f32_16x16x32_bf16 v[196:199], v[140:143], v[100:103], v[196:199]
  ds_read_b64_tr_b16 v[56:57], v3 offset:2048
  v_mfma_f32_16x16x32_bf16 v[200:203], v[128:131], v[104:107], v[200:203]
  ds_read_b64_tr_b16 v[58:59], v4 offset:2048
  v_mfma_f32_16x16x32_bf16 v[200:203], v[132:135], v[108:111], v[200:203]
  v_mfma_f32_16x16x32_bf16 v[200:203], v[136:139], v[112:115], v[200:203]
  v_mfma_f32_16x16x32_bf16 v[204:207], v[148:151], v[112:115], v[204:207]
  v_mfma_f32_16x16x32_bf16 v[204:207], v[144:147], v[108:111], v[204:207]
  v_mfma_f32_16x16x32_bf16 v[204:207], v[140:143], v[104:107], v[204:207]
  v_mfma_f32_16x16x32_bf16 v[208:211], v[128:131], v[108:111], v[208:211]
  v_mfma_f32_16x16x32_bf16 v[208:211], v[132:135], v[112:115], v[208:211]
  v_mfma_f32_16x16x32_bf16 v[212:215], v[144:147], v[112:115], v[212:215]
  v_mfma_f32_16x16x32_bf16 v[212:215], v[140:143], v[108:111], v[212:215]
  v_mfma_f32_16x16x32_bf16 v[216:219], v[116:119], v[96:99], v[216:219]
  v_mfma_f32_16x16x32_bf16 v[216:219], v[120:123], v[100:103], v[216:219]
  v_mfma_f32_16x16x32_bf16 v[216:219], v[124:127], v[104:107], v[216:219]
  v_mfma_f32_16x16x32_bf16 v[220:223], v[124:127], v[108:111], v[220:223]
  v_mfma_f32_16x16x32_bf16 v[220:223], v[120:123], v[104:107], v[220:223]
  v_mfma_f32_16x16x32_bf16 v[220:223], v[116:119], v[100:103], v[220:223]
  s_waitcnt lgkmcnt(0)
  v_mfma_f32_16x16x32_bf16 v[152:155], v[64:67], v[16:19], v[152:155]
  s_barrier
  ds_read_b64_tr_b16 v[132:133], v6 offset:31968
  v_mfma_f32_16x16x32_bf16 v[152:155], v[68:71], v[20:23], v[152:155]
  ds_read_b64_tr_b16 v[134:135], v6 offset:32480
  v_mfma_f32_16x16x32_bf16 v[156:159], v[80:83], v[20:23], v[156:159]
  ds_read_b128 v[84:87], v1 offset:0
  v_mfma_f32_16x16x32_bf16 v[156:159], v[76:79], v[16:19], v[156:159]
  v_mfma_f32_16x16x32_bf16 v[160:163], v[60:63], v[16:19], v[160:163]
  ds_read_b64_tr_b16 v[136:137], v6 offset:36096
  v_mfma_f32_16x16x32_bf16 v[160:163], v[64:67], v[20:23], v[160:163]
  ds_read_b64_tr_b16 v[138:139], v6 offset:36608
  v_mfma_f32_16x16x32_bf16 v[160:163], v[68:71], v[24:27], v[160:163]
  ds_read_b128 v[88:91], v1 offset:2048
  v_mfma_f32_16x16x32_bf16 v[164:167], v[80:83], v[24:27], v[164:167]
  v_mfma_f32_16x16x32_bf16 v[164:167], v[76:79], v[20:23], v[164:167]
  ds_read_b64_tr_b16 v[148:149], v7 offset:36096
  v_mfma_f32_16x16x32_bf16 v[164:167], v[72:75], v[16:19], v[164:167]
  ds_read_b64_tr_b16 v[150:151], v7 offset:36608
  v_mfma_f32_16x16x32_bf16 v[168:171], v[60:63], v[20:23], v[168:171]
  ds_read_b64_tr_b16 v[144:145], v7 offset:31968
  v_mfma_f32_16x16x32_bf16 v[168:171], v[64:67], v[24:27], v[168:171]
  ds_read_b64_tr_b16 v[146:147], v7 offset:32480
  v_mfma_f32_16x16x32_bf16 v[168:171], v[68:71], v[28:31], v[168:171]
  ds_read_b64_tr_b16 v[128:129], v6 offset:27840
  v_mfma_f32_16x16x32_bf16 v[172:175], v[80:83], v[28:31], v[172:175]
  ds_read_b64_tr_b16 v[130:131], v6 offset:28352
  v_mfma_f32_16x16x32_bf16 v[172:175], v[76:79], v[24:27], v[172:175]
  ds_read_b128 v[92:95], v1 offset:4096
  v_mfma_f32_16x16x32_bf16 v[172:175], v[72:75], v[20:23], v[172:175]
  v_mfma_f32_16x16x32_bf16 v[176:179], v[60:63], v[24:27], v[176:179]
  ds_read_b64_tr_b16 v[140:141], v7 offset:27840
  v_mfma_f32_16x16x32_bf16 v[176:179], v[64:67], v[28:31], v[176:179]
  ds_read_b64_tr_b16 v[142:143], v7 offset:28352
  v_mfma_f32_16x16x32_bf16 v[176:179], v[68:71], v[32:35], v[176:179]
  v_mfma_f32_16x16x32_bf16 v[180:183], v[80:83], v[32:35], v[180:183]
  ds_read_b128 v[96:99], v1 offset:6144
  v_mfma_f32_16x16x32_bf16 v[180:183], v[76:79], v[28:31], v[180:183]
  v_mfma_f32_16x16x32_bf16 v[180:183], v[72:75], v[24:27], v[180:183]
  ds_read_b128 v[100:103], v1 offset:8192
  v_mfma_f32_16x16x32_bf16 v[184:187], v[60:63], v[28:31], v[184:187]
  v_mfma_f32_16x16x32_bf16 v[184:187], v[64:67], v[32:35], v[184:187]
  ds_read_b128 v[104:107], v1 offset:10240
  v_mfma_f32_16x16x32_bf16 v[184:187], v[68:71], v[36:39], v[184:187]
  v_mfma_f32_16x16x32_bf16 v[188:191], v[80:83], v[36:39], v[188:191]
  ds_read_b128 v[108:111], v1 offset:12288
  v_mfma_f32_16x16x32_bf16 v[188:191], v[76:79], v[32:35], v[188:191]
  v_mfma_f32_16x16x32_bf16 v[188:191], v[72:75], v[28:31], v[188:191]
  ds_read_b128 v[112:115], v1 offset:14336
  v_mfma_f32_16x16x32_bf16 v[192:195], v[60:63], v[32:35], v[192:195]
  v_mfma_f32_16x16x32_bf16 v[192:195], v[64:67], v[36:39], v[192:195]
  ds_read_b64_tr_b16 v[116:117], v3 offset:27840
  v_mfma_f32_16x16x32_bf16 v[192:195], v[68:71], v[40:43], v[192:195]
  ds_read_b64_tr_b16 v[118:119], v4 offset:27840
  v_mfma_f32_16x16x32_bf16 v[196:199], v[80:83], v[40:43], v[196:199]
  ds_read_b64_tr_b16 v[120:121], v3 offset:28864
  v_mfma_f32_16x16x32_bf16 v[196:199], v[76:79], v[36:39], v[196:199]
  ds_read_b64_tr_b16 v[122:123], v4 offset:28864
  v_mfma_f32_16x16x32_bf16 v[196:199], v[72:75], v[32:35], v[196:199]
  ds_read_b64_tr_b16 v[124:125], v3 offset:29888
  v_mfma_f32_16x16x32_bf16 v[200:203], v[60:63], v[36:39], v[200:203]
  ds_read_b64_tr_b16 v[126:127], v4 offset:29888
  v_mfma_f32_16x16x32_bf16 v[200:203], v[64:67], v[40:43], v[200:203]
  v_mfma_f32_16x16x32_bf16 v[200:203], v[68:71], v[44:47], v[200:203]
  v_mfma_f32_16x16x32_bf16 v[204:207], v[80:83], v[44:47], v[204:207]
  v_add_u32 v2, s51, v2
  v_add_u32 v1, s51, v1
  v_mfma_f32_16x16x32_bf16 v[204:207], v[76:79], v[40:43], v[204:207]
  v_add_u32 v6, s52, v6
  v_add_u32 v7, s52, v7
  v_mfma_f32_16x16x32_bf16 v[204:207], v[72:75], v[36:39], v[204:207]
  v_add_u32 v3, s52, v3
  v_add_u32 v4, s52, v4
  v_mfma_f32_16x16x32_bf16 v[208:211], v[60:63], v[40:43], v[208:211]
  s_cmp_eq_u32 s54, 2
  s_cselect_b32 s51, 4294934528, s55
  v_mfma_f32_16x16x32_bf16 v[208:211], v[64:67], v[44:47], v[208:211]
  s_cselect_b32 s54, -1, s54
  s_add_u32 s54, s54, 1
  v_mfma_f32_16x16x32_bf16 v[212:215], v[76:79], v[44:47], v[212:215]
  s_sub_u32 s52, 0, s52
  s_sub_u32 s53, s53, 1
  v_mfma_f32_16x16x32_bf16 v[212:215], v[72:75], v[40:43], v[212:215]
  s_cmp_lg_u32 s53, 0
  v_mfma_f32_16x16x32_bf16 v[216:219], v[48:51], v[28:31], v[216:219]
  v_mfma_f32_16x16x32_bf16 v[216:219], v[52:55], v[32:35], v[216:219]
  v_mfma_f32_16x16x32_bf16 v[216:219], v[56:59], v[36:39], v[216:219]
  v_mfma_f32_16x16x32_bf16 v[220:223], v[56:59], v[40:43], v[220:223]
  v_mfma_f32_16x16x32_bf16 v[220:223], v[52:55], v[36:39], v[220:223]
  v_mfma_f32_16x16x32_bf16 v[220:223], v[48:51], v[32:35], v[220:223]
  s_cbranch_scc1 L_sp2_loop
  s_waitcnt vmcnt(0) lgkmcnt(0)
  v_mfma_f32_16x16x32_bf16 v[152:155], v[132:135], v[84:87], v[152:155]
  s_barrier
  v_mfma_f32_16x16x32_bf16 v[152:155], v[136:139], v[88:91], v[152:155]
  v_mfma_f32_16x16x32_bf16 v[156:159], v[148:151], v[88:91], v[156:159]
  v_mfma_f32_16x16x32_bf16 v[156:159], v[144:147], v[84:87], v[156:159]
  v_mfma_f32_16x16x32_bf16 v[160:163], v[128:131], v[84:87], v[160:163]
  v_mfma_f32_16x16x32_bf16 v[160:163], v[132:135], v[88:91], v[160:163]
  v_mfma_f32_16x16x32_bf16 v[160:163], v[136:139], v[92:95], v[160:163]
  v_mfma_f32_16x16x32_bf16 v[164:167], v[148:151], v[92:95], v[164:167]
  v_mfma_f32_16x16x32_bf16 v[164:167], v[144:147], v[88:91], v[164:167]
  v_mfma_f32_16x16x32_bf16 v[164:167], v[140:143], v[84:87], v[164:167]
  v_mfma_f32_16x16x32_bf16 v[168:171], v[128:131], v[88:91], v[168:171]
  v_mfma_f32_16x16x32_bf16 v[168:171], v[132:135], v[92:95], v[168:171]
  v_mfma_f32_16x16x32_bf16 v[168:171], v[136:139], v[96:99], v[168:171]
  v_mfma_f32_16x16x32_bf16 v[172:175], v[148:151], v[96:99], v[172:175]
  v_mfma_f32_16x16x32_bf16 v[172:175], v[144:147], v[92:95], v[172:175]
  v_mfma_f32_16x16x32_bf16 v[172:175], v[140:143], v[88:91], v[172:175]
  v_mfma_f32_16x16x32_bf16 v[176:179], v[128:131], v[92:95], v[176:179]
  v_mfma_f32_16x16x32_bf16 v[176:179], v[132:135], v[96:99], v[176:179]
  v_mfma_f32_16x16x32_bf16 v[176:179], v[136:139], v[100:103], v[176:179]
  v_mfma_f32_16x16x32_bf16 v[180:183], v[148:151], v[100:103], v[180:183]
  v_mfma_f32_16x16x32_bf16 v[180:183], v[144:147], v[96:99], v[180:183]
  v_mfma_f32_16x16x32_bf16 v[180:183], v[140:143], v[92:95], v[180:183]
  v_mfma_f32_16x16x32_bf16 v[184:187], v[128:131], v[96:99], v[184:187]
  v_mfma_f32_16x16x32_bf16 v[184:187], v[132:135], v[100:103], v[184:187]
  v_mfma_f32_16x16x32_bf16 v[184:187], v[136:139], v[104:107], v[184:187]
  ds_read_b64_tr_b16 v[16:17], v6 offset:4128
  v_mfma_f32_16x16x32_bf16 v[188:191], v[148:151], v[104:107], v[188:191]
  s_barrier
  ds_read_b64_tr_b16 v[18:19], v6 offset:4640
  v_mfma_f32_16x16x32_bf16 v[188:191], v[144:147], v[100:103], v[188:191]
  ds_read_b128 v[20:23], v2 offset:0
  v_mfma_f32_16x16x32_bf16 v[188:191], v[140:143], v[96:99], v[188:191]
  ds_read_b64_tr_b16 v[24:25], v6 offset:31968
  v_mfma_f32_16x16x32_bf16 v[192:195], v[128:131], v[100:103], v[192:195]
  ds_read_b64_tr_b16 v[26:27], v6 offset:32480
  v_mfma_f32_16x16x32_bf16 v[192:195], v[132:135], v[104:107], v[192:195]
  ds_read_b128 v[28:31], v1 offset:0
  v_mfma_f32_16x16x32_bf16 v[192:195], v[136:139], v[108:111], v[192:195]
  ds_read_b64_tr_b16 v[32:33], v6 offset:8256
  v_mfma_f32_16x16x32_bf16 v[196:199], v[148:151], v[108:111], v[196:199]
  ds_read_b64_tr_b16 v[34:35], v6 offset:8768
  v_mfma_f32_16x16x32_bf16 v[196:199], v[144:147], v[104:107], v[196:199]
  ds_read_b128 v[36:39], v2 offset:2048
  v_mfma_f32_16x16x32_bf16 v[196:199], v[140:143], v[100:103], v[196:199]
  ds_read_b64_tr_b16 v[40:41], v6 offset:36096
  v_mfma_f32_16x16x32_bf16 v[200:203], v[128:131], v[104:107], v[200:203]
  ds_read_b64_tr_b16 v[42:43], v6 offset:36608
  v_mfma_f32_16x16x32_bf16 v[200:203], v[132:135], v[108:111], v[200:203]
  ds_read_b128 v[44:47], v1 offset:2048
  v_mfma_f32_16x16x32_bf16 v[200:203], v[136:139], v[112:115], v[200:203]
  ds_read_b64_tr_b16 v[48:49], v7 offset:4128
  v_mfma_f32_16x16x32_bf16 v[204:207], v[148:151], v[112:115], v[204:207]
  ds_read_b64_tr_b16 v[50:51], v7 offset:4640
  v_mfma_f32_16x16x32_bf16 v[204:207], v[144:147], v[108:111], v[204:207]
  ds_read_b64_tr_b16 v[52:53], v7 offset:31968
  v_mfma_f32_16x16x32_bf16 v[204:207], v[140:143], v[104:107], v[204:207]
  ds_read_b64_tr_b16 v[54:55], v7 offset:32480
  v_mfma_f32_16x16x32_bf16 v[208:211], v[128:131], v[108:111], v[208:211]
  ds_read_b64_tr_b16 v[56:57], v7 offset:8256
  v_mfma_f32_16x16x32_bf16 v[208:211], v[132:135], v[112:115], v[208:211]
  ds_read_b64_tr_b16 v[58:59], v7 offset:8768
  v_mfma_f32_16x16x32_bf16 v[212:215], v[144:147], v[112:115], v[212:215]
  ds_read_b64_tr_b16 v[60:61], v7 offset:36096
  v_mfma_f32_16x16x32_bf16 v[212:215], v[140:143], v[108:111], v[212:215]
  ds_read_b64_tr_b16 v[62:63], v7 offset:36608
  v_mfma_f32_16x16x32_bf16 v[216:219], v[116:119], v[96:99], v[216:219]
  ds_read_b64_tr_b16 v[64:65], v6 offset:0
  v_mfma_f32_16x16x32_bf16 v[216:219], v[120:123], v[100:103], v[216:219]
  ds_read_b64_tr_b16 v[66:67], v6 offset:512
  v_mfma_f32_16x16x32_bf16 v[216:219], v[124:127], v[104:107], v[216:219]
  ds_read_b64_tr_b16 v[68:69], v6 offset:27840
  v_mfma_f32_16x16x32_bf16 v[220:223], v[124:127], v[108:111], v[220:223]
  ds_read_b64_tr_b16 v[70:71], v6 offset:28352
  v_mfma_f32_16x16x32_bf16 v[220:223], v[120:123], v[104:107], v[220:223]
  ds_read_b128 v[72:75], v2 offset:4096
  v_mfma_f32_16x16x32_bf16 v[220:223], v[116:119], v[100:103], v[220:223]
  ds_read_b128 v[76:79], v1 offset:4096
  s_waitcnt lgkmcnt(10)
  v_mfma_f32_16x16x32_bf16 v[152:155], v[16:19], v[20:23], v[152:155]
  ds_read_b64_tr_b16 v[80:81], v7 offset:0
  v_mfma_f32_16x16x32_bf16 v[152:155], v[24:27], v[28:31], v[152:155]
  ds_read_b64_tr_b16 v[82:83], v7 offset:512
  v_mfma_f32_16x16x32_bf16 v[152:155], v[32:35], v[36:39], v[152:155]
  ds_read_b64_tr_b16 v[240:241], v7 offset:27840
  v_mfma_f32_16x16x32_bf16 v[152:155], v[40:43], v[44:47], v[152:155]
  ds_read_b64_tr_b16 v[242:243], v7 offset:28352
  v_mfma_f32_16x16x32_bf16 v[156:159], v[48:51], v[20:23], v[156:159]
  ds_read_b128 v[224:227], v10 offset:0
  v_mfma_f32_16x16x32_bf16 v[156:159], v[52:55], v[28:31], v[156:159]
  ds_read_b128 v[232:235], v10 offset:256
  s_waitcnt lgkmcnt(10)
  v_mfma_f32_16x16x32_bf16 v[156:159], v[56:59], v[36:39], v[156:159]
  ds_read_b128 v[228:231], v10 offset:16
  v_mfma_f32_16x16x32_bf16 v[156:159], v[60:63], v[44:47], v[156:159]
  ds_read_b128 v[236:239], v10 offset:272
  v_mfma_f32_16x16x32_bf16 v[160:163], v[64:67], v[20:23], v[160:163]
  ds_read_b128 v[244:247], v2 offset:6144
  s_waitcnt lgkmcnt(10)
  v_mfma_f32_16x16x32_bf16 v[160:163], v[68:71], v[28:31], v[160:163]
  ds_read_b128 v[84:87], v1 offset:6144
  v_mfma_f32_16x16x32_bf16 v[160:163], v[16:19], v[36:39], v[160:163]
  ds_read_b128 v[88:91], v2 offset:8192
  v_mfma_f32_16x16x32_bf16 v[160:163], v[24:27], v[44:47], v[160:163]
  ds_read_b128 v[92:95], v1 offset:8192
  v_mfma_f32_16x16x32_bf16 v[160:163], v[32:35], v[72:75], v[160:163]
  s_waitcnt lgkmcnt(9)
  v_mfma_f32_16x16x32_bf16 v[160:163], v[40:43], v[76:79], v[160:163]
  v_mfma_f32_16x16x32_bf16 v[164:167], v[80:83], v[20:23], v[164:167]
  s_waitcnt lgkmcnt(7)
  v_mfma_f32_16x16x32_bf16 v[164:167], v[240:243], v[28:31], v[164:167]
  v_mfma_f32_16x16x32_bf16 v[164:167], v[48:51], v[36:39], v[164:167]
  v_mfma_f32_16x16x32_bf16 v[164:167], v[52:55], v[44:47], v[164:167]
  v_mfma_f32_16x16x32_bf16 v[164:167], v[56:59], v[72:75], v[164:167]
  v_mfma_f32_16x16x32_bf16 v[164:167], v[60:63], v[76:79], v[164:167]
  v_mfma_f32_16x16x32_bf16 v[168:171], v[64:67], v[36:39], v[168:171]
  v_mfma_f32_16x16x32_bf16 v[168:171], v[68:71], v[44:47], v[168:171]
  s_barrier
  v_subrev_u32 v6, 55680, v6
  v_mfma_f32_16x16x32_bf16 v[168:171], v[16:19], v[72:75], v[168:171]
  s_barrier
  v_subrev_u32 v7, 55680, v7
  v_mfma_f32_16x16x32_bf16 v[168:171], v[24:27], v[76:79], v[168:171]
  ds_read_b64_tr_b16 v[136:137], v6 offset:4128
  s_waitcnt lgkmcnt(1)
  v_mfma_f32_16x16x32_bf16 v[168:171], v[32:35], v[244:247], v[168:171]
  ds_read_b64_tr_b16 v[138:139], v6 offset:4640
  v_mfma_f32_16x16x32_bf16 v[168:171], v[40:43], v[84:87], v[168:171]
  ds_read_b128 v[148:151], v2 offset:16384
  v_mfma_f32_16x16x32_bf16 v[172:175], v[80:83], v[36:39], v[172:175]
  ds_read_b64_tr_b16 v[128:129], v6 offset:31968
  v_mfma_f32_16x16x32_bf16 v[172:175], v[240:243], v[44:47], v[172:175]
  ds_read_b64_tr_b16 v[130:131], v6 offset:32480
  v_mfma_f32_16x16x32_bf16 v[172:175], v[48:51], v[72:75], v[172:175]
  ds_read_b128 v[132:135], v1 offset:16384
  v_mfma_f32_16x16x32_bf16 v[172:175], v[52:55], v[76:79], v[172:175]
  ds_read_b64_tr_b16 v[144:145], v6 offset:8256
  v_mfma_f32_16x16x32_bf16 v[172:175], v[56:59], v[244:247], v[172:175]
  ds_read_b64_tr_b16 v[146:147], v6 offset:8768
  v_mfma_f32_16x16x32_bf16 v[172:175], v[60:63], v[84:87], v[172:175]
  ds_read_b128 v[112:115], v2 offset:18432
  v_mfma_f32_16x16x32_bf16 v[176:179], v[64:67], v[72:75], v[176:179]
  ds_read_b64_tr_b16 v[140:141], v6 offset:36096
  v_mfma_f32_16x16x32_bf16 v[176:179], v[68:71], v[76:79], v[176:179]
  ds_read_b64_tr_b16 v[142:143], v6 offset:36608
  v_mfma_f32_16x16x32_bf16 v[176:179], v[16:19], v[244:247], v[176:179]
  ds_read_b128 v[96:99], v1 offset:18432
  v_mfma_f32_16x16x32_bf16 v[176:179], v[24:27], v[84:87], v[176:179]
  ds_read_b64_tr_b16 v[124:125], v7 offset:4128
  v_mfma_f32_16x16x32_bf16 v[176:179], v[32:35], v[88:91], v[176:179]
  ds_read_b64_tr_b16 v[126:127], v7 offset:4640
L_t_sp2_0:
  s_cbranch_scc1 L_r_sp2_0
  v_mfma_f32_16x16x32_bf16 v[176:179], v[40:43], v[92:95], v[176:179]
  ds_read_b64_tr_b16 v[108:109], v7 offset:31968
  v_mfma_f32_16x16x32_bf16 v[180:183], v[80:83], v[72:75], v[180:183]
  ds_read_b64_tr_b16 v[110:111], v7 offset:32480
  v_mfma_f32_16x16x32_bf16 v[180:183], v[240:243], v[76:79], v[180:183]
  ds_read_b64_tr_b16 v[120:121], v7 offset:8256
  v_mfma_f32_16x16x32_bf16 v[180:183], v[48:51], v[244:247], v[180:183]
  ds_read_b64_tr_b16 v[122:123], v7 offset:8768
  v_mfma_f32_16x16x32_bf16 v[180:183], v[52:55], v[84:87], v[180:183]
  ds_read_b64_tr_b16 v[104:105], v7 offset:36096
  ds_read_b64_tr_b16 v[106:107], v7 offset:36608
  v_mfma_f32_16x16x32_bf16 v[180:183], v[56:59], v[88:91], v[180:183]
  ds_read_b128 v[116:119], v2 offset:10240
  v_mfma_f32_16x16x32_bf16 v[180:183], v[60:63], v[92:95], v[180:183]
  ds_read_b128 v[100:103], v1 offset:10240
  s_waitcnt lgkmcnt(11)
  v_mfma_f32_16x16x32_bf16 v[152:155], v[136:139], v[148:151], v[152:155]
  ds_read_b64_tr_b16 v[20:21], v6 offset:0
  v_mfma_f32_16x16x32_bf16 v[152:155], v[128:131], v[132:135], v[152:155]
  ds_read_b64_tr_b16 v[22:23], v6 offset:512
  v_mfma_f32_16x16x32_bf16 v[152:155], v[144:147], v[112:115], v[152:155]
  ds_read_b64_tr_b16 v[28:29], v6 offset:27840
  s_waitcnt lgkmcnt(11)
  v_mfma_f32_16x16x32_bf16 v[152:155], v[140:143], v[96:99], v[152:155]
  ds_read_b64_tr_b16 v[30:31], v6 offset:28352
  v_mfma_f32_16x16x32_bf16 v[156:159], v[124:127], v[148:151], v[156:159]
  ds_read_b128 v[36:39], v2 offset:20480
  s_waitcnt lgkmcnt(11)
  v_mfma_f32_16x16x32_bf16 v[156:159], v[108:111], v[132:135], v[156:159]
  ds_read_b128 v[44:47], v1 offset:20480
  s_waitcnt lgkmcnt(10)
  v_mfma_f32_16x16x32_bf16 v[156:159], v[120:123], v[112:115], v[156:159]
  ds_read_b64_tr_b16 v[72:73], v7 offset:0
  s_waitcnt lgkmcnt(9)
  v_mfma_f32_16x16x32_bf16 v[156:159], v[104:107], v[96:99], v[156:159]
  ds_read_b64_tr_b16 v[74:75], v7 offset:512
  v_mfma_f32_16x16x32_bf16 v[184:187], v[64:67], v[244:247], v[184:187]
  ds_read_b64_tr_b16 v[76:77], v7 offset:27840
  v_mfma_f32_16x16x32_bf16 v[184:187], v[68:71], v[84:87], v[184:187]
  ds_read_b64_tr_b16 v[78:79], v7 offset:28352
  v_mfma_f32_16x16x32_bf16 v[184:187], v[16:19], v[88:91], v[184:187]
  v_mfma_f32_16x16x32_bf16 v[184:187], v[24:27], v[92:95], v[184:187]
  s_waitcnt lgkmcnt(8)
  v_mfma_f32_16x16x32_bf16 v[184:187], v[32:35], v[116:119], v[184:187]
  v_fma_f32 v152, v152, v224, v232
  v_fma_f32 v153, v153, v225, v233
  v_mfma_f32_16x16x32_bf16 v[184:187], v[40:43], v[100:103], v[184:187]
  v_fma_f32 v154, v154, v226, v234
  v_fma_f32 v155, v155, v227, v235
  v_mfma_f32_16x16x32_bf16 v[188:191], v[80:83], v[244:247], v[188:191]
  ds_read_b128 v[244:247], v2 offset:12288
  v_exp_f32 v248, v152
  v_mfma_f32_16x16x32_bf16 v[188:191], v[240:243], v[84:87], v[188:191]
  ds_read_b128 v[84:87], v1 offset:12288
  v_exp_f32 v249, v153
  v_mfma_f32_16x16x32_bf16 v[188:191], v[48:51], v[88:91], v[188:191]
  v_exp_f32 v250, v154
  v_mfma_f32_16x16x32_bf16 v[188:191], v[52:55], v[92:95], v[188:191]
  v_exp_f32 v251, v155
  v_mfma_f32_16x16x32_bf16 v[188:191], v[56:59], v[116:119], v[188:191]
  v_fma_f32 v156, v156, v228, v236
  v_fma_f32 v157, v157, v229, v237
  v_mfma_f32_16x16x32_bf16 v[188:191], v[60:63], v[100:103], v[188:191]
  v_fma_f32 v158, v158, v230, v238
  v_fma_f32 v159, v159, v231, v239
  v_mfma_f32_16x16x32_bf16 v[160:163], v[20:23], v[148:151], v[160:163]
  v_exp_f32 v252, v156
  s_waitcnt lgkmcnt(2)
  v_mfma_f32_16x16x32_bf16 v[160:163], v[28:31], v[132:135], v[160:163]
  v_exp_f32 v253, v157
  v_mfma_f32_16x16x32_bf16 v[160:163], v[136:139], v[112:115], v[160:163]
  v_exp_f32 v254, v158
  v_mfma_f32_16x16x32_bf16 v[160:163], v[128:131], v[96:99], v[160:163]
  v_exp_f32 v255, v159
  v_mfma_f32_16x16x32_bf16 v[160:163], v[144:147], v[36:39], v[160:163]
  v_fma_f32 v248, v248, s56, s56
  v_fma_f32 v249, v249, s56, s56
  v_mfma_f32_16x16x32_bf16 v[160:163], v[140:143], v[44:47], v[160:163]
  v_fma_f32 v250, v250, s56, s56
  v_fma_f32 v251, v251, s56, s56
  v_mfma_f32_16x16x32_bf16 v[164:167], v[72:75], v[148:151], v[164:167]
  ds_read_b128 v[148:151], v2 offset:22528
  v_rcp_f32 v248, v248
  v_mfma_f32_16x16x32_bf16 v[164:167], v[76:79], v[132:135], v[164:167]
  ds_read_b128 v[132:135], v1 offset:22528
  v_rcp_f32 v249, v249
  v_mfma_f32_16x16x32_bf16 v[164:167], v[124:127], v[112:115], v[164:167]
  v_rcp_f32 v250, v250
  v_mfma_f32_16x16x32_bf16 v[164:167], v[108:111], v[96:99], v[164:167]
  v_rcp_f32 v251, v251
  v_mfma_f32_16x16x32_bf16 v[164:167], v[120:123], v[36:39], v[164:167]
  v_fma_f32 v252, v252, s56, s56
  v_fma_f32 v253, v253, s56, s56
  v_mfma_f32_16x16x32_bf16 v[164:167], v[104:107], v[44:47], v[164:167]
  v_fma_f32 v254, v254, s56, s56
  v_fma_f32 v255, v255, s56, s56
  v_mfma_f32_16x16x32_bf16 v[192:195], v[64:67], v[88:91], v[192:195]
  v_rcp_f32 v252, v252
  v_mfma_f32_16x16x32_bf16 v[192:195], v[68:71], v[92:95], v[192:195]
  v_rcp_f32 v253, v253
  v_mfma_f32_16x16x32_bf16 v[192:195], v[16:19], v[116:119], v[192:195]
  v_rcp_f32 v254, v254
  v_mfma_f32_16x16x32_bf16 v[192:195], v[24:27], v[100:103], v[192:195]
  v_rcp_f32 v255, v255
  s_waitcnt lgkmcnt(2)
  v_mfma_f32_16x16x32_bf16 v[192:195], v[32:35], v[244:247], v[192:195]
  v_mul_f32 v152, v152, v248
  v_mul_f32 v153, v153, v249
  v_mfma_f32_16x16x32_bf16 v[192:195], v[40:43], v[84:87], v[192:195]
  v_mul_f32 v154, v154, v250
  v_mul_f32 v155, v155, v251
  v_mfma_f32_16x16x32_bf16 v[196:199], v[80:83], v[88:91], v[196:199]
  ds_read_b128 v[88:91], v2 offset:14336
  v_cvt_pk_bf16_f32 v12, v152, v153
  v_mfma_f32_16x16x32_bf16 v[196:199], v[240:243], v[92:95], v[196:199]
  ds_read_b128 v[92:95], v1 offset:14336
  v_cvt_pk_bf16_f32 v13, v154, v155
  v_mfma_f32_16x16x32_bf16 v[196:199], v[48:51], v[116:119], v[196:199]
  v_mul_f32 v156, v156, v252
  v_mul_f32 v157, v157, v253
  v_mfma_f32_16x16x32_bf16 v[196:199], v[52:55], v[100:103], v[196:199]
  v_mul_f32 v158, v158, v254
  v_mul_f32 v159, v159, v255
  v_mfma_f32_16x16x32_bf16 v[196:199], v[56:59], v[244:247], v[196:199]
  v_cvt_pk_bf16_f32 v14, v156, v157
  v_cvt_pk_bf16_f32 v15, v158, v159
  v_mfma_f32_16x16x32_bf16 v[196:199], v[60:63], v[84:87], v[196:199]
  buffer_store_dwordx4 v[12:15], v8, s[28:31], s48 offen offset:0 sc1
  v_fma_f32 v160, v160, v224, v232
  v_mfma_f32_16x16x32_bf16 v[168:171], v[20:23], v[112:115], v[168:171]
  v_fma_f32 v161, v161, v225, v233
  v_fma_f32 v162, v162, v226, v234
  v_mfma_f32_16x16x32_bf16 v[168:171], v[28:31], v[96:99], v[168:171]
  v_fma_f32 v163, v163, v227, v235
  v_exp_f32 v248, v160
  v_mfma_f32_16x16x32_bf16 v[168:171], v[136:139], v[36:39], v[168:171]
  ds_read_b128 v[156:159], v2 offset:24576
  v_exp_f32 v249, v161
  v_mfma_f32_16x16x32_bf16 v[168:171], v[128:131], v[44:47], v[168:171]
  v_exp_f32 v250, v162
  s_waitcnt lgkmcnt(3)
  v_mfma_f32_16x16x32_bf16 v[168:171], v[144:147], v[148:151], v[168:171]
  v_exp_f32 v251, v163
  v_mfma_f32_16x16x32_bf16 v[168:171], v[140:143], v[132:135], v[168:171]
  v_fma_f32 v164, v164, v228, v236
  v_fma_f32 v165, v165, v229, v237
  v_mfma_f32_16x16x32_bf16 v[172:175], v[72:75], v[112:115], v[172:175]
  ds_read_b128 v[112:115], v1 offset:24576
  v_fma_f32 v166, v166, v230, v238
  v_mfma_f32_16x16x32_bf16 v[172:175], v[76:79], v[96:99], v[172:175]
  v_fma_f32 v167, v167, v231, v239
  v_exp_f32 v252, v164
  v_mfma_f32_16x16x32_bf16 v[172:175], v[124:127], v[36:39], v[172:175]
  v_exp_f32 v253, v165
  v_mfma_f32_16x16x32_bf16 v[172:175], v[108:111], v[44:47], v[172:175]
  v_exp_f32 v254, v166
  v_mfma_f32_16x16x32_bf16 v[172:175], v[120:123], v[148:151], v[172:175]
  v_exp_f32 v255, v167
  v_mfma_f32_16x16x32_bf16 v[172:175], v[104:107], v[132:135], v[172:175]
  v_fma_f32 v248, v248, s56, s56
  v_fma_f32 v249, v249, s56, s56
  v_mfma_f32_16x16x32_bf16 v[200:203], v[64:67], v[116:119], v[200:203]
  v_fma_f32 v250, v250, s56, s56
  v_fma_f32 v251, v251, s56, s56
  v_mfma_f32_16x16x32_bf16 v[200:203], v[68:71], v[100:103], v[200:203]
  v_rcp_f32 v248, v248
  v_mfma_f32_16x16x32_bf16 v[200:203], v[16:19], v[244:247], v[200:203]
  v_rcp_f32 v249, v249
  v_mfma_f32_16x16x32_bf16 v[200:203], v[24:27], v[84:87], v[200:203]
  v_rcp_f32 v250, v250
  s_waitcnt lgkmcnt(1)
  v_mfma_f32_16x16x32_bf16 v[200:203], v[32:35], v[88:91], v[200:203]
  v_rcp_f32 v251, v251
  v_mfma_f32_16x16x32_bf16 v[200:203], v[40:43], v[92:95], v[200:203]
  v_fma_f32 v252, v252, s56, s56
  v_fma_f32 v253, v253, s56, s56
  v_mfma_f32_16x16x32_bf16 v[204:207], v[80:83], v[116:119], v[204:207]
  v_fma_f32 v254, v254, s56, s56
  v_fma_f32 v255, v255, s56, s56
  v_mfma_f32_16x16x32_bf16 v[204:207], v[240:243], v[100:103], v[204:207]
  v_rcp_f32 v252, v252
  v_mfma_f32_16x16x32_bf16 v[204:207], v[48:51], v[244:247], v[204:207]
  v_rcp_f32 v253, v253
  v_mfma_f32_16x16x32_bf16 v[204:207], v[52:55], v[84:87], v[204:207]
  v_rcp_f32 v254, v254
  v_mfma_f32_16x16x32_bf16 v[204:207], v[56:59], v[88:91], v[204:207]
  ds_read_b128 v[96:99], v2 offset:26624
  v_rcp_f32 v255, v255
  v_mfma_f32_16x16x32_bf16 v[204:207], v[60:63], v[92:95], v[204:207]
  ds_read_b128 v[32:35], v1 offset:26624
  v_mul_f32 v160, v160, v248
  v_mfma_f32_16x16x32_bf16 v[176:179], v[20:23], v[36:39], v[176:179]
  v_mul_f32 v161, v161, v249
  v_mul_f32 v162, v162, v250
  v_mfma_f32_16x16x32_bf16 v[176:179], v[28:31], v[44:47], v[176:179]
  v_mul_f32 v163, v163, v251
  v_cvt_pk_bf16_f32 v152, v160, v161
  v_mfma_f32_16x16x32_bf16 v[176:179], v[136:139], v[148:151], v[176:179]
  v_cvt_pk_bf16_f32 v153, v162, v163
  v_mul_f32 v164, v164, v252
  v_mfma_f32_16x16x32_bf16 v[176:179], v[128:131], v[132:135], v[176:179]
  v_mul_f32 v165, v165, v253
  v_mul_f32 v166, v166, v254
  v_mfma_f32_16x16x32_bf16 v[176:179], v[144:147], v[156:159], v[176:179]
  v_mul_f32 v167, v167, v255
  v_cvt_pk_bf16_f32 v154, v164, v165
  s_waitcnt lgkmcnt(2)
  v_mfma_f32_16x16x32_bf16 v[176:179], v[140:143], v[112:115], v[176:179]
  v_cvt_pk_bf16_f32 v155, v166, v167
  buffer_store_dwordx4 v[152:155], v8, s[28:31], s48 offen offset:1152 sc1
  v_mfma_f32_16x16x32_bf16 v[180:183], v[72:75], v[36:39], v[180:183]
  ds_read_b64_tr_b16 v[40:41], v3 offset:0
  v_fma_f32 v168, v168, v224, v232
  v_mfma_f32_16x16x32_bf16 v[180:183], v[76:79], v[44:47], v[180:183]
  ds_read_b64_tr_b16 v[42:43], v4 offset:0
  v_fma_f32 v169, v169, v225, v233
  v_mfma_f32_16x16x32_bf16 v[180:183], v[124:127], v[148:151], v[180:183]
  ds_read_b128 v[116:119], v2 offset:6144
  v_fma_f32 v170, v170, v226, v234
  v_mfma_f32_16x16x32_bf16 v[180:183], v[108:111], v[132:135], v[180:183]
  ds_read_b64_tr_b16 v[100:101], v3 offset:27840
  v_fma_f32 v171, v171, v227, v235
  v_mfma_f32_16x16x32_bf16 v[180:183], v[120:123], v[156:159], v[180:183]
  ds_read_b64_tr_b16 v[102:103], v4 offset:27840
  v_exp_f32 v248, v168
  v_mfma_f32_16x16x32_bf16 v[180:183], v[104:107], v[112:115], v[180:183]
  ds_read_b128 v[56:59], v1 offset:6144
  v_exp_f32 v249, v169
  v_mfma_f32_16x16x32_bf16 v[208:211], v[64:67], v[244:247], v[208:211]
  ds_read_b64_tr_b16 v[60:61], v3 offset:1024
  v_exp_f32 v250, v170
  v_mfma_f32_16x16x32_bf16 v[208:211], v[68:71], v[84:87], v[208:211]
  ds_read_b64_tr_b16 v[62:63], v4 offset:1024
  v_exp_f32 v251, v171
  v_mfma_f32_16x16x32_bf16 v[208:211], v[16:19], v[88:91], v[208:211]
  ds_read_b128 v[164:167], v2 offset:8192
  v_fma_f32 v172, v172, v228, v236
  v_mfma_f32_16x16x32_bf16 v[208:211], v[24:27], v[92:95], v[208:211]
  ds_read_b64_tr_b16 v[36:37], v3 offset:28864
  v_fma_f32 v173, v173, v229, v237
  v_mfma_f32_16x16x32_bf16 v[212:215], v[80:83], v[244:247], v[212:215]
  ds_read_b64_tr_b16 v[38:39], v4 offset:28864
  v_fma_f32 v174, v174, v230, v238
  v_mfma_f32_16x16x32_bf16 v[212:215], v[240:243], v[84:87], v[212:215]
  ds_read_b128 v[44:47], v1 offset:8192
  v_fma_f32 v175, v175, v231, v239
  v_mfma_f32_16x16x32_bf16 v[212:215], v[48:51], v[88:91], v[212:215]
  ds_read_b64_tr_b16 v[152:153], v3 offset:2048
  v_exp_f32 v252, v172
  v_mfma_f32_16x16x32_bf16 v[212:215], v[52:55], v[92:95], v[212:215]
  ds_read_b64_tr_b16 v[154:155], v4 offset:2048
  v_exp_f32 v253, v173
  v_mfma_f32_16x16x32_bf16 v[184:187], v[20:23], v[148:151], v[184:187]
  ds_read_b128 v[64:67], v2 offset:10240
  v_exp_f32 v254, v174
  v_mfma_f32_16x16x32_bf16 v[184:187], v[28:31], v[132:135], v[184:187]
  ds_read_b64_tr_b16 v[68:69], v3 offset:29888
  v_exp_f32 v255, v175
  v_mfma_f32_16x16x32_bf16 v[184:187], v[136:139], v[156:159], v[184:187]
  ds_read_b64_tr_b16 v[70:71], v4 offset:29888
  v_fma_f32 v248, v248, s56, s56
  v_mfma_f32_16x16x32_bf16 v[184:187], v[128:131], v[112:115], v[184:187]
  ds_read_b128 v[16:19], v1 offset:10240
  v_fma_f32 v249, v249, s56, s56
  s_waitcnt lgkmcnt(10)
  v_mfma_f32_16x16x32_bf16 v[184:187], v[144:147], v[96:99], v[184:187]
  ds_read_b128 v[24:27], v2 offset:12288
  v_fma_f32 v250, v250, s56, s56
  v_mfma_f32_16x16x32_bf16 v[184:187], v[140:143], v[32:35], v[184:187]
  ds_read_b128 v[80:83], v1 offset:12288
  v_fma_f32 v251, v251, s56, s56
  v_mfma_f32_16x16x32_bf16 v[188:191], v[72:75], v[148:151], v[188:191]
  ds_read_b128 v[244:247], v2 offset:28672
  v_rcp_f32 v248, v248
  v_mfma_f32_16x16x32_bf16 v[188:191], v[76:79], v[132:135], v[188:191]
  ds_read_b128 v[240:243], v1 offset:28672
  v_rcp_f32 v249, v249
  v_mfma_f32_16x16x32_bf16 v[188:191], v[124:127], v[156:159], v[188:191]
  v_rcp_f32 v250, v250
  v_mfma_f32_16x16x32_bf16 v[188:191], v[108:111], v[112:115], v[188:191]
  v_rcp_f32 v251, v251
  v_mfma_f32_16x16x32_bf16 v[188:191], v[120:123], v[96:99], v[188:191]
  v_fma_f32 v252, v252, s56, s56
  v_fma_f32 v253, v253, s56, s56
  v_mfma_f32_16x16x32_bf16 v[188:191], v[104:107], v[32:35], v[188:191]
  v_fma_f32 v254, v254, s56, s56
  v_fma_f32 v255, v255, s56, s56
  v_mfma_f32_16x16x32_bf16 v[216:219], v[40:43], v[116:119], v[216:219]
  v_rcp_f32 v252, v252
  v_mfma_f32_16x16x32_bf16 v[216:219], v[100:103], v[56:59], v[216:219]
  v_rcp_f32 v253, v253
  s_waitcnt lgkmcnt(4)
  v_mfma_f32_16x16x32_bf16 v[216:219], v[60:63], v[164:167], v[216:219]
  ds_read_b128 v[84:87], v2 offset:30720
  v_rcp_f32 v254, v254
  v_mfma_f32_16x16x32_bf16 v[216:219], v[36:39], v[44:47], v[216:219]
  ds_read_b128 v[48:51], v1 offset:30720
  v_rcp_f32 v255, v255
  v_mfma_f32_16x16x32_bf16 v[216:219], v[152:155], v[64:67], v[216:219]
  v_mul_f32 v168, v168, v248
  v_mul_f32 v169, v169, v249
  v_mfma_f32_16x16x32_bf16 v[216:219], v[68:71], v[16:19], v[216:219]
  v_mul_f32 v170, v170, v250
  v_mul_f32 v171, v171, v251
  v_mfma_f32_16x16x32_bf16 v[220:223], v[40:43], v[164:167], v[220:223]
  v_cvt_pk_bf16_f32 v160, v168, v169
  v_cvt_pk_bf16_f32 v161, v170, v171
  v_mfma_f32_16x16x32_bf16 v[220:223], v[100:103], v[44:47], v[220:223]
  v_mul_f32 v172, v172, v252
  v_mul_f32 v173, v173, v253
  v_mfma_f32_16x16x32_bf16 v[220:223], v[60:63], v[64:67], v[220:223]
  v_mul_f32 v174, v174, v254
  v_mul_f32 v175, v175, v255
  v_mfma_f32_16x16x32_bf16 v[220:223], v[36:39], v[16:19], v[220:223]
  v_cvt_pk_bf16_f32 v162, v172, v173
  v_cvt_pk_bf16_f32 v163, v174, v175
  s_waitcnt lgkmcnt(2)
  v_mfma_f32_16x16x32_bf16 v[220:223], v[152:155], v[24:27], v[220:223]
  buffer_store_dwordx4 v[160:163], v8, s[28:31], s48 offen offset:2304 sc1
  v_fma_f32 v176, v176, v224, v232
  v_mfma_f32_16x16x32_bf16 v[220:223], v[68:71], v[80:83], v[220:223]
  v_fma_f32 v177, v177, v225, v233
  v_fma_f32 v178, v178, v226, v234
  v_mfma_f32_16x16x32_bf16 v[192:195], v[20:23], v[156:159], v[192:195]
  v_fma_f32 v179, v179, v227, v235
  v_exp_f32 v248, v176
  v_mfma_f32_16x16x32_bf16 v[192:195], v[28:31], v[112:115], v[192:195]
  v_exp_f32 v249, v177
  v_mfma_f32_16x16x32_bf16 v[192:195], v[136:139], v[96:99], v[192:195]
  v_exp_f32 v250, v178
  v_mfma_f32_16x16x32_bf16 v[192:195], v[128:131], v[32:35], v[192:195]
  v_exp_f32 v251, v179
  v_mfma_f32_16x16x32_bf16 v[192:195], v[144:147], v[244:247], v[192:195]
  v_fma_f32 v180, v180, v228, v236
  v_fma_f32 v181, v181, v229, v237
  v_mfma_f32_16x16x32_bf16 v[192:195], v[140:143], v[240:243], v[192:195]
  v_fma_f32 v182, v182, v230, v238
  v_fma_f32 v183, v183, v231, v239
  v_mfma_f32_16x16x32_bf16 v[196:199], v[72:75], v[156:159], v[196:199]
  v_subrev_u32 v3, 55680, v3
  v_exp_f32 v252, v180
  v_mfma_f32_16x16x32_bf16 v[196:199], v[76:79], v[112:115], v[196:199]
  v_subrev_u32 v4, 55680, v4
  v_exp_f32 v253, v181
  v_mfma_f32_16x16x32_bf16 v[196:199], v[124:127], v[96:99], v[196:199]
  ds_read_b64_tr_b16 v[88:89], v3 offset:0
  v_exp_f32 v254, v182
  v_mfma_f32_16x16x32_bf16 v[196:199], v[108:111], v[32:35], v[196:199]
  ds_read_b64_tr_b16 v[90:91], v4 offset:0
  v_exp_f32 v255, v183
  v_mfma_f32_16x16x32_bf16 v[196:199], v[120:123], v[244:247], v[196:199]
  ds_read_b128 v[52:55], v2 offset:22528
  v_fma_f32 v248, v248, s56, s56
  v_mfma_f32_16x16x32_bf16 v[196:199], v[104:107], v[240:243], v[196:199]
  ds_read_b64_tr_b16 v[92:93], v3 offset:27840
  v_fma_f32 v249, v249, s56, s56
  v_mfma_f32_16x16x32_bf16 v[200:203], v[20:23], v[96:99], v[200:203]
  ds_read_b64_tr_b16 v[94:95], v4 offset:27840
  v_fma_f32 v250, v250, s56, s56
  v_mfma_f32_16x16x32_bf16 v[200:203], v[28:31], v[32:35], v[200:203]
  ds_read_b128 v[148:151], v1 offset:22528
  v_fma_f32 v251, v251, s56, s56
  v_mfma_f32_16x16x32_bf16 v[200:203], v[136:139], v[244:247], v[200:203]
  ds_read_b64_tr_b16 v[132:133], v3 offset:1024
  v_rcp_f32 v248, v248
  v_mfma_f32_16x16x32_bf16 v[200:203], v[128:131], v[240:243], v[200:203]
  ds_read_b64_tr_b16 v[134:135], v4 offset:1024
  v_rcp_f32 v249, v249
  s_waitcnt lgkmcnt(8)
  v_mfma_f32_16x16x32_bf16 v[200:203], v[144:147], v[84:87], v[200:203]
  ds_read_b128 v[116:119], v2 offset:24576
  v_rcp_f32 v250, v250
  v_mfma_f32_16x16x32_bf16 v[200:203], v[140:143], v[48:51], v[200:203]
  ds_read_b64_tr_b16 v[56:57], v3 offset:28864
  v_rcp_f32 v251, v251
  v_mfma_f32_16x16x32_bf16 v[204:207], v[72:75], v[96:99], v[204:207]
  ds_read_b64_tr_b16 v[58:59], v4 offset:28864
  v_fma_f32 v252, v252, s56, s56
  v_mfma_f32_16x16x32_bf16 v[204:207], v[76:79], v[32:35], v[204:207]
  ds_read_b128 v[40:43], v1 offset:24576
  v_fma_f32 v253, v253, s56, s56
  v_mfma_f32_16x16x32_bf16 v[204:207], v[124:127], v[244:247], v[204:207]
  ds_read_b64_tr_b16 v[164:165], v3 offset:2048
  v_fma_f32 v254, v254, s56, s56
  v_mfma_f32_16x16x32_bf16 v[204:207], v[108:111], v[240:243], v[204:207]
  ds_read_b64_tr_b16 v[166:167], v4 offset:2048
  v_fma_f32 v255, v255, s56, s56
  v_mfma_f32_16x16x32_bf16 v[204:207], v[120:123], v[84:87], v[204:207]
  ds_read_b128 v[100:103], v2 offset:26624
  v_rcp_f32 v252, v252
  v_mfma_f32_16x16x32_bf16 v[204:207], v[104:107], v[48:51], v[204:207]
  ds_read_b64_tr_b16 v[44:45], v3 offset:29888
  v_rcp_f32 v253, v253
  v_mfma_f32_16x16x32_bf16 v[208:211], v[20:23], v[244:247], v[208:211]
  ds_read_b64_tr_b16 v[46:47], v4 offset:29888
  v_rcp_f32 v254, v254
  v_mfma_f32_16x16x32_bf16 v[208:211], v[28:31], v[240:243], v[208:211]
  ds_read_b128 v[60:63], v11 offset:0
  v_rcp_f32 v255, v255
  v_mfma_f32_16x16x32_bf16 v[208:211], v[136:139], v[84:87], v[208:211]
  ds_read_b128 v[64:67], v11 offset:256
  v_mul_f32 v176, v176, v248
  v_mfma_f32_16x16x32_bf16 v[208:211], v[128:131], v[48:51], v[208:211]
  ds_read_b128 v[36:39], v1 offset:26624
  v_mul_f32 v177, v177, v249
  v_mfma_f32_16x16x32_bf16 v[212:215], v[72:75], v[244:247], v[212:215]
  ds_read_b128 v[16:19], v2 offset:28672
  v_mul_f32 v178, v178, v250
  v_mfma_f32_16x16x32_bf16 v[212:215], v[76:79], v[240:243], v[212:215]
  ds_read_b128 v[172:175], v1 offset:28672
  v_mul_f32 v179, v179, v251
  v_mfma_f32_16x16x32_bf16 v[212:215], v[124:127], v[84:87], v[212:215]
  v_cvt_pk_bf16_f32 v168, v176, v177
  v_cvt_pk_bf16_f32 v169, v178, v179
  v_mfma_f32_16x16x32_bf16 v[212:215], v[108:111], v[48:51], v[212:215]
  v_mul_f32 v180, v180, v252
  v_mul_f32 v181, v181, v253
  s_waitcnt lgkmcnt(8)
  v_mfma_f32_16x16x32_bf16 v[216:219], v[88:91], v[52:55], v[216:219]
  v_mul_f32 v182, v182, v254
  v_mul_f32 v183, v183, v255
  v_mfma_f32_16x16x32_bf16 v[216:219], v[92:95], v[148:151], v[216:219]
  v_cvt_pk_bf16_f32 v170, v180, v181
  v_cvt_pk_bf16_f32 v171, v182, v183
  v_mfma_f32_16x16x32_bf16 v[216:219], v[132:135], v[116:119], v[216:219]
  buffer_store_dwordx4 v[168:171], v8, s[28:31], s48 offen offset:3456 sc1
  v_fma_f32 v184, v184, v224, v232
  v_mfma_f32_16x16x32_bf16 v[216:219], v[56:59], v[40:43], v[216:219]
  v_fma_f32 v185, v185, v225, v233
  v_fma_f32 v186, v186, v226, v234
  s_waitcnt lgkmcnt(4)
  v_mfma_f32_16x16x32_bf16 v[216:219], v[164:167], v[100:103], v[216:219]
  v_fma_f32 v187, v187, v227, v235
  v_exp_f32 v248, v184
  s_waitcnt lgkmcnt(2)
  v_mfma_f32_16x16x32_bf16 v[216:219], v[44:47], v[36:39], v[216:219]
  v_exp_f32 v249, v185
  v_mfma_f32_16x16x32_bf16 v[220:223], v[88:91], v[116:119], v[220:223]
  v_exp_f32 v250, v186
  v_mfma_f32_16x16x32_bf16 v[220:223], v[92:95], v[40:43], v[220:223]
  v_exp_f32 v251, v187
  v_mfma_f32_16x16x32_bf16 v[220:223], v[132:135], v[100:103], v[220:223]
  v_fma_f32 v188, v188, v228, v236
  v_fma_f32 v189, v189, v229, v237
  v_mfma_f32_16x16x32_bf16 v[220:223], v[56:59], v[36:39], v[220:223]
  v_fma_f32 v190, v190, v230, v238
  v_fma_f32 v191, v191, v231, v239
  s_waitcnt lgkmcnt(0)
  v_mfma_f32_16x16x32_bf16 v[220:223], v[164:167], v[16:19], v[220:223]
  v_exp_f32 v252, v188
  v_mfma_f32_16x16x32_bf16 v[220:223], v[44:47], v[172:175], v[220:223]
  v_exp_f32 v253, v189
  v_exp_f32 v254, v190
  v_exp_f32 v255, v191
  v_pk_fma_f32 v[248:249], v[248:249], s[56:57], s[56:57]
  v_pk_fma_f32 v[250:251], v[250:251], s[56:57], s[56:57]
  v_rcp_f32 v248, v248
  v_rcp_f32 v249, v249
  v_rcp_f32 v250, v250
  v_rcp_f32 v251, v251
  v_pk_fma_f32 v[252:253], v[252:253], s[56:57], s[56:57]
  v_pk_fma_f32 v[254:255], v[254:255], s[56:57], s[56:57]
  v_rcp_f32 v252, v252
  v_rcp_f32 v253, v253
  v_rcp_f32 v254, v254
  v_rcp_f32 v255, v255
  v_pk_mul_f32 v[184:185], v[184:185], v[248:249]
  v_pk_mul_f32 v[186:187], v[186:187], v[250:251]
  v_cvt_pk_bf16_f32 v176, v184, v185
  v_cvt_pk_bf16_f32 v177, v186, v187
  v_pk_mul_f32 v[188:189], v[188:189], v[252:253]
  v_pk_mul_f32 v[190:191], v[190:191], v[254:255]
  v_cvt_pk_bf16_f32 v178, v188, v189
  v_cvt_pk_bf16_f32 v179, v190, v191
  buffer_store_dwordx4 v[176:179], v8, s[28:31], s49 offen offset:0 sc1
  v_pk_fma_f32 v[192:193], v[192:193], v[224:225], v[232:233]
  v_pk_fma_f32 v[194:195], v[194:195], v[226:227], v[234:235]
  v_exp_f32 v248, v192
  v_exp_f32 v249, v193
  v_exp_f32 v250, v194
  v_exp_f32 v251, v195
  v_pk_fma_f32 v[196:197], v[196:197], v[228:229], v[236:237]
  v_pk_fma_f32 v[198:199], v[198:199], v[230:231], v[238:239]
  v_exp_f32 v252, v196
  v_exp_f32 v253, v197
  v_exp_f32 v254, v198
  v_exp_f32 v255, v199
  v_pk_fma_f32 v[248:249], v[248:249], s[56:57], s[56:57]
  v_pk_fma_f32 v[250:251], v[250:251], s[56:57], s[56:57]
  v_rcp_f32 v248, v248
  v_rcp_f32 v249, v249
  v_rcp_f32 v250, v250
  v_rcp_f32 v251, v251
  v_pk_fma_f32 v[252:253], v[252:253], s[56:57], s[56:57]
  v_pk_fma_f32 v[254:255], v[254:255], s[56:57], s[56:57]
  v_rcp_f32 v252, v252
  v_rcp_f32 v253, v253
  v_rcp_f32 v254, v254
  v_rcp_f32 v255, v255
  v_pk_mul_f32 v[192:193], v[192:193], v[248:249]
  v_pk_mul_f32 v[194:195], v[194:195], v[250:251]
  v_cvt_pk_bf16_f32 v184, v192, v193
  v_cvt_pk_bf16_f32 v185, v194, v195
  v_pk_mul_f32 v[196:197], v[196:197], v[252:253]
  v_pk_mul_f32 v[198:199], v[198:199], v[254:255]
  v_cvt_pk_bf16_f32 v186, v196, v197
  v_cvt_pk_bf16_f32 v187, v198, v199
  buffer_store_dwordx4 v[184:187], v8, s[28:31], s49 offen offset:1152 sc1
  v_pk_fma_f32 v[200:201], v[200:201], v[224:225], v[232:233]
  v_pk_fma_f32 v[202:203], v[202:203], v[226:227], v[234:235]
  v_exp_f32 v248, v200
  v_exp_f32 v249, v201
  v_exp_f32 v250, v202
  v_exp_f32 v251, v203
  v_pk_fma_f32 v[204:205], v[204:205], v[228:229], v[236:237]
  v_pk_fma_f32 v[206:207], v[206:207], v[230:231], v[238:239]
  v_exp_f32 v252, v204
  v_exp_f32 v253, v205
  v_exp_f32 v254, v206
  v_exp_f32 v255, v207
  v_pk_fma_f32 v[248:249], v[248:249], s[56:57], s[56:57]
  v_pk_fma_f32 v[250:251], v[250:251], s[56:57], s[56:57]
  v_rcp_f32 v248, v248
  v_rcp_f32 v249, v249
  v_rcp_f32 v250, v250
  v_rcp_f32 v251, v251
  v_pk_fma_f32 v[252:253], v[252:253], s[56:57], s[56:57]
  v_pk_fma_f32 v[254:255], v[254:255], s[56:57], s[56:57]
  v_rcp_f32 v252, v252
  v_rcp_f32 v253, v253
  v_rcp_f32 v254, v254
  v_rcp_f32 v255, v255
  v_pk_mul_f32 v[200:201], v[200:201], v[248:249]
  v_pk_mul_f32 v[202:203], v[202:203], v[250:251]
  v_cvt_pk_bf16_f32 v192, v200, v201
  v_cvt_pk_bf16_f32 v193, v202, v203
  v_pk_mul_f32 v[204:205], v[204:205], v[252:253]
  v_pk_mul_f32 v[206:207], v[206:207], v[254:255]
  v_cvt_pk_bf16_f32 v194, v204, v205
  v_cvt_pk_bf16_f32 v195, v206, v207
  buffer_store_dwordx4 v[192:195], v8, s[28:31], s49 offen offset:2304 sc1
  v_pk_fma_f32 v[208:209], v[208:209], v[224:225], v[232:233]
  v_pk_fma_f32 v[210:211], v[210:211], v[226:227], v[234:235]
  v_exp_f32 v248, v208
  v_exp_f32 v249, v209
  v_exp_f32 v250, v210
  v_exp_f32 v251, v211
  v_pk_fma_f32 v[212:213], v[212:213], v[228:229], v[236:237]
  v_pk_fma_f32 v[214:215], v[214:215], v[230:231], v[238:239]
  v_exp_f32 v252, v212
  v_exp_f32 v253, v213
  v_exp_f32 v254, v214
  v_exp_f32 v255, v215
  v_pk_fma_f32 v[248:249], v[248:249], s[56:57], s[56:57]
  v_pk_fma_f32 v[250:251], v[250:251], s[56:57], s[56:57]
  v_rcp_f32 v248, v248
  v_rcp_f32 v249, v249
  v_rcp_f32 v250, v250
  v_rcp_f32 v251, v251
  v_pk_fma_f32 v[252:253], v[252:253], s[56:57], s[56:57]
  v_pk_fma_f32 v[254:255], v[254:255], s[56:57], s[56:57]
  v_rcp_f32 v252, v252
  v_rcp_f32 v253, v253
  v_rcp_f32 v254, v254
  v_rcp_f32 v255, v255
  v_pk_mul_f32 v[208:209], v[208:209], v[248:249]
  v_pk_mul_f32 v[210:211], v[210:211], v[250:251]
  v_cvt_pk_bf16_f32 v200, v208, v209
  v_cvt_pk_bf16_f32 v201, v210, v211
  v_pk_mul_f32 v[212:213], v[212:213], v[252:253]
  v_pk_mul_f32 v[214:215], v[214:215], v[254:255]
  v_cvt_pk_bf16_f32 v202, v212, v213
  v_cvt_pk_bf16_f32 v203, v214, v215
  buffer_store_dwordx4 v[200:203], v8, s[28:31], s49 offen offset:3456 sc1
  v_pk_fma_f32 v[216:217], v[216:217], v[60:61], v[64:65]
  v_pk_fma_f32 v[218:219], v[218:219], v[62:63], v[66:67]
  v_exp_f32 v248, v216
  v_exp_f32 v249, v217
  v_exp_f32 v250, v218
  v_exp_f32 v251, v219
  v_pk_fma_f32 v[220:221], v[220:221], v[60:61], v[64:65]
  v_pk_fma_f32 v[222:223], v[222:223], v[62:63], v[66:67]
  v_exp_f32 v252, v220
  v_exp_f32 v253, v221
  v_exp_f32 v254, v222
  v_exp_f32 v255, v223
  v_pk_fma_f32 v[248:249], v[248:249], s[56:57], s[56:57]
  v_pk_fma_f32 v[250:251], v[250:251], s[56:57], s[56:57]
  v_rcp_f32 v248, v248
  v_rcp_f32 v249, v249
  v_rcp_f32 v250, v250
  v_rcp_f32 v251, v251
  v_pk_fma_f32 v[252:253], v[252:253], s[56:57], s[56:57]
  v_pk_fma_f32 v[254:255], v[254:255], s[56:57], s[56:57]
  v_rcp_f32 v252, v252
  v_rcp_f32 v253, v253
  v_rcp_f32 v254, v254
  v_rcp_f32 v255, v255
  v_pk_mul_f32 v[216:217], v[216:217], v[248:249]
  v_pk_mul_f32 v[218:219], v[218:219], v[250:251]
  v_cvt_pk_bf16_f32 v208, v216, v217
  v_cvt_pk_bf16_f32 v209, v218, v219
  v_pk_mul_f32 v[220:221], v[220:221], v[252:253]
  v_pk_mul_f32 v[222:223], v[222:223], v[254:255]
  v_cvt_pk_bf16_f32 v210, v220, v221
  v_cvt_pk_bf16_f32 v211, v222, v223
  s_nop 1
  v_permlane16_swap_b32 v208, v210
  v_permlane16_swap_b32 v209, v211
  buffer_store_dwordx4 v[208:211], v9, s[28:31], s50 offen
  s_endpgm
.fill ((832 - (. - L_base)) & 4095) / 4, 4, 0xbf810000
L_sp3_go:
  s_cmp_eq_u32 0, 0
  s_branch L_t_sp3_0
L_r_sp3_0:
  s_barrier
  s_mov_b32 s53, 6
  s_mov_b32 s54, 1
  s_mov_b32 s52, 55680
  s_mov_b32 s55, 16384
  s_mov_b32 s51, 16384
  ds_read_b64_tr_b16 v[64:65], v6 offset:4128
  ds_read_b64_tr_b16 v[66:67], v6 offset:4640
  ds_read_b128 v[16:19], v2 offset:0
  ds_read_b64_tr_b16 v[68:69], v6 offset:8256
  ds_read_b64_tr_b16 v[70:71], v6 offset:8768
  ds_read_b128 v[20:23], v2 offset:2048
  ds_read_b64_tr_b16 v[80:81], v7 offset:8256
  ds_read_b64_tr_b16 v[82:83], v7 offset:8768
  ds_read_b64_tr_b16 v[76:77], v7 offset:4128
  ds_read_b64_tr_b16 v[78:79], v7 offset:4640
  ds_read_b64_tr_b16 v[60:61], v6 offset:0
  ds_read_b64_tr_b16 v[62:63], v6 offset:512
  ds_read_b128 v[24:27], v2 offset:4096
  ds_read_b64_tr_b16 v[72:73], v7 offset:0
  ds_read_b64_tr_b16 v[74:75], v7 offset:512
  ds_read_b128 v[28:31], v2 offset:6144
  ds_read_b128 v[32:35], v2 offset:8192
  ds_read_b128 v[36:39], v2 offset:10240
  ds_read_b128 v[40:43], v2 offset:12288
  ds_read_b128 v[44:47], v2 offset:14336
  ds_read_b64_tr_b16 v[48:49], v3 offset:0
  ds_read_b64_tr_b16 v[50:51], v4 offset:0
  ds_read_b64_tr_b16 v[52:53], v3 offset:1024
  ds_read_b64_tr_b16 v[54:55], v4 offset:1024
  ds_read_b64_tr_b16 v[56:57], v3 offset:2048
  ds_read_b64_tr_b16 v[58:59], v4 offset:2048
  s_waitcnt lgkmcnt(15)
  v_mfma_f32_16x16x32_bf16 v[152:155], v[64:67], v[16:19], 0
  v_mfma_f32_16x16x32_bf16 v[152:155], v[68:71], v[20:23], v[152:155]
  v_mfma_f32_16x16x32_bf16 v[156:159], v[80:83], v[20:23], 0
  v_mfma_f32_16x16x32_bf16 v[156:159], v[76:79], v[16:19], v[156:159]
  s_waitcnt lgkmcnt(0)
  s_barrier
  ds_read_b64_tr_b16 v[132:133], v6 offset:31968
  v_mfma_f32_16x16x32_bf16 v[160:163], v[60:63], v[16:19], 0
  ds_read_b64_tr_b16 v[134:135], v6 offset:32480
  v_mfma_f32_16x16x32_bf16 v[160:163], v[64:67], v[20:23], v[160:163]
  ds_read_b128 v[84:87], v1 offset:0
  v_mfma_f32_16x16x32_bf16 v[160:163], v[68:71], v[24:27], v[160:163]
  v_mfma_f32_16x16x32_bf16 v[164:167], v[80:83], v[24:27], 0
  ds_read_b64_tr_b16 v[136:137], v6 offset:36096
  v_mfma_f32_16x16x32_bf16 v[164:167], v[76:79], v[20:23], v[164:167]
  ds_read_b64_tr_b16 v[138:139], v6 offset:36608
  v_mfma_f32_16x16x32_bf16 v[164:167], v[72:75], v[16:19], v[164:167]
  ds_read_b128 v[88:91], v1 offset:2048
  v_mfma_f32_16x16x32_bf16 v[168:171], v[60:63], v[20:23], 0
  v_mfma_f32_16x16x32_bf16 v[168:171], v[64:67], v[24:27], v[168:171]
  ds_read_b64_tr_b16 v[148:149], v7 offset:36096
  v_mfma_f32_16x16x32_bf16 v[168:171], v[68:71], v[28:31], v[168:171]
  ds_read_b64_tr_b16 v[150:151], v7 offset:36608
  v_mfma_f32_16x16x32_bf16 v[172:175], v[80:83], v[28:31], 0
  ds_read_b64_tr_b16 v[144:145], v7 offset:31968
  v_mfma_f32_16x16x32_bf16 v[172:175], v[76:79], v[24:27], v[172:175]
  ds_read_b64_tr_b16 v[146:147], v7 offset:32480
  v_mfma_f32_16x16x32_bf16 v[172:175], v[72:75], v[20:23], v[172:175]
  ds_read_b64_tr_b16 v[128:129], v6 offset:27840
  v_mfma_f32_16x16x32_bf16 v[176:179], v[60:63], v[24:27], 0
  ds_read_b64_tr_b16 v[130:131], v6 offset:28352
  v_mfma_f32_16x16x32_bf16 v[176:179], v[64:67], v[28:31], v[176:179]
  ds_read_b128 v[92:95], v1 offset:4096
  v_mfma_f32_16x16x32_bf16 v[176:179], v[68:71], v[32:35], v[176:179]
  v_mfma_f32_16x16x32_bf16 v[180:183], v[80:83], v[32:35], 0
  ds_read_b64_tr_b16 v[140:141], v7 offset:27840
  v_mfma_f32_16x16x32_bf16 v[180:183], v[76:79], v[28:31], v[180:183]
  ds_read_b64_tr_b16 v[142:143], v7 offset:28352
  v_mfma_f32_16x16x32_bf16 v[180:183], v[72:75], v[24:27], v[180:183]
  v_mfma_f32_16x16x32_bf16 v[184:187], v[60:63], v[28:31], 0
  ds_read_b128 v[96:99], v1 offset:6144
  v_mfma_f32_16x16x32_bf16 v[184:187], v[64:67], v[32:35], v[184:187]
  v_mfma_f32_16x16x32_bf16 v[184:187], v[68:71], v[36:39], v[184:187]
  ds_read_b128 v[100:103], v1 offset:8192
  v_mfma_f32_16x16x32_bf16 v[188:191], v[80:83], v[36:39], 0
  v_mfma_f32_16x16x32_bf16 v[188:191], v[76:79], v[32:35], v[188:191]
  ds_read_b128 v[104:107], v1 offset:10240
  v_mfma_f32_16x16x32_bf16 v[188:191], v[72:75], v[28:31], v[188:191]
  v_mfma_f32_16x16x32_bf16 v[192:195], v[60:63], v[32:35], 0
  ds_read_b128 v[108:111], v1 offset:12288
  v_mfma_f32_16x16x32_bf16 v[192:195], v[64:67], v[36:39], v[192:195]
  v_mfma_f32_16x16x32_bf16 v[192:195], v[68:71], v[40:43], v[192:195]
  ds_read_b128 v[112:115], v1 offset:14336
  v_mfma_f32_16x16x32_bf16 v[196:199], v[80:83], v[40:43], 0
  v_mfma_f32_16x16x32_bf16 v[196:199], v[76:79], v[36:39], v[196:199]
  ds_read_b64_tr_b16 v[116:117], v3 offset:27840
  v_mfma_f32_16x16x32_bf16 v[196:199], v[72:75], v[32:35], v[196:199]
  ds_read_b64_tr_b16 v[118:119], v4 offset:27840
  v_mfma_f32_16x16x32_bf16 v[200:203], v[60:63], v[36:39], 0
  ds_read_b64_tr_b16 v[120:121], v3 offset:28864
  v_mfma_f32_16x16x32_bf16 v[200:203], v[64:67], v[40:43], v[200:203]
  ds_read_b64_tr_b16 v[122:123], v4 offset:28864
  v_mfma_f32_16x16x32_bf16 v[200:203], v[68:71], v[44:47], v[200:203]
  ds_read_b64_tr_b16 v[124:125], v3 offset:29888
  v_mfma_f32_16x16x32_bf16 v[204:207], v[80:83], v[44:47], 0
  ds_read_b64_tr_b16 v[126:127], v4 offset:29888
  v_mfma_f32_16x16x32_bf16 v[204:207], v[76:79], v[40:43], v[204:207]
  v_mfma_f32_16x16x32_bf16 v[204:207], v[72:75], v[36:39], v[204:207]
  v_mfma_f32_16x16x32_bf16 v[208:211], v[60:63], v[40:43], 0
  v_add_u32 v2, s51, v2
  v_add_u32 v1, s51, v1
  v_mfma_f32_16x16x32_bf16 v[208:211], v[64:67], v[44:47], v[208:211]
  v_add_u32 v6, s52, v6
  v_add_u32 v7, s52, v7
  v_mfma_f32_16x16x32_bf16 v[212:215], v[76:79], v[44:47], 0
  v_add_u32 v3, s52, v3
  v_add_u32 v4, s52, v4
  v_mfma_f32_16x16x32_bf16 v[212:215], v[72:75], v[40:43], v[212:215]
  s_cmp_eq_u32 s54, 2
  s_cselect_b32 s51, 4294934528, s55
  v_mfma_f32_16x16x32_bf16 v[216:219], v[48:51], v[36:39], 0
  s_cselect_b32 s54, -1, s54
  s_add_u32 s54, s54, 1
  v_mfma_f32_16x16x32_bf16 v[216:219], v[52:55], v[40:43], v[216:219]
  s_sub_u32 s52, 0, s52
  v_mfma_f32_16x16x32_bf16 v[216:219], v[56:59], v[44:47], v[216:219]
  v_mfma_f32_16x16x32_bf16 v[220:223], v[52:55], v[44:47], 0
  v_mfma_f32_16x16x32_bf16 v[220:223], v[48:51], v[40:43], v[220:223]
L_sp3_loop:
  s_waitcnt lgkmcnt(0)
  v_mfma_f32_16x16x32_bf16 v[152:155], v[132:135], v[84:87], v[152:155]
  s_barrier
  ds_read_b64_tr_b16 v[64:65], v6 offset:4128
  v_mfma_f32_16x16x32_bf16 v[152:155], v[136:139], v[88:91], v[152:155]
  ds_read_b64_tr_b16 v[66:67], v6 offset:4640
  v_mfma_f32_16x16x32_bf16 v[156:159], v[148:151], v[88:91], v[156:159]
  ds_read_b128 v[16:19], v2 offset:0
  v_mfma_f32_16x16x32_bf16 v[156:159], v[144:147], v[84:87], v[156:159]
  v_mfma_f32_16x16x32_bf16 v[160:163], v[128:131], v[84:87], v[160:163]
  ds_read_b64_tr_b16 v[68:69], v6 offset:8256
  v_mfma_f32_16x16x32_bf16 v[160:163], v[132:135], v[88:91], v[160:163]
  ds_read_b64_tr_b16 v[70:71], v6 offset:8768
  v_mfma_f32_16x16x32_bf16 v[160:163], v[136:139], v[92:95], v[160:163]
  ds_read_b128 v[20:23], v2 offset:2048
  v_mfma_f32_16x16x32_bf16 v[164:167], v[148:151], v[92:95], v[164:167]
  v_mfma_f32_16x16x32_bf16 v[164:167], v[144:147], v[88:91], v[164:167]
  ds_read_b64_tr_b16 v[80:81], v7 offset:8256
  v_mfma_f32_16x16x32_bf16 v[164:167], v[140:143], v[84:87], v[164:167]
  ds_read_b64_tr_b16 v[82:83], v7 offset:8768
  v_mfma_f32_16x16x32_bf16 v[168:171], v[128:131], v[88:91], v[168:171]
  ds_read_b64_tr_b16 v[76:77], v7 offset:4128
  v_mfma_f32_16x16x32_bf16 v[168:171], v[132:135], v[92:95], v[168:171]
  ds_read_b64_tr_b16 v[78:79], v7 offset:4640
  v_mfma_f32_16x16x32_bf16 v[168:171], v[136:139], v[96:99], v[168:171]
  ds_read_b64_tr_b16 v[60:61], v6 offset:0
  v_mfma_f32_16x16x32_bf16 v[172:175], v[148:151], v[96:99], v[172:175]
  ds_read_b64_tr_b16 v[62:63], v6 offset:512
  v_mfma_f32_16x16x32_bf16 v[172:175], v[144:147], v[92:95], v[172:175]
  ds_read_b128 v[24:27], v2 offset:4096
  v_mfma_f32_16x16x32_bf16 v[172:175], v[140:143], v[88:91], v[172:175]
  v_mfma_f32_16x16x32_bf16 v[176:179], v[128:131], v[92:95], v[176:179]
  ds_read_b64_tr_b16 v[72:73], v7 offset:0
  v_mfma_f32_16x16x32_bf16 v[176:179], v[132:135], v[96:99], v[176:179]
  ds_read_b64_tr_b16 v[74:75], v7 offset:512
  v_mfma_f32_16x16x32_bf16 v[176:179], v[136:139], v[100:103], v[176:179]
  v_mfma_f32_16x16x32_bf16 v[180:183], v[148:151], v[100:103], v[180:183]
  ds_read_b128 v[28:31], v2 offset:6144
  v_mfma_f32_16x16x32_bf16 v[180:183], v[144:147], v[96:99], v[180:183]
  v_mfma_f32_16x16x32_bf16 v[180:183], v[140:143], v[92:95], v[180:183]
  ds_read_b128 v[32:35], v2 offset:8192
  v_mfma_f32_16x16x32_bf16 v[184:187], v[128:131], v[96:99], v[184:187]
  v_mfma_f32_16x16x32_bf16 v[184:187], v[132:135], v[100:103], v[184:187]
  ds_read_b128 v[36:39], v2 offset:10240
  v_mfma_f32_16x16x32_bf16 v[184:187], v[136:139], v[104:107], v[184:187]
  v_mfma_f32_16x16x32_bf16 v[188:191], v[148:151], v[104:107], v[188:191]
  ds_read_b128 v[40:43], v2 offset:12288
  v_mfma_f32_16x16x32_bf16 v[188:191], v[144:147], v[100:103], v[188:191]
  v_mfma_f32_16x16x32_bf16 v[188:191], v[140:143], v[96:99], v[188:191]
  ds_read_b128 v[44:47], v2 offset:14336
  v_mfma_f32_16x16x32_bf16 v[192:195], v[128:131], v[100:103], v[192:195]
  v_mfma_f32_16x16x32_bf16 v[192:195], v[132:135], v[104:107], v[192:195]
  ds_read_b64_tr_b16 v[48:49], v3 offset:0
  v_mfma_f32_16x16x32_bf16 v[192:195], v[136:139], v[108:111], v[192:195]
  ds_read_b64_tr_b16 v[50:51], v4 offset:0
  v_mfma_f32_16x16x32_bf16 v[196:199], v[148:151], v[108:111], v[196:199]
  ds_read_b64_tr_b16 v[52:53], v3 offset:1024
  v_mfma_f32_16x16x32_bf16 v[196:199], v[144:147], v[104:107], v[196:199]
  ds_read_b64_tr_b16 v[54:55], v4 offset:1024
  v_mfma_f32_16x16x32_bf16 v[196:199], v[140:143], v[100:103], v[196:199]
  ds_read_b64_tr_b16 v[56:57], v3 offset:2048
  v_mfma_f32_16x16x32_bf16 v[200:203], v[128:131], v[104:107], v[200:203]
  ds_read_b64_tr_b16 v[58:59], v4 offset:2048
  v_mfma_f32_16x16x32_bf16 v[200:203], v[132:135], v[108:111], v[200:203]
  v_mfma_f32_16x16x32_bf16 v[200:203], v[136:139], v[112:115], v[200:203]
  v_mfma_f32_16x16x32_bf16 v[204:207], v[148:151], v[112:115], v[204:207]
  v_mfma_f32_16x16x32_bf16 v[204:207], v[144:147], v[108:111], v[204:207]
  v_mfma_f32_16x16x32_bf16 v[204:207], v[140:143], v[104:107], v[204:207]
  v_mfma_f32_16x16x32_bf16 v[208:211], v[128:131], v[108:111], v[208:211]
  v_mfma_f32_16x16x32_bf16 v[208:211], v[132:135], v[112:115], v[208:211]
  v_mfma_f32_16x16x32_bf16 v[212:215], v[144:147], v[112:115], v[212:215]
  v_mfma_f32_16x16x32_bf16 v[212:215], v[140:143], v[108:111], v[212:215]
  v_mfma_f32_16x16x32_bf16 v[216:219], v[116:119], v[104:107], v[216:219]
  v_mfma_f32_16x16x32_bf16 v[216:219], v[120:123], v[108:111], v[216:219]
  v_mfma_f32_16x16x32_bf16 v[216:219], v[124:127], v[112:115], v[216:219]
  v_mfma_f32_16x16x32_bf16 v[220:223], v[120:123], v[112:115], v[220:223]
  v_mfma_f32_16x16x32_bf16 v[220:223], v[116:119], v[108:111], v[220:223]
  s_waitcnt lgkmcnt(0)
  v_mfma_f32_16x16x32_bf16 v[152:155], v[64:67], v[16:19], v[152:155]
  s_barrier
  ds_read_b64_tr_b16 v[132:133], v6 offset:31968
  v_mfma_f32_16x16x32_bf16 v[152:155], v[68:71], v[20:23], v[152:155]
  ds_read_b64_tr_b16 v[134:135], v6 offset:32480
  v_mfma_f32_16x16x32_bf16 v[156:159], v[80:83], v[20:23], v[156:159]
  ds_read_b128 v[84:87], v1 offset:0
  v_mfma_f32_16x16x32_bf16 v[156:159], v[76:79], v[16:19], v[156:159]
  v_mfma_f32_16x16x32_bf16 v[160:163], v[60:63], v[16:19], v[160:163]
  ds_read_b64_tr_b16 v[136:137], v6 offset:36096
  v_mfma_f32_16x16x32_bf16 v[160:163], v[64:67], v[20:23], v[160:163]
  ds_read_b64_tr_b16 v[138:139], v6 offset:36608
  v_mfma_f32_16x16x32_bf16 v[160:163], v[68:71], v[24:27], v[160:163]
  ds_read_b128 v[88:91], v1 offset:2048
  v_mfma_f32_16x16x32_bf16 v[164:167], v[80:83], v[24:27], v[164:167]
  v_mfma_f32_16x16x32_bf16 v[164:167], v[76:79], v[20:23], v[164:167]
  ds_read_b64_tr_b16 v[148:149], v7 offset:36096
  v_mfma_f32_16x16x32_bf16 v[164:167], v[72:75], v[16:19], v[164:167]
  ds_read_b64_tr_b16 v[150:151], v7 offset:36608
  v_mfma_f32_16x16x32_bf16 v[168:171], v[60:63], v[20:23], v[168:171]
  ds_read_b64_tr_b16 v[144:145], v7 offset:31968
  v_mfma_f32_16x16x32_bf16 v[168:171], v[64:67], v[24:27], v[168:171]
  ds_read_b64_tr_b16 v[146:147], v7 offset:32480
  v_mfma_f32_16x16x32_bf16 v[168:171], v[68:71], v[28:31], v[168:171]
  ds_read_b64_tr_b16 v[128:129], v6 offset:27840
  v_mfma_f32_16x16x32_bf16 v[172:175], v[80:83], v[28:31], v[172:175]
  ds_read_b64_tr_b16 v[130:131], v6 offset:28352
  v_mfma_f32_16x16x32_bf16 v[172:175], v[76:79], v[24:27], v[172:175]
  ds_read_b128 v[92:95], v1 offset:4096
  v_mfma_f32_16x16x32_bf16 v[172:175], v[72:75], v[20:23], v[172:175]
  v_mfma_f32_16x16x32_bf16 v[176:179], v[60:63], v[24:27], v[176:179]
  ds_read_b64_tr_b16 v[140:141], v7 offset:27840
  v_mfma_f32_16x16x32_bf16 v[176:179], v[64:67], v[28:31], v[176:179]
  ds_read_b64_tr_b16 v[142:143], v7 offset:28352
  v_mfma_f32_16x16x32_bf16 v[176:179], v[68:71], v[32:35], v[176:179]
  v_mfma_f32_16x16x32_bf16 v[180:183], v[80:83], v[32:35], v[180:183]
  ds_read_b128 v[96:99], v1 offset:6144
  v_mfma_f32_16x16x32_bf16 v[180:183], v[76:79], v[28:31], v[180:183]
  v_mfma_f32_16x16x32_bf16 v[180:183], v[72:75], v[24:27], v[180:183]
  ds_read_b128 v[100:103], v1 offset:8192
  v_mfma_f32_16x16x32_bf16 v[184:187], v[60:63], v[28:31], v[184:187]
  v_mfma_f32_16x16x32_bf16 v[184:187], v[64:67], v[32:35], v[184:187]
  ds_read_b128 v[104:107], v1 offset:10240
  v_mfma_f32_16x16x32_bf16 v[184:187], v[68:71], v[36:39], v[184:187]
  v_mfma_f32_16x16x32_bf16 v[188:191], v[80:83], v[36:39], v[188:191]
  ds_read_b128 v[108:111], v1 offset:12288
  v_mfma_f32_16x16x32_bf16 v[188:191], v[76:79], v[32:35], v[188:191]
  v_mfma_f32_16x16x32_bf16 v[188:191], v[72:75], v[28:31], v[188:191]
  ds_read_b128 v[112:115], v1 offset:14336
  v_mfma_f32_16x16x32_bf16 v[192:195], v[60:63], v[32:35], v[192:195]
  v_mfma_f32_16x16x32_bf16 v[192:195], v[64:67], v[36:39], v[192:195]
  ds_read_b64_tr_b16 v[116:117], v3 offset:27840
  v_mfma_f32_16x16x32_bf16 v[192:195], v[68:71], v[40:43], v[192:195]
  ds_read_b64_tr_b16 v[118:119], v4 offset:27840
  v_mfma_f32_16x16x32_bf16 v[196:199], v[80:83], v[40:43], v[196:199]
  ds_read_b64_tr_b16 v[120:121], v3 offset:28864
  v_mfma_f32_16x16x32_bf16 v[196:199], v[76:79], v[36:39], v[196:199]
  ds_read_b64_tr_b16 v[122:123], v4 offset:28864
  v_mfma_f32_16x16x32_bf16 v[196:199], v[72:75], v[32:35], v[196:199]
  ds_read_b64_tr_b16 v[124:125], v3 offset:29888
  v_mfma_f32_16x16x32_bf16 v[200:203], v[60:63], v[36:39], v[200:203]
  ds_read_b64_tr_b16 v[126:127], v4 offset:29888
  v_mfma_f32_16x16x32_bf16 v[200:203], v[64:67], v[40:43], v[200:203]
  v_mfma_f32_16x16x32_bf16 v[200:203], v[68:71], v[44:47], v[200:203]
  v_mfma_f32_16x16x32_bf16 v[204:207], v[80:83], v[44:47], v[204:207]
  v_add_u32 v2, s51, v2
  v_add_u32 v1, s51, v1
  v_mfma_f32_16x16x32_bf16 v[204:207], v[76:79], v[40:43], v[204:207]
  v_add_u32 v6, s52, v6
  v_add_u32 v7, s52, v7
  v_mfma_f32_16x16x32_bf16 v[204:207], v[72:75], v[36:39], v[204:207]
  v_add_u32 v3, s52, v3
  v_add_u32 v4, s52, v4
  v_mfma_f32_16x16x32_bf16 v[208:211], v[60:63], v[40:43], v[208:211]
  s_cmp_eq_u32 s54, 2
  s_cselect_b32 s51, 4294934528, s55
  v_mfma_f32_16x16x32_bf16 v[208:211], v[64:67], v[44:47], v[208:211]
  s_cselect_b32 s54, -1, s54
  s_add_u32 s54, s54, 1
  v_mfma_f32_16x16x32_bf16 v[212:215], v[76:79], v[44:47], v[212:215]
  s_sub_u32 s52, 0, s52
  s_sub_u32 s53, s53, 1
  v_mfma_f32_16x16x32_bf16 v[212:215], v[72:75], v[40:43], v[212:215]
  s_cmp_lg_u32 s53, 0
  v_mfma_f32_16x16x32_bf16 v[216:219], v[48:51], v[36:39], v[216:219]
  v_mfma_f32_16x16x32_bf16 v[216:219], v[52:55], v[40:43], v[216:219]
  v_mfma_f32_16x16x32_bf16 v[216:219], v[56:59], v[44:47], v[216:219]
  v_mfma_f32_16x16x32_bf16 v[220:223], v[52:55], v[44:47], v[220:223]
  v_mfma_f32_16x16x32_bf16 v[220:223], v[48:51], v[40:43], v[220:223]
  s_cbranch_scc1 L_sp3_loop
  s_waitcnt vmcnt(0) lgkmcnt(0)
  v_mfma_f32_16x16x32_bf16 v[152:155], v[132:135], v[84:87], v[152:155]
  s_barrier
  v_mfma_f32_16x16x32_bf16 v[152:155], v[136:139], v[88:91], v[152:155]
  v_mfma_f32_16x16x32_bf16 v[156:159], v[148:151], v[88:91], v[156:159]
  v_mfma_f32_16x16x32_bf16 v[156:159], v[144:147], v[84:87], v[156:159]
  v_mfma_f32_16x16x32_bf16 v[160:163], v[128:131], v[84:87], v[160:163]
  v_mfma_f32_16x16x32_bf16 v[160:163], v[132:135], v[88:91], v[160:163]
  v_mfma_f32_16x16x32_bf16 v[160:163], v[136:139], v[92:95], v[160:163]
  v_mfma_f32_16x16x32_bf16 v[164:167], v[148:151], v[92:95], v[164:167]
  v_mfma_f32_16x16x32_bf16 v[164:167], v[144:147], v[88:91], v[164:167]
  v_mfma_f32_16x16x32_bf16 v[164:167], v[140:143], v[84:87], v[164:167]
  v_mfma_f32_16x16x32_bf16 v[168:171], v[128:131], v[88:91], v[168:171]
  v_mfma_f32_16x16x32_bf16 v[168:171], v[132:135], v[92:95], v[168:171]
  v_mfma_f32_16x16x32_bf16 v[168:171], v[136:139], v[96:99], v[168:171]
  v_mfma_f32_16x16x32_bf16 v[172:175], v[148:151], v[96:99], v[172:175]
  v_mfma_f32_16x16x32_bf16 v[172:175], v[144:147], v[92:95], v[172:175]
  v_mfma_f32_16x16x32_bf16 v[172:175], v[140:143], v[88:91], v[172:175]
  v_mfma_f32_16x16x32_bf16 v[176:179], v[128:131], v[92:95], v[176:179]
  v_mfma_f32_16x16x32_bf16 v[176:179], v[132:135], v[96:99], v[176:179]
  v_mfma_f32_16x16x32_bf16 v[176:179], v[136:139], v[100:103], v[176:179]
  v_mfma_f32_16x16x32_bf16 v[180:183], v[148:151], v[100:103], v[180:183]
  v_mfma_f32_16x16x32_bf16 v[180:183], v[144:147], v[96:99], v[180:183]
  v_mfma_f32_16x16x32_bf16 v[180:183], v[140:143], v[92:95], v[180:183]
  v_mfma_f32_16x16x32_bf16 v[184:187], v[128:131], v[96:99], v[184:187]
  v_mfma_f32_16x16x32_bf16 v[184:187], v[132:135], v[100:103], v[184:187]
  ds_read_b64_tr_b16 v[16:17], v6 offset:4128
  v_mfma_f32_16x16x32_bf16 v[184:187], v[136:139], v[104:107], v[184:187]
  ds_read_b64_tr_b16 v[18:19], v6 offset:4640
  v_mfma_f32_16x16x32_bf16 v[188:191], v[148:151], v[104:107], v[188:191]
  s_barrier
  ds_read_b128 v[20:23], v2 offset:0
  v_mfma_f32_16x16x32_bf16 v[188:191], v[144:147], v[100:103], v[188:191]
  ds_read_b64_tr_b16 v[24:25], v6 offset:31968
  v_mfma_f32_16x16x32_bf16 v[188:191], v[140:143], v[96:99], v[188:191]
  ds_read_b64_tr_b16 v[26:27], v6 offset:32480
  v_mfma_f32_16x16x32_bf16 v[192:195], v[128:131], v[100:103], v[192:195]
  ds_read_b128 v[28:31], v1 offset:0
  v_mfma_f32_16x16x32_bf16 v[192:195], v[132:135], v[104:107], v[192:195]
  ds_read_b64_tr_b16 v[32:33], v6 offset:8256
  v_mfma_f32_16x16x32_bf16 v[192:195], v[136:139], v[108:111], v[192:195]
  ds_read_b64_tr_b16 v[34:35], v6 offset:8768
  v_mfma_f32_16x16x32_bf16 v[196:199], v[148:151], v[108:111], v[196:199]
  ds_read_b128 v[36:39], v2 offset:2048
  v_mfma_f32_16x16x32_bf16 v[196:199], v[144:147], v[104:107], v[196:199]
  ds_read_b64_tr_b16 v[40:41], v6 offset:36096
  v_mfma_f32_16x16x32_bf16 v[196:199], v[140:143], v[100:103], v[196:199]
  ds_read_b64_tr_b16 v[42:43], v6 offset:36608
  v_mfma_f32_16x16x32_bf16 v[200:203], v[128:131], v[104:107], v[200:203]
  ds_read_b128 v[44:47], v1 offset:2048
  v_mfma_f32_16x16x32_bf16 v[200:203], v[132:135], v[108:111], v[200:203]
  ds_read_b64_tr_b16 v[48:49], v7 offset:4128
  v_mfma_f32_16x16x32_bf16 v[200:203], v[136:139], v[112:115], v[200:203]
  ds_read_b64_tr_b16 v[50:51], v7 offset:4640
  v_mfma_f32_16x16x32_bf16 v[204:207], v[148:151], v[112:115], v[204:207]
  ds_read_b64_tr_b16 v[52:53], v7 offset:31968
  v_mfma_f32_16x16x32_bf16 v[204:207], v[144:147], v[108:111], v[204:207]
  ds_read_b64_tr_b16 v[54:55], v7 offset:32480
  v_mfma_f32_16x16x32_bf16 v[204:207], v[140:143], v[104:107], v[204:207]
  ds_read_b64_tr_b16 v[56:57], v7 offset:8256
  v_mfma_f32_16x16x32_bf16 v[208:211], v[128:131], v[108:111], v[208:211]
  ds_read_b64_tr_b16 v[58:59], v7 offset:8768
  v_mfma_f32_16x16x32_bf16 v[208:211], v[132:135], v[112:115], v[208:211]
  ds_read_b64_tr_b16 v[60:61], v7 offset:36096
  v_mfma_f32_16x16x32_bf16 v[212:215], v[144:147], v[112:115], v[212:215]
  ds_read_b64_tr_b16 v[62:63], v7 offset:36608
  v_mfma_f32_16x16x32_bf16 v[212:215], v[140:143], v[108:111], v[212:215]
  ds_read_b64_tr_b16 v[64:65], v6 offset:0
  v_mfma_f32_16x16x32_bf16 v[216:219], v[116:119], v[104:107], v[216:219]
  ds_read_b64_tr_b16 v[66:67], v6 offset:512
  v_mfma_f32_16x16x32_bf16 v[216:219], v[120:123], v[108:111], v[216:219]
  ds_read_b64_tr_b16 v[68:69], v6 offset:27840
  v_mfma_f32_16x16x32_bf16 v[216:219], v[124:127], v[112:115], v[216:219]
  ds_read_b64_tr_b16 v[70:71], v6 offset:28352
  v_mfma_f32_16x16x32_bf16 v[220:223], v[120:123], v[112:115], v[220:223]
  ds_read_b128 v[72:75], v2 offset:4096
  v_mfma_f32_16x16x32_bf16 v[220:223], v[116:119], v[108:111], v[220:223]
  ds_read_b128 v[76:79], v1 offset:4096
  s_waitcnt lgkmcnt(10)
  v_mfma_f32_16x16x32_bf16 v[152:155], v[16:19], v[20:23], v[152:155]
  ds_read_b64_tr_b16 v[80:81], v7 offset:0
  v_mfma_f32_16x16x32_bf16 v[152:155], v[24:27], v[28:31], v[152:155]
  ds_read_b64_tr_b16 v[82:83], v7 offset:512
  v_mfma_f32_16x16x32_bf16 v[152:155], v[32:35], v[36:39], v[152:155]
  ds_read_b64_tr_b16 v[240:241], v7 offset:27840
  v_mfma_f32_16x16x32_bf16 v[152:155], v[40:43], v[44:47], v[152:155]
  ds_read_b64_tr_b16 v[242:243], v7 offset:28352
  v_mfma_f32_16x16x32_bf16 v[156:159], v[48:51], v[20:23], v[156:159]
  ds_read_b128 v[224:227], v10 offset:0
  v_mfma_f32_16x16x32_bf16 v[156:159], v[52:55], v[28:31], v[156:159]
  ds_read_b128 v[232:235], v10 offset:256
  s_waitcnt lgkmcnt(10)
  v_mfma_f32_16x16x32_bf16 v[156:159], v[56:59], v[36:39], v[156:159]
  ds_read_b128 v[228:231], v10 offset:16
  v_mfma_f32_16x16x32_bf16 v[156:159], v[60:63], v[44:47], v[156:159]
  ds_read_b128 v[236:239], v10 offset:272
  v_mfma_f32_16x16x32_bf16 v[160:163], v[64:67], v[20:23], v[160:163]
  ds_read_b128 v[244:247], v2 offset:6144
  s_waitcnt lgkmcnt(10)
  v_mfma_f32_16x16x32_bf16 v[160:163], v[68:71], v[28:31], v[160:163]
  ds_read_b128 v[84:87], v1 offset:6144
  v_mfma_f32_16x16x32_bf16 v[160:163], v[16:19], v[36:39], v[160:163]
  ds_read_b128 v[88:91], v2 offset:8192
  v_mfma_f32_16x16x32_bf16 v[160:163], v[24:27], v[44:47], v[160:163]
  ds_read_b128 v[92:95], v1 offset:8192
  v_mfma_f32_16x16x32_bf16 v[160:163], v[32:35], v[72:75], v[160:163]
  s_waitcnt lgkmcnt(9)
  v_mfma_f32_16x16x32_bf16 v[160:163], v[40:43], v[76:79], v[160:163]
  v_mfma_f32_16x16x32_bf16 v[164:167], v[80:83], v[20:23], v[164:167]
  s_waitcnt lgkmcnt(7)
  v_mfma_f32_16x16x32_bf16 v[164:167], v[240:243], v[28:31], v[164:167]
  v_mfma_f32_16x16x32_bf16 v[164:167], v[48:51], v[36:39], v[164:167]
  v_mfma_f32_16x16x32_bf16 v[164:167], v[52:55], v[44:47], v[164:167]
  v_mfma_f32_16x16x32_bf16 v[164:167], v[56:59], v[72:75], v[164:167]
  v_mfma_f32_16x16x32_bf16 v[164:167], v[60:63], v[76:79], v[164:167]
  v_mfma_f32_16x16x32_bf16 v[168:171], v[64:67], v[36:39], v[168:171]
  v_mfma_f32_16x16x32_bf16 v[168:171], v[68:71], v[44:47], v[168:171]
  s_barrier
  v_subrev_u32 v6, 55680, v6
  v_mfma_f32_16x16x32_bf16 v[168:171], v[16:19], v[72:75], v[168:171]
  s_barrier
  v_subrev_u32 v7, 55680, v7
  v_mfma_f32_16x16x32_bf16 v[168:171], v[24:27], v[76:79], v[168:171]
  ds_read_b64_tr_b16 v[96:97], v6 offset:4128
  s_waitcnt lgkmcnt(1)
  v_mfma_f32_16x16x32_bf16 v[168:171], v[32:35], v[244:247], v[168:171]
  ds_read_b64_tr_b16 v[98:99], v6 offset:4640
  v_mfma_f32_16x16x32_bf16 v[168:171], v[40:43], v[84:87], v[168:171]
  ds_read_b128 v[100:103], v2 offset:16384
  v_mfma_f32_16x16x32_bf16 v[172:175], v[80:83], v[36:39], v[172:175]
  ds_read_b64_tr_b16 v[136:137], v6 offset:31968
  v_mfma_f32_16x16x32_bf16 v[172:175], v[240:243], v[44:47], v[172:175]
  ds_read_b64_tr_b16 v[138:139], v6 offset:32480
  v_mfma_f32_16x16x32_bf16 v[172:175], v[48:51], v[72:75], v[172:175]
  ds_read_b128 v[148:151], v1 offset:16384
  v_mfma_f32_16x16x32_bf16 v[172:175], v[52:55], v[76:79], v[172:175]
  ds_read_b64_tr_b16 v[128:129], v6 offset:8256
  v_mfma_f32_16x16x32_bf16 v[172:175], v[56:59], v[244:247], v[172:175]
  ds_read_b64_tr_b16 v[130:131], v6 offset:8768
  v_mfma_f32_16x16x32_bf16 v[172:175], v[60:63], v[84:87], v[172:175]
L_t_sp3_0:
  s_cbranch_scc1 L_r_sp3_0
  ds_read_b128 v[132:135], v2 offset:18432
  v_mfma_f32_16x16x32_bf16 v[176:179], v[64:67], v[72:75], v[176:179]
  ds_read_b64_tr_b16 v[144:145], v6 offset:36096
  v_mfma_f32_16x16x32_bf16 v[176:179], v[68:71], v[76:79], v[176:179]
  ds_read_b64_tr_b16 v[146:147], v6 offset:36608
  v_mfma_f32_16x16x32_bf16 v[176:179], v[16:19], v[244:247], v[176:179]
  ds_read_b128 v[140:143], v1 offset:18432
  v_mfma_f32_16x16x32_bf16 v[176:179], v[24:27], v[84:87], v[176:179]
  ds_read_b64_tr_b16 v[104:105], v7 offset:4128
  v_mfma_f32_16x16x32_bf16 v[176:179], v[32:35], v[88:91], v[176:179]
  ds_read_b64_tr_b16 v[106:107], v7 offset:4640
  v_mfma_f32_16x16x32_bf16 v[176:179], v[40:43], v[92:95], v[176:179]
  ds_read_b64_tr_b16 v[124:125], v7 offset:31968
  v_mfma_f32_16x16x32_bf16 v[180:183], v[80:83], v[72:75], v[180:183]
  ds_read_b64_tr_b16 v[126:127], v7 offset:32480
  v_mfma_f32_16x16x32_bf16 v[180:183], v[240:243], v[76:79], v[180:183]
  ds_read_b64_tr_b16 v[120:121], v7 offset:8256
  v_mfma_f32_16x16x32_bf16 v[180:183], v[48:51], v[244:247], v[180:183]
  ds_read_b64_tr_b16 v[122:123], v7 offset:8768
  v_mfma_f32_16x16x32_bf16 v[180:183], v[52:55], v[84:87], v[180:183]
  ds_read_b64_tr_b16 v[112:113], v7 offset:36096
  ds_read_b64_tr_b16 v[114:115], v7 offset:36608
  v_mfma_f32_16x16x32_bf16 v[180:183], v[56:59], v[88:91], v[180:183]
  ds_read_b128 v[116:119], v2 offset:10240
  v_mfma_f32_16x16x32_bf16 v[180:183], v[60:63], v[92:95], v[180:183]
  ds_read_b128 v[108:111], v1 offset:10240
  s_waitcnt lgkmcnt(11)
  v_mfma_f32_16x16x32_bf16 v[152:155], v[96:99], v[100:103], v[152:155]
  ds_read_b64_tr_b16 v[20:21], v6 offset:0
  v_mfma_f32_16x16x32_bf16 v[152:155], v[136:139], v[148:151], v[152:155]
  ds_read_b64_tr_b16 v[22:23], v6 offset:512
  v_mfma_f32_16x16x32_bf16 v[152:155], v[128:131], v[132:135], v[152:155]
  ds_read_b64_tr_b16 v[28:29], v6 offset:27840
  s_waitcnt lgkmcnt(11)
  v_mfma_f32_16x16x32_bf16 v[152:155], v[144:147], v[140:143], v[152:155]
  ds_read_b64_tr_b16 v[30:31], v6 offset:28352
  v_mfma_f32_16x16x32_bf16 v[156:159], v[104:107], v[100:103], v[156:159]
  ds_read_b128 v[36:39], v2 offset:20480
  s_waitcnt lgkmcnt(11)
  v_mfma_f32_16x16x32_bf16 v[156:159], v[124:127], v[148:151], v[156:159]
  ds_read_b128 v[44:47], v1 offset:20480
  s_waitcnt lgkmcnt(10)
  v_mfma_f32_16x16x32_bf16 v[156:159], v[120:123], v[132:135], v[156:159]
  ds_read_b64_tr_b16 v[72:73], v7 offset:0
  s_waitcnt lgkmcnt(9)
  v_mfma_f32_16x16x32_bf16 v[156:159], v[112:115], v[140:143], v[156:159]
  ds_read_b64_tr_b16 v[74:75], v7 offset:512
  v_mfma_f32_16x16x32_bf16 v[184:187], v[64:67], v[244:247], v[184:187]
  ds_read_b64_tr_b16 v[76:77], v7 offset:27840
  v_mfma_f32_16x16x32_bf16 v[184:187], v[68:71], v[84:87], v[184:187]
  ds_read_b64_tr_b16 v[78:79], v7 offset:28352
  v_mfma_f32_16x16x32_bf16 v[184:187], v[16:19], v[88:91], v[184:187]
  v_mfma_f32_16x16x32_bf16 v[184:187], v[24:27], v[92:95], v[184:187]
  s_waitcnt lgkmcnt(8)
  v_mfma_f32_16x16x32_bf16 v[184:187], v[32:35], v[116:119], v[184:187]
  v_fma_f32 v152, v152, v224, v232
  v_fma_f32 v153, v153, v225, v233
  v_mfma_f32_16x16x32_bf16 v[184:187], v[40:43], v[108:111], v[184:187]
  v_fma_f32 v154, v154, v226, v234
  v_fma_f32 v155, v155, v227, v235
  v_mfma_f32_16x16x32_bf16 v[188:191], v[80:83], v[244:247], v[188:191]
  ds_read_b128 v[244:247], v2 offset:12288
  v_exp_f32 v248, v152
  v_mfma_f32_16x16x32_bf16 v[188:191], v[240:243], v[84:87], v[188:191]
  ds_read_b128 v[84:87], v1 offset:12288
  v_exp_f32 v249, v153
  v_mfma_f32_16x16x32_bf16 v[188:191], v[48:51], v[88:91], v[188:191]
  v_exp_f32 v250, v154
  v_mfma_f32_16x16x32_bf16 v[188:191], v[52:55], v[92:95], v[188:191]
  v_exp_f32 v251, v155
  v_mfma_f32_16x16x32_bf16 v[188:191], v[56:59], v[116:119], v[188:191]
  v_fma_f32 v156, v156, v228, v236
  v_fma_f32 v157, v157, v229, v237
  v_mfma_f32_16x16x32_bf16 v[188:191], v[60:63], v[108:111], v[188:191]
  v_fma_f32 v158, v158, v230, v238
  v_fma_f32 v159, v159, v231, v239
  v_mfma_f32_16x16x32_bf16 v[160:163], v[20:23], v[100:103], v[160:163]
  v_exp_f32 v252, v156
  s_waitcnt lgkmcnt(2)
  v_mfma_f32_16x16x32_bf16 v[160:163], v[28:31], v[148:151], v[160:163]
  v_exp_f32 v253, v157
  v_mfma_f32_16x16x32_bf16 v[160:163], v[96:99], v[132:135], v[160:163]
  v_exp_f32 v254, v158
  v_mfma_f32_16x16x32_bf16 v[160:163], v[136:139], v[140:143], v[160:163]
  v_exp_f32 v255, v159
  v_mfma_f32_16x16x32_bf16 v[160:163], v[128:131], v[36:39], v[160:163]
  v_fma_f32 v248, v248, s56, s56
  v_fma_f32 v249, v249, s56, s56
  v_mfma_f32_16x16x32_bf16 v[160:163], v[144:147], v[44:47], v[160:163]
  v_fma_f32 v250, v250, s56, s56
  v_fma_f32 v251, v251, s56, s56
  v_mfma_f32_16x16x32_bf16 v[164:167], v[72:75], v[100:103], v[164:167]
  ds_read_b128 v[100:103], v2 offset:22528
  v_rcp_f32 v248, v248
  v_mfma_f32_16x16x32_bf16 v[164:167], v[76:79], v[148:151], v[164:167]
  ds_read_b128 v[148:151], v1 offset:22528
  v_rcp_f32 v249, v249
  v_mfma_f32_16x16x32_bf16 v[164:167], v[104:107], v[132:135], v[164:167]
  v_rcp_f32 v250, v250
  v_mfma_f32_16x16x32_bf16 v[164:167], v[124:127], v[140:143], v[164:167]
  v_rcp_f32 v251, v251
  v_mfma_f32_16x16x32_bf16 v[164:167], v[120:123], v[36:39], v[164:167]
  v_fma_f32 v252, v252, s56, s56
  v_fma_f32 v253, v253, s56, s56
  v_mfma_f32_16x16x32_bf16 v[164:167], v[112:115], v[44:47], v[164:167]
  v_fma_f32 v254, v254, s56, s56
  v_fma_f32 v255, v255, s56, s56
  v_mfma_f32_16x16x32_bf16 v[192:195], v[64:67], v[88:91], v[192:195]
  v_rcp_f32 v252, v252
  v_mfma_f32_16x16x32_bf16 v[192:195], v[68:71], v[92:95], v[192:195]
  v_rcp_f32 v253, v253
  v_mfma_f32_16x16x32_bf16 v[192:195], v[16:19], v[116:119], v[192:195]
  v_rcp_f32 v254, v254
  v_mfma_f32_16x16x32_bf16 v[192:195], v[24:27], v[108:111], v[192:195]
  v_rcp_f32 v255, v255
  s_waitcnt lgkmcnt(2)
  v_mfma_f32_16x16x32_bf16 v[192:195], v[32:35], v[244:247], v[192:195]
  v_mul_f32 v152, v152, v248
  v_mul_f32 v153, v153, v249
  v_mfma_f32_16x16x32_bf16 v[192:195], v[40:43], v[84:87], v[192:195]
  v_mul_f32 v154, v154, v250
  v_mul_f32 v155, v155, v251
  v_mfma_f32_16x16x32_bf16 v[196:199], v[80:83], v[88:91], v[196:199]
  ds_read_b128 v[88:91], v2 offset:14336
  v_cvt_pk_bf16_f32 v12, v152, v153
  v_mfma_f32_16x16x32_bf16 v[196:199], v[240:243], v[92:95], v[196:199]
  ds_read_b128 v[92:95], v1 offset:14336
  v_cvt_pk_bf16_f32 v13, v154, v155
  v_mfma_f32_16x16x32_bf16 v[196:199], v[48:51], v[116:119], v[196:199]
  v_mul_f32 v156, v156, v252
  v_mul_f32 v157, v157, v253
  v_mfma_f32_16x16x32_bf16 v[196:199], v[52:55], v[108:111], v[196:199]
  v_mul_f32 v158, v158, v254
  v_mul_f32 v159, v159, v255
  v_mfma_f32_16x16x32_bf16 v[196:199], v[56:59], v[244:247], v[196:199]
  v_cvt_pk_bf16_f32 v14, v156, v157
  v_cvt_pk_bf16_f32 v15, v158, v159
  v_mfma_f32_16x16x32_bf16 v[196:199], v[60:63], v[84:87], v[196:199]
  buffer_store_dwordx4 v[12:15], v8, s[28:31], s48 offen offset:0 sc1
  v_fma_f32 v160, v160, v224, v232
  v_mfma_f32_16x16x32_bf16 v[168:171], v[20:23], v[132:135], v[168:171]
  v_fma_f32 v161, v161, v225, v233
  v_fma_f32 v162, v162, v226, v234
  v_mfma_f32_16x16x32_bf16 v[168:171], v[28:31], v[140:143], v[168:171]
  v_fma_f32 v163, v163, v227, v235
  v_exp_f32 v248, v160
  v_mfma_f32_16x16x32_bf16 v[168:171], v[96:99], v[36:39], v[168:171]
  ds_read_b128 v[156:159], v2 offset:24576
  v_exp_f32 v249, v161
  v_mfma_f32_16x16x32_bf16 v[168:171], v[136:139], v[44:47], v[168:171]
  v_exp_f32 v250, v162
  s_waitcnt lgkmcnt(3)
  v_mfma_f32_16x16x32_bf16 v[168:171], v[128:131], v[100:103], v[168:171]
  v_exp_f32 v251, v163
  v_mfma_f32_16x16x32_bf16 v[168:171], v[144:147], v[148:151], v[168:171]
  v_fma_f32 v164, v164, v228, v236
  v_fma_f32 v165, v165, v229, v237
  v_mfma_f32_16x16x32_bf16 v[172:175], v[72:75], v[132:135], v[172:175]
  ds_read_b128 v[132:135], v1 offset:24576
  v_fma_f32 v166, v166, v230, v238
  v_mfma_f32_16x16x32_bf16 v[172:175], v[76:79], v[140:143], v[172:175]
  v_fma_f32 v167, v167, v231, v239
  v_exp_f32 v252, v164
  v_mfma_f32_16x16x32_bf16 v[172:175], v[104:107], v[36:39], v[172:175]
  v_exp_f32 v253, v165
  v_mfma_f32_16x16x32_bf16 v[172:175], v[124:127], v[44:47], v[172:175]
  v_exp_f32 v254, v166
  v_mfma_f32_16x16x32_bf16 v[172:175], v[120:123], v[100:103], v[172:175]
  v_exp_f32 v255, v167
  v_mfma_f32_16x16x32_bf16 v[172:175], v[112:115], v[148:151], v[172:175]
  v_fma_f32 v248, v248, s56, s56
  v_fma_f32 v249, v249, s56, s56
  v_mfma_f32_16x16x32_bf16 v[200:203], v[64:67], v[116:119], v[200:203]
  v_fma_f32 v250, v250, s56, s56
  v_fma_f32 v251, v251, s56, s56
  v_mfma_f32_16x16x32_bf16 v[200:203], v[68:71], v[108:111], v[200:203]
  v_rcp_f32 v248, v248
  v_mfma_f32_16x16x32_bf16 v[200:203], v[16:19], v[244:247], v[200:203]
  v_rcp_f32 v249, v249
  v_mfma_f32_16x16x32_bf16 v[200:203], v[24:27], v[84:87], v[200:203]
  v_rcp_f32 v250, v250
  s_waitcnt lgkmcnt(1)
  v_mfma_f32_16x16x32_bf16 v[200:203], v[32:35], v[88:91], v[200:203]
  v_rcp_f32 v251, v251
  v_mfma_f32_16x16x32_bf16 v[200:203], v[40:43], v[92:95], v[200:203]
  v_fma_f32 v252, v252, s56, s56
  v_fma_f32 v253, v253, s56, s56
  v_mfma_f32_16x16x32_bf16 v[204:207], v[80:83], v[116:119], v[204:207]
  v_fma_f32 v254, v254, s56, s56
  v_fma_f32 v255, v255, s56, s56
  v_mfma_f32_16x16x32_bf16 v[204:207], v[240:243], v[108:111], v[204:207]
  v_rcp_f32 v252, v252
  v_mfma_f32_16x16x32_bf16 v[204:207], v[48:51], v[244:247], v[204:207]
  v_rcp_f32 v253, v253
  v_mfma_f32_16x16x32_bf16 v[204:207], v[52:55], v[84:87], v[204:207]
  v_rcp_f32 v254, v254
  v_mfma_f32_16x16x32_bf16 v[204:207], v[56:59], v[88:91], v[204:207]
  ds_read_b128 v[140:143], v2 offset:26624
  v_rcp_f32 v255, v255
  v_mfma_f32_16x16x32_bf16 v[204:207], v[60:63], v[92:95], v[204:207]
  ds_read_b128 v[32:35], v1 offset:26624
  v_mul_f32 v160, v160, v248
  v_mfma_f32_16x16x32_bf16 v[176:179], v[20:23], v[36:39], v[176:179]
  v_mul_f32 v161, v161, v249
  v_mul_f32 v162, v162, v250
  v_mfma_f32_16x16x32_bf16 v[176:179], v[28:31], v[44:47], v[176:179]
  v_mul_f32 v163, v163, v251
  v_cvt_pk_bf16_f32 v152, v160, v161
  v_mfma_f32_16x16x32_bf16 v[176:179], v[96:99], v[100:103], v[176:179]
  v_cvt_pk_bf16_f32 v153, v162, v163
  v_mul_f32 v164, v164, v252
  v_mfma_f32_16x16x32_bf16 v[176:179], v[136:139], v[148:151], v[176:179]
  v_mul_f32 v165, v165, v253
  v_mul_f32 v166, v166, v254
  v_mfma_f32_16x16x32_bf16 v[176:179], v[128:131], v[156:159], v[176:179]
  v_mul_f32 v167, v167, v255
  v_cvt_pk_bf16_f32 v154, v164, v165
  s_waitcnt lgkmcnt(2)
  v_mfma_f32_16x16x32_bf16 v[176:179], v[144:147], v[132:135], v[176:179]
  v_cvt_pk_bf16_f32 v155, v166, v167
  buffer_store_dwordx4 v[152:155], v8, s[28:31], s48 offen offset:1152 sc1
  v_mfma_f32_16x16x32_bf16 v[180:183], v[72:75], v[36:39], v[180:183]
  ds_read_b64_tr_b16 v[40:41], v3 offset:0
  v_fma_f32 v168, v168, v224, v232
  v_mfma_f32_16x16x32_bf16 v[180:183], v[76:79], v[44:47], v[180:183]
  ds_read_b64_tr_b16 v[42:43], v4 offset:0
  v_fma_f32 v169, v169, v225, v233
  v_mfma_f32_16x16x32_bf16 v[180:183], v[104:107], v[100:103], v[180:183]
  ds_read_b128 v[116:119], v2 offset:10240
  v_fma_f32 v170, v170, v226, v234
  v_mfma_f32_16x16x32_bf16 v[180:183], v[124:127], v[148:151], v[180:183]
  ds_read_b64_tr_b16 v[108:109], v3 offset:27840
  v_fma_f32 v171, v171, v227, v235
  v_mfma_f32_16x16x32_bf16 v[180:183], v[120:123], v[156:159], v[180:183]
  ds_read_b64_tr_b16 v[110:111], v4 offset:27840
  v_exp_f32 v248, v168
  v_mfma_f32_16x16x32_bf16 v[180:183], v[112:115], v[132:135], v[180:183]
  ds_read_b128 v[56:59], v1 offset:10240
  v_exp_f32 v249, v169
  v_mfma_f32_16x16x32_bf16 v[208:211], v[64:67], v[244:247], v[208:211]
  ds_read_b64_tr_b16 v[60:61], v3 offset:1024
  v_exp_f32 v250, v170
  v_mfma_f32_16x16x32_bf16 v[208:211], v[68:71], v[84:87], v[208:211]
  ds_read_b64_tr_b16 v[62:63], v4 offset:1024
  v_exp_f32 v251, v171
  v_mfma_f32_16x16x32_bf16 v[208:211], v[16:19], v[88:91], v[208:211]
  ds_read_b128 v[164:167], v2 offset:12288
  v_fma_f32 v172, v172, v228, v236
  v_mfma_f32_16x16x32_bf16 v[208:211], v[24:27], v[92:95], v[208:211]
  ds_read_b64_tr_b16 v[36:37], v3 offset:28864
  v_fma_f32 v173, v173, v229, v237
  v_mfma_f32_16x16x32_bf16 v[212:215], v[80:83], v[244:247], v[212:215]
  ds_read_b64_tr_b16 v[38:39], v4 offset:28864
  v_fma_f32 v174, v174, v230, v238
  v_mfma_f32_16x16x32_bf16 v[212:215], v[240:243], v[84:87], v[212:215]
  ds_read_b128 v[44:47], v1 offset:12288
  v_fma_f32 v175, v175, v231, v239
  v_mfma_f32_16x16x32_bf16 v[212:215], v[48:51], v[88:91], v[212:215]
  ds_read_b64_tr_b16 v[152:153], v3 offset:2048
  v_exp_f32 v252, v172
  v_mfma_f32_16x16x32_bf16 v[212:215], v[52:55], v[92:95], v[212:215]
  ds_read_b64_tr_b16 v[154:155], v4 offset:2048
  v_exp_f32 v253, v173
  v_mfma_f32_16x16x32_bf16 v[184:187], v[20:23], v[100:103], v[184:187]
  ds_read_b128 v[64:67], v2 offset:14336
  v_exp_f32 v254, v174
  v_mfma_f32_16x16x32_bf16 v[184:187], v[28:31], v[148:151], v[184:187]
  ds_read_b64_tr_b16 v[68:69], v3 offset:29888
  v_exp_f32 v255, v175
  v_mfma_f32_16x16x32_bf16 v[184:187], v[96:99], v[156:159], v[184:187]
  ds_read_b64_tr_b16 v[70:71], v4 offset:29888
  v_fma_f32 v248, v248, s56, s56
  v_mfma_f32_16x16x32_bf16 v[184:187], v[136:139], v[132:135], v[184:187]
  ds_read_b128 v[16:19], v1 offset:14336
  v_fma_f32 v249, v249, s56, s56
  s_waitcnt lgkmcnt(10)
  v_mfma_f32_16x16x32_bf16 v[184:187], v[128:131], v[140:143], v[184:187]
  ds_read_b128 v[24:27], v2 offset:28672
  v_fma_f32 v250, v250, s56, s56
  v_mfma_f32_16x16x32_bf16 v[184:187], v[144:147], v[32:35], v[184:187]
  ds_read_b128 v[80:83], v1 offset:28672
  v_fma_f32 v251, v251, s56, s56
  v_mfma_f32_16x16x32_bf16 v[188:191], v[72:75], v[100:103], v[188:191]
  v_rcp_f32 v248, v248
  v_mfma_f32_16x16x32_bf16 v[188:191], v[76:79], v[148:151], v[188:191]
  v_rcp_f32 v249, v249
  v_mfma_f32_16x16x32_bf16 v[188:191], v[104:107], v[156:159], v[188:191]
  v_rcp_f32 v250, v250
  v_mfma_f32_16x16x32_bf16 v[188:191], v[124:127], v[132:135], v[188:191]
  v_rcp_f32 v251, v251
  v_mfma_f32_16x16x32_bf16 v[188:191], v[120:123], v[140:143], v[188:191]
  v_fma_f32 v252, v252, s56, s56
  v_fma_f32 v253, v253, s56, s56
  v_mfma_f32_16x16x32_bf16 v[188:191], v[112:115], v[32:35], v[188:191]
  v_fma_f32 v254, v254, s56, s56
  v_fma_f32 v255, v255, s56, s56
  v_mfma_f32_16x16x32_bf16 v[216:219], v[40:43], v[116:119], v[216:219]
  ds_read_b128 v[244:247], v2 offset:30720
  v_rcp_f32 v252, v252
  v_mfma_f32_16x16x32_bf16 v[216:219], v[108:111], v[56:59], v[216:219]
  ds_read_b128 v[240:243], v1 offset:30720
  v_rcp_f32 v253, v253
  s_waitcnt lgkmcnt(4)
  v_mfma_f32_16x16x32_bf16 v[216:219], v[60:63], v[164:167], v[216:219]
  v_rcp_f32 v254, v254
  v_mfma_f32_16x16x32_bf16 v[216:219], v[36:39], v[44:47], v[216:219]
  v_rcp_f32 v255, v255
  v_mfma_f32_16x16x32_bf16 v[216:219], v[152:155], v[64:67], v[216:219]
  v_mul_f32 v168, v168, v248
  v_mul_f32 v169, v169, v249
  v_mfma_f32_16x16x32_bf16 v[216:219], v[68:71], v[16:19], v[216:219]
  v_mul_f32 v170, v170, v250
  v_mul_f32 v171, v171, v251
  v_mfma_f32_16x16x32_bf16 v[220:223], v[40:43], v[164:167], v[220:223]
  v_cvt_pk_bf16_f32 v160, v168, v169
  v_cvt_pk_bf16_f32 v161, v170, v171
  v_mfma_f32_16x16x32_bf16 v[220:223], v[108:111], v[44:47], v[220:223]
  v_mul_f32 v172, v172, v252
  v_mul_f32 v173, v173, v253
  v_mfma_f32_16x16x32_bf16 v[220:223], v[60:63], v[64:67], v[220:223]
  v_mul_f32 v174, v174, v254
  v_mul_f32 v175, v175, v255
  v_mfma_f32_16x16x32_bf16 v[220:223], v[36:39], v[16:19], v[220:223]
  v_cvt_pk_bf16_f32 v162, v172, v173
  v_cvt_pk_bf16_f32 v163, v174, v175
  v_mfma_f32_16x16x32_bf16 v[192:195], v[20:23], v[156:159], v[192:195]
  buffer_store_dwordx4 v[160:163], v8, s[28:31], s48 offen offset:2304 sc1
  v_fma_f32 v176, v176, v224, v232
  v_mfma_f32_16x16x32_bf16 v[192:195], v[28:31], v[132:135], v[192:195]
  v_fma_f32 v177, v177, v225, v233
  v_fma_f32 v178, v178, v226, v234
  v_mfma_f32_16x16x32_bf16 v[192:195], v[96:99], v[140:143], v[192:195]
  v_fma_f32 v179, v179, v227, v235
  v_exp_f32 v248, v176
  v_mfma_f32_16x16x32_bf16 v[192:195], v[136:139], v[32:35], v[192:195]
  v_exp_f32 v249, v177
  s_waitcnt lgkmcnt(0)
  v_mfma_f32_16x16x32_bf16 v[192:195], v[128:131], v[24:27], v[192:195]
  v_exp_f32 v250, v178
  v_mfma_f32_16x16x32_bf16 v[192:195], v[144:147], v[80:83], v[192:195]
  v_exp_f32 v251, v179
  v_mfma_f32_16x16x32_bf16 v[196:199], v[72:75], v[156:159], v[196:199]
  v_subrev_u32 v3, 55680, v3
  v_fma_f32 v180, v180, v228, v236
  v_mfma_f32_16x16x32_bf16 v[196:199], v[76:79], v[132:135], v[196:199]
  v_subrev_u32 v4, 55680, v4
  v_fma_f32 v181, v181, v229, v237
  v_mfma_f32_16x16x32_bf16 v[196:199], v[104:107], v[140:143], v[196:199]
  ds_read_b64_tr_b16 v[84:85], v3 offset:0
  v_fma_f32 v182, v182, v230, v238
  v_mfma_f32_16x16x32_bf16 v[196:199], v[124:127], v[32:35], v[196:199]
  ds_read_b64_tr_b16 v[86:87], v4 offset:0
  v_fma_f32 v183, v183, v231, v239
  v_mfma_f32_16x16x32_bf16 v[196:199], v[120:123], v[24:27], v[196:199]
  ds_read_b128 v[48:51], v2 offset:26624
  v_exp_f32 v252, v180
  v_mfma_f32_16x16x32_bf16 v[196:199], v[112:115], v[80:83], v[196:199]
  ds_read_b64_tr_b16 v[88:89], v3 offset:27840
  v_exp_f32 v253, v181
  v_mfma_f32_16x16x32_bf16 v[200:203], v[20:23], v[140:143], v[200:203]
  ds_read_b64_tr_b16 v[90:91], v4 offset:27840
  v_exp_f32 v254, v182
  v_mfma_f32_16x16x32_bf16 v[200:203], v[28:31], v[32:35], v[200:203]
  ds_read_b128 v[52:55], v1 offset:26624
  v_exp_f32 v255, v183
  v_mfma_f32_16x16x32_bf16 v[200:203], v[96:99], v[24:27], v[200:203]
  ds_read_b64_tr_b16 v[92:93], v3 offset:1024
  v_fma_f32 v248, v248, s56, s56
  v_mfma_f32_16x16x32_bf16 v[200:203], v[136:139], v[80:83], v[200:203]
  ds_read_b64_tr_b16 v[94:95], v4 offset:1024
  v_fma_f32 v249, v249, s56, s56
  v_mfma_f32_16x16x32_bf16 v[200:203], v[128:131], v[244:247], v[200:203]
  ds_read_b128 v[100:103], v2 offset:28672
  v_fma_f32 v250, v250, s56, s56
  v_mfma_f32_16x16x32_bf16 v[200:203], v[144:147], v[240:243], v[200:203]
  ds_read_b64_tr_b16 v[148:149], v3 offset:28864
  v_fma_f32 v251, v251, s56, s56
  v_mfma_f32_16x16x32_bf16 v[204:207], v[72:75], v[140:143], v[204:207]
  ds_read_b64_tr_b16 v[150:151], v4 offset:28864
  v_rcp_f32 v248, v248
  v_mfma_f32_16x16x32_bf16 v[204:207], v[76:79], v[32:35], v[204:207]
  ds_read_b128 v[116:119], v1 offset:28672
  v_rcp_f32 v249, v249
  v_mfma_f32_16x16x32_bf16 v[204:207], v[104:107], v[24:27], v[204:207]
  ds_read_b64_tr_b16 v[56:57], v3 offset:2048
  v_rcp_f32 v250, v250
  v_mfma_f32_16x16x32_bf16 v[204:207], v[124:127], v[80:83], v[204:207]
  ds_read_b64_tr_b16 v[58:59], v4 offset:2048
  v_rcp_f32 v251, v251
  v_mfma_f32_16x16x32_bf16 v[204:207], v[120:123], v[244:247], v[204:207]
  ds_read_b128 v[152:155], v2 offset:30720
  v_fma_f32 v252, v252, s56, s56
  v_mfma_f32_16x16x32_bf16 v[204:207], v[112:115], v[240:243], v[204:207]
  ds_read_b64_tr_b16 v[68:69], v3 offset:29888
  v_fma_f32 v253, v253, s56, s56
  v_mfma_f32_16x16x32_bf16 v[208:211], v[20:23], v[24:27], v[208:211]
  ds_read_b64_tr_b16 v[70:71], v4 offset:29888
  v_fma_f32 v254, v254, s56, s56
  v_mfma_f32_16x16x32_bf16 v[208:211], v[28:31], v[80:83], v[208:211]
  ds_read_b128 v[40:43], v11 offset:0
  v_fma_f32 v255, v255, s56, s56
  v_mfma_f32_16x16x32_bf16 v[208:211], v[96:99], v[244:247], v[208:211]
  ds_read_b128 v[164:167], v11 offset:256
  v_rcp_f32 v252, v252
  v_mfma_f32_16x16x32_bf16 v[208:211], v[136:139], v[240:243], v[208:211]
  ds_read_b128 v[108:111], v1 offset:30720
  v_rcp_f32 v253, v253
  v_mfma_f32_16x16x32_bf16 v[212:215], v[72:75], v[24:27], v[212:215]
  v_rcp_f32 v254, v254
  v_mfma_f32_16x16x32_bf16 v[212:215], v[76:79], v[80:83], v[212:215]
  v_rcp_f32 v255, v255
  v_mfma_f32_16x16x32_bf16 v[212:215], v[104:107], v[244:247], v[212:215]
  v_mul_f32 v176, v176, v248
  v_mul_f32 v177, v177, v249
  v_mfma_f32_16x16x32_bf16 v[212:215], v[124:127], v[240:243], v[212:215]
  v_mul_f32 v178, v178, v250
  v_mul_f32 v179, v179, v251
  s_waitcnt lgkmcnt(6)
  v_mfma_f32_16x16x32_bf16 v[216:219], v[84:87], v[48:51], v[216:219]
  v_cvt_pk_bf16_f32 v168, v176, v177
  v_cvt_pk_bf16_f32 v169, v178, v179
  v_mfma_f32_16x16x32_bf16 v[216:219], v[88:91], v[52:55], v[216:219]
  v_mul_f32 v180, v180, v252
  v_mul_f32 v181, v181, v253
  v_mfma_f32_16x16x32_bf16 v[216:219], v[92:95], v[100:103], v[216:219]
  v_mul_f32 v182, v182, v254
  v_mul_f32 v183, v183, v255
  v_mfma_f32_16x16x32_bf16 v[216:219], v[148:151], v[116:119], v[216:219]
  v_cvt_pk_bf16_f32 v170, v180, v181
  v_cvt_pk_bf16_f32 v171, v182, v183
  s_waitcnt lgkmcnt(2)
  v_mfma_f32_16x16x32_bf16 v[216:219], v[56:59], v[152:155], v[216:219]
  buffer_store_dwordx4 v[168:171], v8, s[28:31], s48 offen offset:3456 sc1
  v_fma_f32 v184, v184, v224, v232
  s_waitcnt lgkmcnt(0)
  v_mfma_f32_16x16x32_bf16 v[216:219], v[68:71], v[108:111], v[216:219]
  v_fma_f32 v185, v185, v225, v233
  v_fma_f32 v186, v186, v226, v234
  v_mfma_f32_16x16x32_bf16 v[220:223], v[84:87], v[100:103], v[220:223]
  v_fma_f32 v187, v187, v227, v235
  v_exp_f32 v248, v184
  v_mfma_f32_16x16x32_bf16 v[220:223], v[88:91], v[116:119], v[220:223]
  v_exp_f32 v249, v185
  v_mfma_f32_16x16x32_bf16 v[220:223], v[92:95], v[152:155], v[220:223]
  v_exp_f32 v250, v186
  v_mfma_f32_16x16x32_bf16 v[220:223], v[148:151], v[108:111], v[220:223]
  v_exp_f32 v251, v187
  v_pk_fma_f32 v[188:189], v[188:189], v[228:229], v[236:237]
  v_pk_fma_f32 v[190:191], v[190:191], v[230:231], v[238:239]
  v_exp_f32 v252, v188
  v_exp_f32 v253, v189
  v_exp_f32 v254, v190
  v_exp_f32 v255, v191
  v_pk_fma_f32 v[248:249], v[248:249], s[56:57], s[56:57]
  v_pk_fma_f32 v[250:251], v[250:251], s[56:57], s[56:57]
  v_rcp_f32 v248, v248
  v_rcp_f32 v249, v249
  v_rcp_f32 v250, v250
  v_rcp_f32 v251, v251
  v_pk_fma_f32 v[252:253], v[252:253], s[56:57], s[56:57]
  v_pk_fma_f32 v[254:255], v[254:255], s[56:57], s[56:57]
  v_rcp_f32 v252, v252
  v_rcp_f32 v253, v253
  v_rcp_f32 v254, v254
  v_rcp_f32 v255, v255
  v_pk_mul_f32 v[184:185], v[184:185], v[248:249]
  v_pk_mul_f32 v[186:187], v[186:187], v[250:251]
  v_cvt_pk_bf16_f32 v176, v184, v185
  v_cvt_pk_bf16_f32 v177, v186, v187
  v_pk_mul_f32 v[188:189], v[188:189], v[252:253]
  v_pk_mul_f32 v[190:191], v[190:191], v[254:255]
  v_cvt_pk_bf16_f32 v178, v188, v189
  v_cvt_pk_bf16_f32 v179, v190, v191
  buffer_store_dwordx4 v[176:179], v8, s[28:31], s49 offen offset:0 sc1
  v_pk_fma_f32 v[192:193], v[192:193], v[224:225], v[232:233]
  v_pk_fma_f32 v[194:195], v[194:195], v[226:227], v[234:235]
  v_exp_f32 v248, v192
  v_exp_f32 v249, v193
  v_exp_f32 v250, v194
  v_exp_f32 v251, v195
  v_pk_fma_f32 v[196:197], v[196:197], v[228:229], v[236:237]
  v_pk_fma_f32 v[198:199], v[198:199], v[230:231], v[238:239]
  v_exp_f32 v252, v196
  v_exp_f32 v253, v197
  v_exp_f32 v254, v198
  v_exp_f32 v255, v199
  v_pk_fma_f32 v[248:249], v[248:249], s[56:57], s[56:57]
  v_pk_fma_f32 v[250:251], v[250:251], s[56:57], s[56:57]
  v_rcp_f32 v248, v248
  v_rcp_f32 v249, v249
  v_rcp_f32 v250, v250
  v_rcp_f32 v251, v251
  v_pk_fma_f32 v[252:253], v[252:253], s[56:57], s[56:57]
  v_pk_fma_f32 v[254:255], v[254:255], s[56:57], s[56:57]
  v_rcp_f32 v252, v252
  v_rcp_f32 v253, v253
  v_rcp_f32 v254, v254
  v_rcp_f32 v255, v255
  v_pk_mul_f32 v[192:193], v[192:193], v[248:249]
  v_pk_mul_f32 v[194:195], v[194:195], v[250:251]
  v_cvt_pk_bf16_f32 v184, v192, v193
  v_cvt_pk_bf16_f32 v185, v194, v195
  v_pk_mul_f32 v[196:197], v[196:197], v[252:253]
  v_pk_mul_f32 v[198:199], v[198:199], v[254:255]
  v_cvt_pk_bf16_f32 v186, v196, v197
  v_cvt_pk_bf16_f32 v187, v198, v199
  buffer_store_dwordx4 v[184:187], v8, s[28:31], s49 offen offset:1152 sc1
  v_pk_fma_f32 v[200:201], v[200:201], v[224:225], v[232:233]
  v_pk_fma_f32 v[202:203], v[202:203], v[226:227], v[234:235]
  v_exp_f32 v248, v200
  v_exp_f32 v249, v201
  v_exp_f32 v250, v202
  v_exp_f32 v251, v203
  v_pk_fma_f32 v[204:205], v[204:205], v[228:229], v[236:237]
  v_pk_fma_f32 v[206:207], v[206:207], v[230:231], v[238:239]
  v_exp_f32 v252, v204
  v_exp_f32 v253, v205
  v_exp_f32 v254, v206
  v_exp_f32 v255, v207
  v_pk_fma_f32 v[248:249], v[248:249], s[56:57], s[56:57]
  v_pk_fma_f32 v[250:251], v[250:251], s[56:57], s[56:57]
  v_rcp_f32 v248, v248
  v_rcp_f32 v249, v249
  v_rcp_f32 v250, v250
  v_rcp_f32 v251, v251
  v_pk_fma_f32 v[252:253], v[252:253], s[56:57], s[56:57]
  v_pk_fma_f32 v[254:255], v[254:255], s[56:57], s[56:57]
  v_rcp_f32 v252, v252
  v_rcp_f32 v253, v253
  v_rcp_f32 v254, v254
  v_rcp_f32 v255, v255
  v_pk_mul_f32 v[200:201], v[200:201], v[248:249]
  v_pk_mul_f32 v[202:203], v[202:203], v[250:251]
  v_cvt_pk_bf16_f32 v192, v200, v201
  v_cvt_pk_bf16_f32 v193, v202, v203
  v_pk_mul_f32 v[204:205], v[204:205], v[252:253]
  v_pk_mul_f32 v[206:207], v[206:207], v[254:255]
  v_cvt_pk_bf16_f32 v194, v204, v205
  v_cvt_pk_bf16_f32 v195, v206, v207
  buffer_store_dwordx4 v[192:195], v8, s[28:31], s49 offen offset:2304 sc1
  v_pk_fma_f32 v[208:209], v[208:209], v[224:225], v[232:233]
  v_pk_fma_f32 v[210:211], v[210:211], v[226:227], v[234:235]
  v_exp_f32 v248, v208
  v_exp_f32 v249, v209
  v_exp_f32 v250, v210
  v_exp_f32 v251, v211
  v_pk_fma_f32 v[212:213], v[212:213], v[228:229], v[236:237]
  v_pk_fma_f32 v[214:215], v[214:215], v[230:231], v[238:239]
  v_exp_f32 v252, v212
  v_exp_f32 v253, v213
  v_exp_f32 v254, v214
  v_exp_f32 v255, v215
  v_pk_fma_f32 v[248:249], v[248:249], s[56:57], s[56:57]
  v_pk_fma_f32 v[250:251], v[250:251], s[56:57], s[56:57]
  v_rcp_f32 v248, v248
  v_rcp_f32 v249, v249
  v_rcp_f32 v250, v250
  v_rcp_f32 v251, v251
  v_pk_fma_f32 v[252:253], v[252:253], s[56:57], s[56:57]
  v_pk_fma_f32 v[254:255], v[254:255], s[56:57], s[56:57]
  v_rcp_f32 v252, v252
  v_rcp_f32 v253, v253
  v_rcp_f32 v254, v254
  v_rcp_f32 v255, v255
  v_pk_mul_f32 v[208:209], v[208:209], v[248:249]
  v_pk_mul_f32 v[210:211], v[210:211], v[250:251]
  v_cvt_pk_bf16_f32 v200, v208, v209
  v_cvt_pk_bf16_f32 v201, v210, v211
  v_pk_mul_f32 v[212:213], v[212:213], v[252:253]
  v_pk_mul_f32 v[214:215], v[214:215], v[254:255]
  v_cvt_pk_bf16_f32 v202, v212, v213
  v_cvt_pk_bf16_f32 v203, v214, v215
  buffer_store_dwordx4 v[200:203], v8, s[28:31], s49 offen offset:3456 sc1
  v_pk_fma_f32 v[216:217], v[216:217], v[40:41], v[164:165]
  v_pk_fma_f32 v[218:219], v[218:219], v[42:43], v[166:167]
  v_exp_f32 v248, v216
  v_exp_f32 v249, v217
  v_exp_f32 v250, v218
  v_exp_f32 v251, v219
  v_pk_fma_f32 v[220:221], v[220:221], v[40:41], v[164:165]
  v_pk_fma_f32 v[222:223], v[222:223], v[42:43], v[166:167]
  v_exp_f32 v252, v220
  v_exp_f32 v253, v221
  v_exp_f32 v254, v222
  v_exp_f32 v255, v223
  v_pk_fma_f32 v[248:249], v[248:249], s[56:57], s[56:57]
  v_pk_fma_f32 v[250:251], v[250:251], s[56:57], s[56:57]
  v_rcp_f32 v248, v248
  v_rcp_f32 v249, v249
  v_rcp_f32 v250, v250
  v_rcp_f32 v251, v251
  v_pk_fma_f32 v[252:253], v[252:253], s[56:57], s[56:57]
  v_pk_fma_f32 v[254:255], v[254:255], s[56:57], s[56:57]
  v_rcp_f32 v252, v252
  v_rcp_f32 v253, v253
  v_rcp_f32 v254, v254
  v_rcp_f32 v255, v255
  v_pk_mul_f32 v[216:217], v[216:217], v[248:249]
  v_pk_mul_f32 v[218:219], v[218:219], v[250:251]
  v_cvt_pk_bf16_f32 v208, v216, v217
  v_cvt_pk_bf16_f32 v209, v218, v219
  v_pk_mul_f32 v[220:221], v[220:221], v[252:253]
  v_pk_mul_f32 v[222:223], v[222:223], v[254:255]
  v_cvt_pk_bf16_f32 v210, v220, v221
  v_cvt_pk_bf16_f32 v211, v222, v223
  s_nop 1
  v_permlane16_swap_b32 v208, v210
  v_permlane16_swap_b32 v209, v211
  buffer_store_dwordx4 v[208:211], v9, s[28:31], s50 offen
  s_endpgm
L_end:
  s_endpgm
.section .rodata,"a"
.p2align 6
.amdhsa_kernel standalone__batchnorm__sampling_kernel
.amdhsa_next_free_vgpr 256
.amdhsa_next_free_sgpr 102
.amdhsa_accum_offset 256
.amdhsa_group_segment_fixed_size 0
.amdhsa_kernarg_size 72
.amdhsa_user_sgpr_count 2
.amdhsa_user_sgpr_kernarg_segment_ptr 1
.amdhsa_system_sgpr_workgroup_id_x 1
.amdhsa_float_denorm_mode_32 3
.end_amdhsa_kernel
```
